```python
import torch

def _softmax(x, axis=-1):
    return torch.softmax(x, dim=axis)
def _gelu(x):
    return torch.nn.functional.gelu(x, approximate="tanh")
def _silu(x):
    return torch.nn.functional.silu(x)
def _sigmoid(x):
    return torch.sigmoid(x)
def _layernorm(x, axis=-1, eps=1e-5):
    m = x.mean(dim=axis, keepdim=True)
    v = x.var(dim=axis, keepdim=True, unbiased=False)
    return (x - m) / torch.sqrt(v + eps)
def _scatter_add(tgt, idx, src, axis=0):
    return tgt.clone().index_add_(axis, idx, src)
def _segment_sum(src, seg, n):
    out = torch.zeros((n,) + src.shape[1:], dtype=src.dtype)
    return out.index_add_(0, seg, src)
def _pad(x, pw):
    flat = tuple(v for pair in reversed(pw) for v in pair)
    return torch.nn.functional.pad(x, flat)

kernel_name = 'sequential_preLN__mha_block__dense_activation_relu__prompt'

def setup_inputs():

    _w = (lambda a: (lambda t: t.to(torch.bfloat16) if t.is_floating_point() else t)(torch.as_tensor(a)))
    def _A_setup():
        B, S, D, H = 1, 2048, 640, 32
        return {
            "x": _w((lambda *s: torch.randn(*s, dtype=torch.bfloat16) * 0.05)(B, S, D)),
            "wqkv": _w((lambda *s: torch.randn(*s, dtype=torch.bfloat16) * 0.05)(D, 3 * D)),
            "wo": _w((lambda *s: torch.randn(*s, dtype=torch.bfloat16) * 0.05)(D, D)),
        }
    _A_in = _A_setup()

    def _B_setup():
        B, S, D, Dff = 1, 2048, 640, 1728
        return {
            "x": _w((lambda *s: torch.randn(*s, dtype=torch.bfloat16) * 0.05)(B, S, D)),
            "w1": _w((lambda *s: torch.randn(*s, dtype=torch.bfloat16) * 0.05)(D, Dff)),
            "w2": _w((lambda *s: torch.randn(*s, dtype=torch.bfloat16) * 0.05)(Dff, D)),
        }
    _B_in = _B_setup()

    return {
        "A_x": _A_in["x"],
        "A_wqkv": _A_in["wqkv"],
        "A_wo": _A_in["wo"],
        "B_x": _B_in["x"],
        "B_w1": _B_in["w1"],
        "B_w2": _B_in["w2"],
    }

def reference(A_x, A_wqkv, A_wo, B_x, B_w1, B_w2):
    def _A_ref(x, wqkv, wo):
        B, S, D = x.shape
        H = 32
        Dh = D // H
        qkv = (lambda x, *d: x.permute(*d))((x @ wqkv).reshape(B, S, 3, H, Dh), 2, 0, 3, 1, 4)
        q, k, v = qkv[0], qkv[1], qkv[2]
        scores = torch.einsum("bhqd,bhkd->bhqk", q, k) * (Dh ** -0.5)
        p = _softmax(scores, axis=-1)
        o = torch.einsum("bhqk,bhkd->bhqd", p, v)
        return (lambda x, *d: x.permute(*d))(o, 0, 2, 1, 3).reshape(B, S, D) @ wo

    def _B_ref(x, w1, w2):
        h = torch.einsum("bsd,df->bsf", x, w1)
        zero = torch.zeros_like(h)
        h = torch.maximum(h, zero)
        return torch.einsum("bsf,fd->bsd", h, w2)

    x = A_x
    h = x + _A_ref(_layernorm(x, axis=-1), A_wqkv, A_wo)
    h2 = h + _B_ref(_layernorm(h, axis=-1), B_w1, B_w2)
    return h2
```

```asm
; @launch grid=(256,1,1) block=(512,1,1) lds=163840
.amdgcn_target "amdgcn-amd-amdhsa--gfx950"
.text
.globl sequential_preLN__mha_block__dense_activation_relu__prompt_kernel
.p2align 8
.type sequential_preLN__mha_block__dense_activation_relu__prompt_kernel,@function
sequential_preLN__mha_block__dense_activation_relu__prompt_kernel:
    s_cmp_ge_u32 s2, 240
    s_cbranch_scc1 p1_1
    s_load_dwordx4 s[4:7], s[0:1], 0
    s_load_dwordx4 s[8:11], s[0:1], 56
    v_lshrrev_b32 v2, 6, v0
    v_and_b32 v1, 63, v0
    v_readfirstlane_b32 s20, v2
    s_and_b32 s27, s2, 1
    s_mul_i32 s27, s27, 30
    s_lshr_b32 s23, s2, 3
    s_add_u32 s27, s27, s23
    s_lshr_b32 s22, s27, 2
    s_and_b32 s27, s27, 3
    s_bfe_u32 s21, s2, 0x20001
    s_lshl_b32 s21, s21, 2
    s_add_u32 s21, s21, s27
    s_lshr_b32 s38, s21, 1
    s_lshr_b32 s40, s21, 3
    s_add_u32 s38, s38, s40
    s_add_u32 s38, s38, s22
    s_add_u32 s40, s38, 8
    s_cmp_eq_u32 s40, 30
    s_cselect_b32 s40, 20, s40
    s_cmp_ge_u32 s22, 12
    s_cselect_b32 s30, s40, s38
    s_cmp_lt_u32 s22, 10
    s_cselect_b32 s30, s22, s30
    s_cmp_lt_u32 s22, 8
    s_cselect_b32 s40, 2, -5
    s_cselect_b32 s31, 10, 20
    s_add_u32 s38, s38, s40
    s_sub_u32 s40, s38, 10
    s_cmp_ge_u32 s38, 10
    s_cselect_b32 s38, s40, s38
    s_add_u32 s31, s31, s38
    s_cmp_lt_u32 s20, 4
    s_cbranch_scc1 p1_2
    s_mul_i32 s27, s27, 3
    s_add_u32 s23, s22, s27
    s_sub_u32 s27, s23, 10
    s_cmp_ge_u32 s23, 10
    s_cselect_b32 s23, s27, s23
    s_sub_u32 s27, s23, 10
    s_cmp_ge_u32 s23, 10
    s_cselect_b32 s23, s27, s23
    s_mul_i32 s37, s21, 163840
    s_lshl_b32 s36, s30, 7
    s_sub_u32 s41, s20, 4
    s_lshl_b32 s41, s41, 10
    s_mov_b32 s26, s41
    v_and_b32 v7, 255, v0
    v_lshrrev_b32 v2, 3, v7
    v_mul_u32_u24 v8, 1280, v2
    v_lshrrev_b32 v3, 4, v7
    v_xor_b32 v4, v7, v3
    v_and_b32 v4, 7, v4
    v_lshl_add_u32 v8, v4, 4, v8
    v_mul_u32_u24 v12, 3840, v2
    v_lshlrev_b32 v4, 2, v3
    v_xor_b32 v4, v7, v4
    v_and_b32 v4, 7, v4
    v_lshl_add_u32 v12, v4, 4, v12
    v_add_u32 v9, 40960, v8
    v_add_u32 v10, 81920, v8
    v_add_u32 v11, 122880, v8
    v_add_u32 v13, 122880, v12
    s_waitcnt lgkmcnt(0)
    s_mov_b32 s12, s4
    s_mov_b32 s13, s5
    s_mov_b32 s14, 2621440
    s_mov_b32 s15, 0x20000
    s_mov_b32 s16, s6
    s_mov_b32 s17, s7
    s_mov_b32 s18, 2457600
    s_mov_b32 s19, 0x20000
    s_mov_b32 s28, 0
p1p_6:
    s_lshl_b32 s24, s23, 7
    s_mul_i32 s25, s23, 245760
    s_mov_b32 m0, s26
    s_add_u32 s24, s24, s37
    s_add_u32 s25, s25, s36
    buffer_load_dwordx4 v8, s[12:15], s24 offen lds
    s_add_u32 m0, s26, 16384
    s_nop 0
    buffer_load_dwordx4 v12, s[16:19], s25 offen lds
    s_add_u32 m0, s26, 4096
    s_nop 0
    buffer_load_dwordx4 v9, s[12:15], s24 offen lds
    s_add_u32 m0, s26, 20480
    s_nop 0
    buffer_load_dwordx4 v13, s[16:19], s25 offen lds
    s_add_u32 m0, s26, 8192
    s_nop 0
    buffer_load_dwordx4 v10, s[12:15], s24 offen lds
    s_add_u32 m0, s26, 12288
    s_nop 0
    buffer_load_dwordx4 v11, s[12:15], s24 offen lds
    s_add_u32 s23, s23, 1
    s_cmp_eq_u32 s23, 10
    s_cselect_b32 s23, 0, s23
    s_add_u32 s26, s26, 24576
    s_cmp_ge_u32 s26, 73728
    s_cselect_b32 s26, s41, s26
    s_add_u32 s28, s28, 1
    s_cmp_eq_u32 s28, 1
    s_cbranch_scc1 p1p_6
    s_cmp_eq_u32 s28, 2
    s_cbranch_scc0 p1p_7
    v_bfe_u32 v5, v1, 2, 2
    v_lshrrev_b32 v6, 5, v1
    v_lshl_add_u32 v6, v6, 3, v5
    v_lshlrev_b32 v14, 7, v6
    v_bfe_u32 v5, v1, 3, 1
    v_lshl_add_u32 v14, v5, 6, v14
    v_bfe_u32 v5, v1, 4, 1
    v_lshl_add_u32 v14, v5, 5, v14
    v_and_b32 v5, 3, v1
    v_lshl_add_u32 v14, v5, 3, v14
    s_lshl_b32 s27, s41, 1
    s_add_u32 s27, s27, 16384
    v_add_u32 v14, s27, v14
    v_lshrrev_b32 v2, 2, v1
    v_lshrrev_b32 v4, 4, v1
    v_xor_b32 v4, v2, v4
    v_and_b32 v4, 1, v4
    v_and_b32 v2, 2, v2
    v_or_b32 v4, v4, v2
    v_mov_b32 v2, 0x3f803f80
    v_cmp_eq_u32 vcc, 0, v4
    s_nop 1
    v_cndmask_b32 v36, 0, v2, vcc
    v_cndmask_b32 v37, 0, v2, vcc
    v_cndmask_b32 v38, 0, v2, vcc
    v_cndmask_b32 v39, 0, v2, vcc
    v_cmp_eq_u32 vcc, 2, v4
    s_nop 1
    v_cndmask_b32 v40, 0, v2, vcc
    v_cndmask_b32 v41, 0, v2, vcc
    v_cndmask_b32 v42, 0, v2, vcc
    v_cndmask_b32 v43, 0, v2, vcc
    v_mov_b32 v44, 0
    v_mov_b32 v45, 0
    v_mov_b32 v46, 0
    v_mov_b32 v47, 0
    v_mov_b32 v64, 0
    v_mov_b32 v65, 0
    v_mov_b32 v66, 0
    v_mov_b32 v67, 0
    v_mov_b32 v68, 0
    v_mov_b32 v69, 0
    v_mov_b32 v70, 0
    v_mov_b32 v71, 0
    s_mov_b32 s29, 0
p1p_7:
    s_waitcnt lgkmcnt(0)
    v_mfma_f32_16x16x32_bf16 v[44:47], v[36:39], v[64:67], v[44:47]
    v_mfma_f32_16x16x32_bf16 v[44:47], v[40:43], v[68:71], v[44:47]
    s_waitcnt vmcnt(6)
    s_barrier
    v_add_u32 v15, s29, v14
    v_xor_b32 v16, 64, v15
    ds_read_b64_tr_b16 v[64:65], v15 offset:0
    ds_read_b64_tr_b16 v[66:67], v15 offset:512
    ds_read_b64_tr_b16 v[68:69], v16 offset:0
    ds_read_b64_tr_b16 v[70:71], v16 offset:512
    s_add_u32 s29, s29, 24576
    s_cmp_ge_u32 s29, 73728
    s_cselect_b32 s29, 0, s29
    s_cmp_lt_u32 s28, 10
    s_cbranch_scc1 p1p_6
    s_lshl_b32 s36, s31, 7
    s_add_u32 s26, s41, 73728
    s_mov_b32 s32, s10
    s_mov_b32 s33, s11
    s_mov_b32 s34, 25794560
    s_mov_b32 s35, 0x20000
    s_mov_b32 s28, 3
p1p_8:
    s_mul_i32 s25, s23, 245760
    s_mov_b32 m0, s26
    s_add_u32 s25, s25, s36
    buffer_load_dwordx4 v12, s[16:19], s25 offen lds
    s_add_u32 m0, s26, 4096
    s_add_u32 s26, s26, 8192
    buffer_load_dwordx4 v13, s[16:19], s25 offen lds
    s_add_u32 s23, s23, 1
    s_cmp_eq_u32 s23, 10
    s_cselect_b32 s23, 0, s23
    s_sub_u32 s28, s28, 1
    s_cmp_lg_u32 s28, 0
    s_cbranch_scc1 p1p_8
    s_waitcnt lgkmcnt(0)
    v_mfma_f32_16x16x32_bf16 v[44:47], v[36:39], v[64:67], v[44:47]
    v_mfma_f32_16x16x32_bf16 v[44:47], v[40:43], v[68:71], v[44:47]
    s_waitcnt vmcnt(6) lgkmcnt(0)
    s_barrier
    v_add_u32 v15, s29, v14
    v_xor_b32 v16, 64, v15
    ds_read_b64_tr_b16 v[64:65], v15 offset:0
    ds_read_b64_tr_b16 v[66:67], v15 offset:512
    ds_read_b64_tr_b16 v[68:69], v16 offset:0
    ds_read_b64_tr_b16 v[70:71], v16 offset:512
    s_add_u32 s29, s29, 24576
    s_cmp_ge_u32 s29, 73728
    s_cselect_b32 s29, 0, s29
    s_waitcnt lgkmcnt(0)
    v_mfma_f32_16x16x32_bf16 v[44:47], v[36:39], v[64:67], v[44:47]
    v_mfma_f32_16x16x32_bf16 v[44:47], v[40:43], v[68:71], v[44:47]
    s_lshr_b32 s27, s41, 2
    s_add_u32 s27, s27, 157696
    v_lshl_add_u32 v2, v1, 2, s27
    v_mov_b32 v3, 0
    v_mov_b32 v4, 1
    s_nop 3
    ds_write_b32 v2, v44
    s_mov_b32 s28, 3
p1p_9:
    s_mul_i32 s25, s23, 245760
    s_mov_b32 m0, s26
    s_add_u32 s25, s25, s36
    buffer_load_dwordx4 v12, s[16:19], s25 offen lds
    s_add_u32 m0, s26, 4096
    s_add_u32 s26, s26, 8192
    buffer_load_dwordx4 v13, s[16:19], s25 offen lds
    s_add_u32 s23, s23, 1
    s_cmp_eq_u32 s23, 10
    s_cselect_b32 s23, 0, s23
    s_sub_u32 s28, s28, 1
    s_cmp_lg_u32 s28, 0
    s_cbranch_scc1 p1p_9
    s_waitcnt vmcnt(6) lgkmcnt(0)
    s_barrier
    v_add_u32 v8, 57344, v14
    v_xor_b32 v9, 64, v8
    v_add_u32 v10, 40960, v8
    v_add_u32 v11, 40960, v9
    s_waitcnt vmcnt(0) lgkmcnt(0)
    s_barrier
    s_mov_b32 s28, 4
p1p_10:
    s_mul_i32 s25, s23, 245760
    s_mov_b32 m0, s26
    s_add_u32 s25, s25, s36
    buffer_load_dwordx4 v12, s[16:19], s25 offen lds
    s_add_u32 m0, s26, 4096
    s_add_u32 s26, s26, 8192
    buffer_load_dwordx4 v13, s[16:19], s25 offen lds
    s_add_u32 s23, s23, 1
    s_cmp_eq_u32 s23, 10
    s_cselect_b32 s23, 0, s23
    s_sub_u32 s28, s28, 1
    s_cmp_lg_u32 s28, 0
    s_cbranch_scc1 p1p_10
    ds_read_b64_tr_b16 v[64:65], v8 offset:0
    ds_read_b64_tr_b16 v[66:67], v8 offset:512
    ds_read_b64_tr_b16 v[68:69], v9 offset:0
    ds_read_b64_tr_b16 v[70:71], v9 offset:512
    ds_read_b64_tr_b16 v[72:73], v8 offset:8192
    ds_read_b64_tr_b16 v[74:75], v8 offset:8704
    ds_read_b64_tr_b16 v[76:77], v9 offset:8192
    ds_read_b64_tr_b16 v[78:79], v9 offset:8704
    ds_read_b64_tr_b16 v[80:81], v8 offset:16384
    ds_read_b64_tr_b16 v[82:83], v8 offset:16896
    ds_read_b64_tr_b16 v[84:85], v9 offset:16384
    ds_read_b64_tr_b16 v[86:87], v9 offset:16896
    s_waitcnt lgkmcnt(8)
    v_mfma_f32_16x16x32_bf16 v[44:47], v[36:39], v[64:67], 0
    v_mfma_f32_16x16x32_bf16 v[44:47], v[40:43], v[68:71], v[44:47]
    ds_read_b64_tr_b16 v[88:89], v8 offset:24576
    ds_read_b64_tr_b16 v[90:91], v8 offset:25088
    ds_read_b64_tr_b16 v[92:93], v9 offset:24576
    ds_read_b64_tr_b16 v[94:95], v9 offset:25088
    s_waitcnt lgkmcnt(8)
    v_mfma_f32_16x16x32_bf16 v[44:47], v[36:39], v[72:75], v[44:47]
    v_mfma_f32_16x16x32_bf16 v[44:47], v[40:43], v[76:79], v[44:47]
    ds_read_b64_tr_b16 v[96:97], v8 offset:32768
    ds_read_b64_tr_b16 v[98:99], v8 offset:33280
    ds_read_b64_tr_b16 v[100:101], v9 offset:32768
    ds_read_b64_tr_b16 v[102:103], v9 offset:33280
    s_waitcnt lgkmcnt(8)
    v_mfma_f32_16x16x32_bf16 v[44:47], v[36:39], v[80:83], v[44:47]
    v_mfma_f32_16x16x32_bf16 v[44:47], v[40:43], v[84:87], v[44:47]
    ds_read_b64_tr_b16 v[104:105], v10 offset:0
    ds_read_b64_tr_b16 v[106:107], v10 offset:512
    ds_read_b64_tr_b16 v[108:109], v11 offset:0
    ds_read_b64_tr_b16 v[110:111], v11 offset:512
    s_waitcnt lgkmcnt(8)
    v_mfma_f32_16x16x32_bf16 v[44:47], v[36:39], v[88:91], v[44:47]
    v_mfma_f32_16x16x32_bf16 v[44:47], v[40:43], v[92:95], v[44:47]
    s_waitcnt lgkmcnt(4)
    v_mfma_f32_16x16x32_bf16 v[44:47], v[36:39], v[96:99], v[44:47]
    v_mfma_f32_16x16x32_bf16 v[44:47], v[40:43], v[100:103], v[44:47]
    s_waitcnt lgkmcnt(0)
    v_mfma_f32_16x16x32_bf16 v[44:47], v[36:39], v[104:107], v[44:47]
    v_mfma_f32_16x16x32_bf16 v[44:47], v[40:43], v[108:111], v[44:47]
    s_waitcnt vmcnt(0) lgkmcnt(0)
    s_barrier
    s_cmp_lg_u32 s20, 7
    s_cbranch_scc1 p1p_11
    s_bfe_u32 s27, s2, 0x50002
    s_lshl_b32 s27, s27, 8
    s_lshr_b32 s38, s2, 7
    s_lshl_b32 s38, s38, 4
    s_add_u32 s27, s27, s38
    s_and_b32 s38, s2, 3
    s_lshl_b32 s38, s38, 2
    s_add_u32 s27, s27, s38
    s_add_u32 s27, s27, 25683968
    v_and_b32 v2, 63, v0
    v_lshlrev_b32 v2, 13, v2
    v_mov_b32 v3, 1
    s_mov_b64 exec, 0xff
    buffer_store_dword v3, v2, s[32:35], s27 offen sc1
    s_mov_b64 exec, -1
    s_setprio 3
p1p_11:
    ds_read_b64_tr_b16 v[112:113], v10 offset:8192
    ds_read_b64_tr_b16 v[114:115], v10 offset:8704
    ds_read_b64_tr_b16 v[116:117], v11 offset:8192
    ds_read_b64_tr_b16 v[118:119], v11 offset:8704
    ds_read_b64_tr_b16 v[120:121], v10 offset:16384
    ds_read_b64_tr_b16 v[122:123], v10 offset:16896
    ds_read_b64_tr_b16 v[124:125], v11 offset:16384
    ds_read_b64_tr_b16 v[126:127], v11 offset:16896
    ds_read_b64_tr_b16 v[128:129], v10 offset:24576
    ds_read_b64_tr_b16 v[130:131], v10 offset:25088
    ds_read_b64_tr_b16 v[132:133], v11 offset:24576
    ds_read_b64_tr_b16 v[134:135], v11 offset:25088
    s_waitcnt lgkmcnt(8)
    v_mfma_f32_16x16x32_bf16 v[44:47], v[36:39], v[112:115], v[44:47]
    v_mfma_f32_16x16x32_bf16 v[44:47], v[40:43], v[116:119], v[44:47]
    ds_read_b64_tr_b16 v[136:137], v10 offset:32768
    ds_read_b64_tr_b16 v[138:139], v10 offset:33280
    ds_read_b64_tr_b16 v[140:141], v11 offset:32768
    ds_read_b64_tr_b16 v[142:143], v11 offset:33280
    s_waitcnt lgkmcnt(8)
    v_mfma_f32_16x16x32_bf16 v[44:47], v[36:39], v[120:123], v[44:47]
    v_mfma_f32_16x16x32_bf16 v[44:47], v[40:43], v[124:127], v[44:47]
    s_waitcnt lgkmcnt(4)
    v_mfma_f32_16x16x32_bf16 v[44:47], v[36:39], v[128:131], v[44:47]
    v_mfma_f32_16x16x32_bf16 v[44:47], v[40:43], v[132:135], v[44:47]
    s_waitcnt lgkmcnt(0)
    v_mfma_f32_16x16x32_bf16 v[44:47], v[36:39], v[136:139], v[44:47]
    v_mfma_f32_16x16x32_bf16 v[44:47], v[40:43], v[140:143], v[44:47]
    s_lshr_b32 s27, s41, 2
    s_add_u32 s27, s27, 155648
    v_lshl_add_u32 v2, v1, 2, s27
    v_mov_b32 v3, 157188
    v_mov_b32 v4, 1
    s_nop 3
    ds_write_b32 v2, v44
    s_mov_b64 exec, 1
    ds_add_u32 v3, v4
    s_mov_b64 exec, -1
    s_branch p2
p1_2:
    s_waitcnt lgkmcnt(0)
    s_mov_b32 s12, s4
    s_mov_b32 s13, s5
    s_mov_b32 s14, 2621440
    s_mov_b32 s15, 0x20000
    s_cmp_lg_u32 s20, 0
    s_cbranch_scc1 p1t_12
    s_and_b32 s56, s2, 7
    s_lshl_b32 s56, s56, 5
    s_lshr_b32 s38, s2, 3
    s_add_u32 s56, s56, s38
    s_mul_i32 s38, s56, 10240
    v_lshrrev_b32 v240, 3, v0
    v_mul_u32_u24 v241, 1280, v240
    v_and_b32 v242, 7, v0
    v_lshl_add_u32 v241, v242, 4, v241
    buffer_load_dwordx4 v[200:203], v241, s[12:15], s38 offen offset:0
    buffer_load_dwordx4 v[204:207], v241, s[12:15], s38 offen offset:128
    buffer_load_dwordx4 v[208:211], v241, s[12:15], s38 offen offset:256
    buffer_load_dwordx4 v[212:215], v241, s[12:15], s38 offen offset:384
    buffer_load_dwordx4 v[216:219], v241, s[12:15], s38 offen offset:512
    buffer_load_dwordx4 v[220:223], v241, s[12:15], s38 offen offset:640
    buffer_load_dwordx4 v[224:227], v241, s[12:15], s38 offen offset:768
    buffer_load_dwordx4 v[228:231], v241, s[12:15], s38 offen offset:896
    buffer_load_dwordx4 v[232:235], v241, s[12:15], s38 offen offset:1024
    buffer_load_dwordx4 v[236:239], v241, s[12:15], s38 offen offset:1152
    v_mov_b32 v2, 157184
    v_mov_b32 v3, 0
    ds_write2_b32 v2, v3, v3 offset0:0 offset1:1
    s_waitcnt lgkmcnt(0)
p1t_12:
    s_mov_b32 s32, s10
    s_mov_b32 s33, s11
    s_mov_b32 s34, 25794560
    s_mov_b32 s35, 0x20000
    s_mov_b32 s44, s8
    s_mov_b32 s45, s9
    s_mov_b32 s46, 256
    s_mov_b32 s47, 0x20000
    s_setprio 2
    s_lshl_b32 s27, s21, 8
    s_add_u32 s27, s27, 25679872
    v_and_b32 v16, 15, v1
    v_lshl_add_u32 v16, v16, 2, s27
    s_lshl_b32 s41, s21, 10
    s_lshl_b32 s27, s20, 7
    s_add_u32 s41, s41, s27
    s_add_u32 s41, s41, 25663488
    s_add_u32 s27, s27, 156672
    v_lshrrev_b32 v17, 5, v1
    v_lshl_add_u32 v34, v17, 4, s27
    v_and_b32 v2, 31, v1
    v_lshlrev_b32 v14, 3, v2
    v_bfe_u32 v4, v1, 1, 3
    v_xor_b32 v4, v4, v17
    s_lshl_b32 s27, s20, 12
    v_lshl_add_u32 v2, v2, 7, s27
    v_xor_b32 v5, 0, v4
    v_lshl_add_u32 v8, v5, 4, v2
    v_xor_b32 v5, 2, v4
    v_lshl_add_u32 v9, v5, 4, v2
    v_xor_b32 v5, 4, v4
    v_lshl_add_u32 v10, v5, 4, v2
    v_xor_b32 v5, 6, v4
    v_lshl_add_u32 v11, v5, 4, v2
    v_bfe_u32 v5, v1, 2, 2
    v_lshrrev_b32 v6, 5, v1
    v_lshl_add_u32 v6, v6, 3, v5
    v_lshlrev_b32 v12, 7, v6
    v_bfe_u32 v5, v1, 3, 1
    v_lshl_add_u32 v12, v5, 6, v12
    v_bfe_u32 v5, v1, 4, 1
    v_lshl_add_u32 v12, v5, 5, v12
    v_and_b32 v5, 3, v1
    v_lshl_add_u32 v12, v5, 3, v12
    v_add_u32 v12, 16384, v12
    v_xor_b32 v13, 64, v12
    s_call_b64 s[98:99], p1_5
    s_mov_b32 s36, s30
    s_call_b64 s[58:59], p1_4
    s_cmp_lg_u32 s20, 0
    s_cbranch_scc1 p1t_13
    s_call_b64 s[58:59], p1_3
p1t_13:
    s_barrier
    ds_read_b64_tr_b16 v[48:49], v12 offset:0
    ds_read_b64_tr_b16 v[50:51], v12 offset:512
    ds_read_b128 v[96:99], v8 offset:0
    ds_read_b64_tr_b16 v[52:53], v13 offset:0
    ds_read_b64_tr_b16 v[54:55], v13 offset:512
    s_cmp_ge_u32 s22, 12
    s_cbranch_scc1 p1_16
    s_waitcnt lgkmcnt(2)
    v_mfma_f32_32x32x16_bf16 v[64:79], v[48:51], v[96:99], 0
    ds_read_b64_tr_b16 v[56:57], v12 offset:2048
    ds_read_b64_tr_b16 v[58:59], v12 offset:2560
    ds_read_b128 v[100:103], v9 offset:0
    s_waitcnt lgkmcnt(3)
    v_mfma_f32_32x32x16_bf16 v[80:95], v[52:55], v[96:99], 0
    ds_read_b64_tr_b16 v[60:61], v13 offset:2048
    ds_read_b64_tr_b16 v[62:63], v13 offset:2560
    s_waitcnt lgkmcnt(2)
    v_mfma_f32_32x32x16_bf16 v[64:79], v[56:59], v[100:103], v[64:79]
    ds_read_b64_tr_b16 v[48:49], v12 offset:4096
    ds_read_b64_tr_b16 v[50:51], v12 offset:4608
    ds_read_b128 v[104:107], v10 offset:0
    s_waitcnt lgkmcnt(3)
    v_mfma_f32_32x32x16_bf16 v[80:95], v[60:63], v[100:103], v[80:95]
    ds_read_b64_tr_b16 v[52:53], v13 offset:4096
    ds_read_b64_tr_b16 v[54:55], v13 offset:4608
    s_waitcnt lgkmcnt(2)
    v_mfma_f32_32x32x16_bf16 v[64:79], v[48:51], v[104:107], v[64:79]
    ds_read_b64_tr_b16 v[56:57], v12 offset:6144
    ds_read_b64_tr_b16 v[58:59], v12 offset:6656
    ds_read_b128 v[108:111], v11 offset:0
    s_waitcnt lgkmcnt(3)
    v_mfma_f32_32x32x16_bf16 v[80:95], v[52:55], v[104:107], v[80:95]
    ds_read_b64_tr_b16 v[60:61], v13 offset:6144
    ds_read_b64_tr_b16 v[62:63], v13 offset:6656
    s_waitcnt lgkmcnt(0)
    v_mfma_f32_32x32x16_bf16 v[64:79], v[56:59], v[108:111], v[64:79]
    s_barrier
    ds_read_b64_tr_b16 v[48:49], v12 offset:24576
    ds_read_b64_tr_b16 v[50:51], v12 offset:25088
    ds_read_b128 v[112:115], v8 offset:24576
    v_mfma_f32_32x32x16_bf16 v[80:95], v[60:63], v[108:111], v[80:95]
    ds_read_b64_tr_b16 v[52:53], v13 offset:24576
    ds_read_b64_tr_b16 v[54:55], v13 offset:25088
    s_waitcnt lgkmcnt(2)
    v_mfma_f32_32x32x16_bf16 v[64:79], v[48:51], v[112:115], v[64:79]
    ds_read_b64_tr_b16 v[56:57], v12 offset:26624
    ds_read_b64_tr_b16 v[58:59], v12 offset:27136
    ds_read_b128 v[116:119], v9 offset:24576
    s_waitcnt lgkmcnt(3)
    v_mfma_f32_32x32x16_bf16 v[80:95], v[52:55], v[112:115], v[80:95]
    ds_read_b64_tr_b16 v[60:61], v13 offset:26624
    ds_read_b64_tr_b16 v[62:63], v13 offset:27136
    s_waitcnt lgkmcnt(2)
    v_mfma_f32_32x32x16_bf16 v[64:79], v[56:59], v[116:119], v[64:79]
    ds_read_b64_tr_b16 v[48:49], v12 offset:28672
    ds_read_b64_tr_b16 v[50:51], v12 offset:29184
    ds_read_b128 v[120:123], v10 offset:24576
    s_waitcnt lgkmcnt(3)
    v_mfma_f32_32x32x16_bf16 v[80:95], v[60:63], v[116:119], v[80:95]
    ds_read_b64_tr_b16 v[52:53], v13 offset:28672
    ds_read_b64_tr_b16 v[54:55], v13 offset:29184
    s_waitcnt lgkmcnt(2)
    v_mfma_f32_32x32x16_bf16 v[64:79], v[48:51], v[120:123], v[64:79]
    ds_read_b64_tr_b16 v[56:57], v12 offset:30720
    ds_read_b64_tr_b16 v[58:59], v12 offset:31232
    ds_read_b128 v[124:127], v11 offset:24576
    s_waitcnt lgkmcnt(3)
    v_mfma_f32_32x32x16_bf16 v[80:95], v[52:55], v[120:123], v[80:95]
    ds_read_b64_tr_b16 v[60:61], v13 offset:30720
    ds_read_b64_tr_b16 v[62:63], v13 offset:31232
    s_waitcnt lgkmcnt(0)
    v_mfma_f32_32x32x16_bf16 v[64:79], v[56:59], v[124:127], v[64:79]
    s_barrier
    ds_read_b64_tr_b16 v[48:49], v12 offset:49152
    ds_read_b64_tr_b16 v[50:51], v12 offset:49664
    ds_read_b128 v[128:131], v8 offset:49152
    v_mfma_f32_32x32x16_bf16 v[80:95], v[60:63], v[124:127], v[80:95]
    ds_read_b64_tr_b16 v[52:53], v13 offset:49152
    ds_read_b64_tr_b16 v[54:55], v13 offset:49664
    s_cmp_lg_u32 s20, 0
    s_cbranch_scc1 p1t_19
    s_call_b64 s[58:59], p1_14
p1t_19:
    s_waitcnt lgkmcnt(2)
    v_mfma_f32_32x32x16_bf16 v[64:79], v[48:51], v[128:131], v[64:79]
    ds_read_b64_tr_b16 v[56:57], v12 offset:51200
    ds_read_b64_tr_b16 v[58:59], v12 offset:51712
    ds_read_b128 v[132:135], v9 offset:49152
    s_waitcnt lgkmcnt(3)
    v_mfma_f32_32x32x16_bf16 v[80:95], v[52:55], v[128:131], v[80:95]
    ds_read_b64_tr_b16 v[60:61], v13 offset:51200
    ds_read_b64_tr_b16 v[62:63], v13 offset:51712
    s_waitcnt lgkmcnt(2)
    v_mfma_f32_32x32x16_bf16 v[64:79], v[56:59], v[132:135], v[64:79]
    ds_read_b64_tr_b16 v[48:49], v12 offset:53248
    ds_read_b64_tr_b16 v[50:51], v12 offset:53760
    ds_read_b128 v[136:139], v10 offset:49152
    s_waitcnt lgkmcnt(3)
    v_mfma_f32_32x32x16_bf16 v[80:95], v[60:63], v[132:135], v[80:95]
    ds_read_b64_tr_b16 v[52:53], v13 offset:53248
    ds_read_b64_tr_b16 v[54:55], v13 offset:53760
    s_waitcnt lgkmcnt(2)
    v_mfma_f32_32x32x16_bf16 v[64:79], v[48:51], v[136:139], v[64:79]
    ds_read_b64_tr_b16 v[56:57], v12 offset:55296
    ds_read_b64_tr_b16 v[58:59], v12 offset:55808
    ds_read_b128 v[140:143], v11 offset:49152
    s_waitcnt lgkmcnt(3)
    v_mfma_f32_32x32x16_bf16 v[80:95], v[52:55], v[136:139], v[80:95]
    ds_read_b64_tr_b16 v[60:61], v13 offset:55296
    ds_read_b64_tr_b16 v[62:63], v13 offset:55808
    s_waitcnt lgkmcnt(0)
    v_mfma_f32_32x32x16_bf16 v[64:79], v[56:59], v[140:143], v[64:79]
    s_barrier
    ds_read_b64_tr_b16 v[48:49], v12 offset:0
    ds_read_b64_tr_b16 v[50:51], v12 offset:512
    ds_read_b128 v[144:147], v8 offset:0
    v_mfma_f32_32x32x16_bf16 v[80:95], v[60:63], v[140:143], v[80:95]
    ds_read_b64_tr_b16 v[52:53], v13 offset:0
    ds_read_b64_tr_b16 v[54:55], v13 offset:512
    s_waitcnt lgkmcnt(2)
    v_mfma_f32_32x32x16_bf16 v[64:79], v[48:51], v[144:147], v[64:79]
    ds_read_b64_tr_b16 v[56:57], v12 offset:2048
    ds_read_b64_tr_b16 v[58:59], v12 offset:2560
    ds_read_b128 v[148:151], v9 offset:0
    s_waitcnt lgkmcnt(3)
    v_mfma_f32_32x32x16_bf16 v[80:95], v[52:55], v[144:147], v[80:95]
    ds_read_b64_tr_b16 v[60:61], v13 offset:2048
    ds_read_b64_tr_b16 v[62:63], v13 offset:2560
    s_waitcnt lgkmcnt(2)
    v_mfma_f32_32x32x16_bf16 v[64:79], v[56:59], v[148:151], v[64:79]
    ds_read_b64_tr_b16 v[48:49], v12 offset:4096
    ds_read_b64_tr_b16 v[50:51], v12 offset:4608
    ds_read_b128 v[152:155], v10 offset:0
    s_waitcnt lgkmcnt(3)
    v_mfma_f32_32x32x16_bf16 v[80:95], v[60:63], v[148:151], v[80:95]
    ds_read_b64_tr_b16 v[52:53], v13 offset:4096
    ds_read_b64_tr_b16 v[54:55], v13 offset:4608
    s_waitcnt lgkmcnt(2)
    v_mfma_f32_32x32x16_bf16 v[64:79], v[48:51], v[152:155], v[64:79]
    ds_read_b64_tr_b16 v[56:57], v12 offset:6144
    ds_read_b64_tr_b16 v[58:59], v12 offset:6656
    ds_read_b128 v[156:159], v11 offset:0
    s_waitcnt lgkmcnt(3)
    v_mfma_f32_32x32x16_bf16 v[80:95], v[52:55], v[152:155], v[80:95]
    ds_read_b64_tr_b16 v[60:61], v13 offset:6144
    ds_read_b64_tr_b16 v[62:63], v13 offset:6656
    s_waitcnt lgkmcnt(0)
    v_mfma_f32_32x32x16_bf16 v[64:79], v[56:59], v[156:159], v[64:79]
    s_barrier
    ds_read_b64_tr_b16 v[48:49], v12 offset:24576
    ds_read_b64_tr_b16 v[50:51], v12 offset:25088
    ds_read_b128 v[160:163], v8 offset:24576
    v_mfma_f32_32x32x16_bf16 v[80:95], v[60:63], v[156:159], v[80:95]
    ds_read_b64_tr_b16 v[52:53], v13 offset:24576
    ds_read_b64_tr_b16 v[54:55], v13 offset:25088
    s_waitcnt lgkmcnt(2)
    v_mfma_f32_32x32x16_bf16 v[64:79], v[48:51], v[160:163], v[64:79]
    ds_read_b64_tr_b16 v[56:57], v12 offset:26624
    ds_read_b64_tr_b16 v[58:59], v12 offset:27136
    ds_read_b128 v[164:167], v9 offset:24576
    s_waitcnt lgkmcnt(3)
    v_mfma_f32_32x32x16_bf16 v[80:95], v[52:55], v[160:163], v[80:95]
    ds_read_b64_tr_b16 v[60:61], v13 offset:26624
    ds_read_b64_tr_b16 v[62:63], v13 offset:27136
    s_waitcnt lgkmcnt(2)
    v_mfma_f32_32x32x16_bf16 v[64:79], v[56:59], v[164:167], v[64:79]
    ds_read_b64_tr_b16 v[48:49], v12 offset:28672
    ds_read_b64_tr_b16 v[50:51], v12 offset:29184
    ds_read_b128 v[168:171], v10 offset:24576
    s_waitcnt lgkmcnt(3)
    v_mfma_f32_32x32x16_bf16 v[80:95], v[60:63], v[164:167], v[80:95]
    ds_read_b64_tr_b16 v[52:53], v13 offset:28672
    ds_read_b64_tr_b16 v[54:55], v13 offset:29184
    s_waitcnt lgkmcnt(2)
    v_mfma_f32_32x32x16_bf16 v[64:79], v[48:51], v[168:171], v[64:79]
    ds_read_b64_tr_b16 v[56:57], v12 offset:30720
    ds_read_b64_tr_b16 v[58:59], v12 offset:31232
    ds_read_b128 v[172:175], v11 offset:24576
    s_waitcnt lgkmcnt(3)
    v_mfma_f32_32x32x16_bf16 v[80:95], v[52:55], v[168:171], v[80:95]
    ds_read_b64_tr_b16 v[60:61], v13 offset:30720
    ds_read_b64_tr_b16 v[62:63], v13 offset:31232
    s_waitcnt lgkmcnt(0)
    v_mfma_f32_32x32x16_bf16 v[64:79], v[56:59], v[172:175], v[64:79]
    s_barrier
    ds_read_b64_tr_b16 v[48:49], v12 offset:49152
    ds_read_b64_tr_b16 v[50:51], v12 offset:49664
    ds_read_b128 v[176:179], v8 offset:49152
    v_mfma_f32_32x32x16_bf16 v[80:95], v[60:63], v[172:175], v[80:95]
    ds_read_b64_tr_b16 v[52:53], v13 offset:49152
    ds_read_b64_tr_b16 v[54:55], v13 offset:49664
    s_waitcnt lgkmcnt(2)
    v_mfma_f32_32x32x16_bf16 v[64:79], v[48:51], v[176:179], v[64:79]
    ds_read_b64_tr_b16 v[56:57], v12 offset:51200
    ds_read_b64_tr_b16 v[58:59], v12 offset:51712
    ds_read_b128 v[180:183], v9 offset:49152
    s_waitcnt lgkmcnt(3)
    v_mfma_f32_32x32x16_bf16 v[80:95], v[52:55], v[176:179], v[80:95]
    ds_read_b64_tr_b16 v[60:61], v13 offset:51200
    ds_read_b64_tr_b16 v[62:63], v13 offset:51712
    s_waitcnt lgkmcnt(2)
    v_mfma_f32_32x32x16_bf16 v[64:79], v[56:59], v[180:183], v[64:79]
    ds_read_b64_tr_b16 v[48:49], v12 offset:53248
    ds_read_b64_tr_b16 v[50:51], v12 offset:53760
    ds_read_b128 v[184:187], v10 offset:49152
    s_waitcnt lgkmcnt(3)
    v_mfma_f32_32x32x16_bf16 v[80:95], v[60:63], v[180:183], v[80:95]
    ds_read_b64_tr_b16 v[52:53], v13 offset:53248
    ds_read_b64_tr_b16 v[54:55], v13 offset:53760
    s_waitcnt lgkmcnt(2)
    v_mfma_f32_32x32x16_bf16 v[64:79], v[48:51], v[184:187], v[64:79]
    ds_read_b64_tr_b16 v[56:57], v12 offset:55296
    ds_read_b64_tr_b16 v[58:59], v12 offset:55808
    ds_read_b128 v[188:191], v11 offset:49152
    s_waitcnt lgkmcnt(3)
    v_mfma_f32_32x32x16_bf16 v[80:95], v[52:55], v[184:187], v[80:95]
    ds_read_b64_tr_b16 v[60:61], v13 offset:55296
    ds_read_b64_tr_b16 v[62:63], v13 offset:55808
    s_waitcnt lgkmcnt(0)
    v_mfma_f32_32x32x16_bf16 v[64:79], v[56:59], v[188:191], v[64:79]
    s_barrier
    ds_read_b64_tr_b16 v[48:49], v12 offset:0
    ds_read_b64_tr_b16 v[50:51], v12 offset:512
    ds_read_b128 v[192:195], v8 offset:0
    v_mfma_f32_32x32x16_bf16 v[80:95], v[60:63], v[188:191], v[80:95]
    ds_read_b64_tr_b16 v[52:53], v13 offset:0
    ds_read_b64_tr_b16 v[54:55], v13 offset:512
    buffer_load_dword v15, v16, s[32:35], 0 offen sc1
    s_waitcnt lgkmcnt(2)
    v_mfma_f32_32x32x16_bf16 v[64:79], v[48:51], v[192:195], v[64:79]
    ds_read_b64_tr_b16 v[56:57], v12 offset:2048
    ds_read_b64_tr_b16 v[58:59], v12 offset:2560
    ds_read_b128 v[196:199], v9 offset:0
    s_waitcnt lgkmcnt(3)
    v_mfma_f32_32x32x16_bf16 v[80:95], v[52:55], v[192:195], v[80:95]
    ds_read_b64_tr_b16 v[60:61], v13 offset:2048
    ds_read_b64_tr_b16 v[62:63], v13 offset:2560
    s_waitcnt lgkmcnt(2)
    v_mfma_f32_32x32x16_bf16 v[64:79], v[56:59], v[196:199], v[64:79]
    ds_read_b64_tr_b16 v[48:49], v12 offset:4096
    ds_read_b64_tr_b16 v[50:51], v12 offset:4608
    ds_read_b128 v[200:203], v10 offset:0
    s_waitcnt lgkmcnt(3)
    v_mfma_f32_32x32x16_bf16 v[80:95], v[60:63], v[196:199], v[80:95]
    ds_read_b64_tr_b16 v[52:53], v13 offset:4096
    ds_read_b64_tr_b16 v[54:55], v13 offset:4608
    s_waitcnt lgkmcnt(2)
    v_mfma_f32_32x32x16_bf16 v[64:79], v[48:51], v[200:203], v[64:79]
    ds_read_b64_tr_b16 v[56:57], v12 offset:6144
    ds_read_b64_tr_b16 v[58:59], v12 offset:6656
    ds_read_b128 v[204:207], v11 offset:0
    s_waitcnt lgkmcnt(3)
    v_mfma_f32_32x32x16_bf16 v[80:95], v[52:55], v[200:203], v[80:95]
    ds_read_b64_tr_b16 v[60:61], v13 offset:6144
    ds_read_b64_tr_b16 v[62:63], v13 offset:6656
    s_waitcnt lgkmcnt(0)
    v_mfma_f32_32x32x16_bf16 v[64:79], v[56:59], v[204:207], v[64:79]
    s_barrier
    ds_read_b64_tr_b16 v[48:49], v12 offset:24576
    ds_read_b64_tr_b16 v[50:51], v12 offset:25088
    ds_read_b128 v[208:211], v8 offset:24576
    v_mfma_f32_32x32x16_bf16 v[80:95], v[60:63], v[204:207], v[80:95]
    ds_read_b64_tr_b16 v[52:53], v13 offset:24576
    ds_read_b64_tr_b16 v[54:55], v13 offset:25088
    s_waitcnt lgkmcnt(2)
    v_mfma_f32_32x32x16_bf16 v[64:79], v[48:51], v[208:211], v[64:79]
    ds_read_b64_tr_b16 v[56:57], v12 offset:26624
    ds_read_b64_tr_b16 v[58:59], v12 offset:27136
    ds_read_b128 v[212:215], v9 offset:24576
    s_waitcnt lgkmcnt(3)
    v_mfma_f32_32x32x16_bf16 v[80:95], v[52:55], v[208:211], v[80:95]
    ds_read_b64_tr_b16 v[60:61], v13 offset:26624
    ds_read_b64_tr_b16 v[62:63], v13 offset:27136
    s_waitcnt lgkmcnt(2)
    v_mfma_f32_32x32x16_bf16 v[64:79], v[56:59], v[212:215], v[64:79]
    ds_read_b64_tr_b16 v[48:49], v12 offset:28672
    ds_read_b64_tr_b16 v[50:51], v12 offset:29184
    ds_read_b128 v[216:219], v10 offset:24576
    s_waitcnt lgkmcnt(3)
    v_mfma_f32_32x32x16_bf16 v[80:95], v[60:63], v[212:215], v[80:95]
    ds_read_b64_tr_b16 v[52:53], v13 offset:28672
    ds_read_b64_tr_b16 v[54:55], v13 offset:29184
    s_waitcnt lgkmcnt(2)
    v_mfma_f32_32x32x16_bf16 v[64:79], v[48:51], v[216:219], v[64:79]
    ds_read_b64_tr_b16 v[56:57], v12 offset:30720
    ds_read_b64_tr_b16 v[58:59], v12 offset:31232
    ds_read_b128 v[220:223], v11 offset:24576
    s_waitcnt lgkmcnt(3)
    v_mfma_f32_32x32x16_bf16 v[80:95], v[52:55], v[216:219], v[80:95]
    ds_read_b64_tr_b16 v[60:61], v13 offset:30720
    ds_read_b64_tr_b16 v[62:63], v13 offset:31232
    s_waitcnt lgkmcnt(0)
    v_mfma_f32_32x32x16_bf16 v[64:79], v[56:59], v[220:223], v[64:79]
    s_barrier
    ds_read_b64_tr_b16 v[48:49], v12 offset:49152
    ds_read_b64_tr_b16 v[50:51], v12 offset:49664
    ds_read_b128 v[224:227], v8 offset:49152
    v_mfma_f32_32x32x16_bf16 v[80:95], v[60:63], v[220:223], v[80:95]
    ds_read_b64_tr_b16 v[52:53], v13 offset:49152
    ds_read_b64_tr_b16 v[54:55], v13 offset:49664
    s_call_b64 s[58:59], p1_15
    s_waitcnt lgkmcnt(2)
    v_mfma_f32_32x32x16_bf16 v[64:79], v[48:51], v[224:227], v[64:79]
    ds_read_b64_tr_b16 v[56:57], v12 offset:51200
    ds_read_b64_tr_b16 v[58:59], v12 offset:51712
    ds_read_b128 v[228:231], v9 offset:49152
    s_waitcnt lgkmcnt(3)
    v_mfma_f32_32x32x16_bf16 v[80:95], v[52:55], v[224:227], v[80:95]
    ds_read_b64_tr_b16 v[60:61], v13 offset:51200
    ds_read_b64_tr_b16 v[62:63], v13 offset:51712
    s_waitcnt lgkmcnt(2)
    v_mfma_f32_32x32x16_bf16 v[64:79], v[56:59], v[228:231], v[64:79]
    ds_read_b64_tr_b16 v[48:49], v12 offset:53248
    ds_read_b64_tr_b16 v[50:51], v12 offset:53760
    ds_read_b128 v[232:235], v10 offset:49152
    s_waitcnt lgkmcnt(3)
    v_mfma_f32_32x32x16_bf16 v[80:95], v[60:63], v[228:231], v[80:95]
    ds_read_b64_tr_b16 v[52:53], v13 offset:53248
    ds_read_b64_tr_b16 v[54:55], v13 offset:53760
    s_waitcnt lgkmcnt(2)
    v_mfma_f32_32x32x16_bf16 v[64:79], v[48:51], v[232:235], v[64:79]
    ds_read_b64_tr_b16 v[56:57], v12 offset:55296
    ds_read_b64_tr_b16 v[58:59], v12 offset:55808
    ds_read_b128 v[236:239], v11 offset:49152
    s_waitcnt lgkmcnt(3)
    v_mfma_f32_32x32x16_bf16 v[80:95], v[52:55], v[232:235], v[80:95]
    ds_read_b64_tr_b16 v[60:61], v13 offset:55296
    ds_read_b64_tr_b16 v[62:63], v13 offset:55808
    s_waitcnt lgkmcnt(0)
    v_mfma_f32_32x32x16_bf16 v[64:79], v[56:59], v[236:239], v[64:79]
    s_barrier
    ds_read_b64_tr_b16 v[48:49], v12 offset:0
    ds_read_b64_tr_b16 v[50:51], v12 offset:512
    ds_read_b128 v[240:243], v8 offset:0
    v_mfma_f32_32x32x16_bf16 v[80:95], v[60:63], v[236:239], v[80:95]
    ds_read_b64_tr_b16 v[52:53], v13 offset:0
    ds_read_b64_tr_b16 v[54:55], v13 offset:512
    s_waitcnt lgkmcnt(2)
    v_mfma_f32_32x32x16_bf16 v[64:79], v[48:51], v[240:243], v[64:79]
    ds_read_b64_tr_b16 v[56:57], v12 offset:2048
    ds_read_b64_tr_b16 v[58:59], v12 offset:2560
    ds_read_b128 v[244:247], v9 offset:0
    s_waitcnt lgkmcnt(3)
    v_mfma_f32_32x32x16_bf16 v[80:95], v[52:55], v[240:243], v[80:95]
    ds_read_b64_tr_b16 v[60:61], v13 offset:2048
    ds_read_b64_tr_b16 v[62:63], v13 offset:2560
    s_waitcnt lgkmcnt(2)
    v_mfma_f32_32x32x16_bf16 v[64:79], v[56:59], v[244:247], v[64:79]
    ds_read_b64_tr_b16 v[48:49], v12 offset:4096
    ds_read_b64_tr_b16 v[50:51], v12 offset:4608
    ds_read_b128 v[248:251], v10 offset:0
    s_waitcnt lgkmcnt(3)
    v_mfma_f32_32x32x16_bf16 v[80:95], v[60:63], v[244:247], v[80:95]
    ds_read_b64_tr_b16 v[52:53], v13 offset:4096
    ds_read_b64_tr_b16 v[54:55], v13 offset:4608
    s_waitcnt lgkmcnt(2)
    v_mfma_f32_32x32x16_bf16 v[64:79], v[48:51], v[248:251], v[64:79]
    ds_read_b64_tr_b16 v[56:57], v12 offset:6144
    ds_read_b64_tr_b16 v[58:59], v12 offset:6656
    ds_read_b128 v[252:255], v11 offset:0
    s_waitcnt lgkmcnt(3)
    v_mfma_f32_32x32x16_bf16 v[80:95], v[52:55], v[248:251], v[80:95]
    ds_read_b64_tr_b16 v[60:61], v13 offset:6144
    ds_read_b64_tr_b16 v[62:63], v13 offset:6656
    v_lshlrev_b32 v7, 2, v1
    v_add_u32 v7, 157696, v7
    s_waitcnt lgkmcnt(0)
    v_mfma_f32_32x32x16_bf16 v[64:79], v[56:59], v[252:255], v[64:79]
    s_barrier
    v_mfma_f32_32x32x16_bf16 v[80:95], v[60:63], v[252:255], v[80:95]
    ds_read_b32 v44, v7 offset:0
    ds_read_b32 v45, v7 offset:256
    ds_read_b32 v46, v7 offset:512
    ds_read_b32 v47, v7 offset:768
    s_waitcnt vmcnt(0)
    v_cvt_pk_bf16_f32 v2, v18, v18
    v_and_b32 v21, 0xffff0000, v2
    v_sub_f32 v21, v18, v21
    v_cvt_pk_bf16_f32 v21, v21, v21
    v_mov_b32 v20, v2
    v_lshrrev_b32 v3, 1, v14
    v_add_u32 v3, v3, v34
    v_mov_b32 v22, v20
    v_mov_b32 v23, v21
    s_mov_b32 exec_hi, 0
    ds_write_b32 v3, v19
    v_mov_b32 v22, 0
    v_mov_b32 v23, 0
    s_not_b64 exec, exec
    v_mov_b32 v20, 0
    v_mov_b32 v21, 0
    s_mov_b64 exec, -1
    v_add_u32 v12, 57344, v12
    v_add_u32 v13, 57344, v13
    s_waitcnt lgkmcnt(1)
    v_add_f32 v44, v44, v45
    v_add_f32 v46, v46, v47
    v_add_f32 v44, v44, v46
    v_cvt_pk_bf16_f32 v2, v44, v44
    v_and_b32 v25, 0xffff0000, v2
    v_sub_f32 v25, v44, v25
    v_cvt_pk_bf16_f32 v24, v44, v25
    v_mov_b32 v25, v24
    v_mul_f32 v4, s42, v19
    s_nop 0
    v_mfma_f32_32x32x8_bf16 v[64:79], v[24:25], v[20:21], v[64:79]
    v_mfma_f32_32x32x8_bf16 v[80:95], v[24:25], v[22:23], v[80:95]
    s_nop 7
    s_nop 1
    s_waitcnt lgkmcnt(0)
    v_pk_mul_f32 v[64:65], v[64:65], v[4:5] op_sel_hi:[1,0]
    v_pk_mul_f32 v[66:67], v[66:67], v[4:5] op_sel_hi:[1,0]
    v_pk_mul_f32 v[68:69], v[68:69], v[4:5] op_sel_hi:[1,0]
    v_pk_mul_f32 v[70:71], v[70:71], v[4:5] op_sel_hi:[1,0]
    v_pk_mul_f32 v[72:73], v[72:73], v[4:5] op_sel_hi:[1,0]
    v_pk_mul_f32 v[74:75], v[74:75], v[4:5] op_sel_hi:[1,0]
    v_pk_mul_f32 v[76:77], v[76:77], v[4:5] op_sel_hi:[1,0]
    v_pk_mul_f32 v[78:79], v[78:79], v[4:5] op_sel_hi:[1,0]
    v_cvt_pk_bf16_f32 v64, v64, v65
    v_cvt_pk_bf16_f32 v65, v66, v67
    v_cvt_pk_bf16_f32 v66, v68, v69
    v_cvt_pk_bf16_f32 v67, v70, v71
    v_cvt_pk_bf16_f32 v68, v72, v73
    v_cvt_pk_bf16_f32 v69, v74, v75
    v_cvt_pk_bf16_f32 v70, v76, v77
    v_cvt_pk_bf16_f32 v71, v78, v79
    v_permlane32_swap_b32 v64, v66
    v_permlane32_swap_b32 v65, v67
    s_nop 0
    v_permlane32_swap_b32 v68, v70
    v_permlane32_swap_b32 v69, v71
    s_mov_b64 exec, s[76:77]
    buffer_store_dwordx4 v[64:67], v26, s[32:35], s43 offen sc1
    s_mov_b64 exec, s[78:79]
    buffer_store_dwordx4 v[68:71], v27, s[32:35], s43 offen sc1
    s_mov_b64 exec, -1
    v_pk_mul_f32 v[80:81], v[80:81], v[4:5] op_sel_hi:[1,0]
    v_pk_mul_f32 v[82:83], v[82:83], v[4:5] op_sel_hi:[1,0]
    v_pk_mul_f32 v[84:85], v[84:85], v[4:5] op_sel_hi:[1,0]
    v_pk_mul_f32 v[86:87], v[86:87], v[4:5] op_sel_hi:[1,0]
    v_pk_mul_f32 v[88:89], v[88:89], v[4:5] op_sel_hi:[1,0]
    v_pk_mul_f32 v[90:91], v[90:91], v[4:5] op_sel_hi:[1,0]
    v_pk_mul_f32 v[92:93], v[92:93], v[4:5] op_sel_hi:[1,0]
    v_pk_mul_f32 v[94:95], v[94:95], v[4:5] op_sel_hi:[1,0]
    v_cvt_pk_bf16_f32 v80, v80, v81
    v_cvt_pk_bf16_f32 v81, v82, v83
    v_cvt_pk_bf16_f32 v82, v84, v85
    v_cvt_pk_bf16_f32 v83, v86, v87
    v_cvt_pk_bf16_f32 v84, v88, v89
    v_cvt_pk_bf16_f32 v85, v90, v91
    v_cvt_pk_bf16_f32 v86, v92, v93
    v_cvt_pk_bf16_f32 v87, v94, v95
    v_permlane32_swap_b32 v80, v82
    v_permlane32_swap_b32 v81, v83
    s_nop 0
    v_permlane32_swap_b32 v84, v86
    v_permlane32_swap_b32 v85, v87
    s_mov_b64 exec, s[80:81]
    buffer_store_dwordx4 v[80:83], v28, s[32:35], s43 offen sc1
    s_mov_b64 exec, s[82:83]
    buffer_store_dwordx4 v[84:87], v29, s[32:35], s43 offen sc1
    s_mov_b64 exec, -1
    s_not_b64 exec, s[76:77]
    s_cbranch_execz p1n_20
    v_sub_u32 v6, v26, v14
    buffer_store_dwordx2 v[64:65], v6, s[32:35], s43 offen sc1
    buffer_store_dwordx2 v[66:67], v6, s[32:35], s57 offen sc1
p1n_20:
    s_not_b64 exec, s[78:79]
    s_cbranch_execz p1n_21
    v_sub_u32 v6, v27, v14
    buffer_store_dwordx2 v[68:69], v6, s[32:35], s43 offen sc1
    buffer_store_dwordx2 v[70:71], v6, s[32:35], s57 offen sc1
p1n_21:
    s_not_b64 exec, s[80:81]
    s_cbranch_execz p1n_22
    v_sub_u32 v6, v28, v14
    buffer_store_dwordx2 v[80:81], v6, s[32:35], s43 offen sc1
    buffer_store_dwordx2 v[82:83], v6, s[32:35], s57 offen sc1
p1n_22:
    s_not_b64 exec, s[82:83]
    s_cbranch_execz p1n_23
    v_sub_u32 v6, v29, v14
    buffer_store_dwordx2 v[84:85], v6, s[32:35], s43 offen sc1
    buffer_store_dwordx2 v[86:87], v6, s[32:35], s57 offen sc1
p1n_23:
    s_mov_b64 exec, -1
    s_cmp_ge_u32 s22, 8
    s_cbranch_scc1 p1_17
    ds_read_b64_tr_b16 v[48:49], v12 offset:0
    ds_read_b64_tr_b16 v[50:51], v12 offset:512
    ds_read_b64_tr_b16 v[52:53], v13 offset:0
    ds_read_b64_tr_b16 v[54:55], v13 offset:512
    ds_read_b64_tr_b16 v[56:57], v12 offset:2048
    ds_read_b64_tr_b16 v[58:59], v12 offset:2560
    ds_read_b64_tr_b16 v[60:61], v13 offset:2048
    ds_read_b64_tr_b16 v[62:63], v13 offset:2560
    s_waitcnt lgkmcnt(4)
    v_mfma_f32_32x32x16_bf16 v[64:79], v[48:51], v[96:99], 0
    s_barrier
    ds_read_b64_tr_b16 v[36:37], v12 offset:4096
    ds_read_b64_tr_b16 v[38:39], v12 offset:4608
    v_mfma_f32_32x32x16_bf16 v[80:95], v[52:55], v[96:99], 0
    ds_read_b64_tr_b16 v[40:41], v13 offset:4096
    ds_read_b64_tr_b16 v[42:43], v13 offset:4608
    s_waitcnt lgkmcnt(4)
    v_mfma_f32_32x32x16_bf16 v[64:79], v[56:59], v[100:103], v[64:79]
    ds_read_b64_tr_b16 v[48:49], v12 offset:6144
    ds_read_b64_tr_b16 v[50:51], v12 offset:6656
    v_mfma_f32_32x32x16_bf16 v[80:95], v[60:63], v[100:103], v[80:95]
    ds_read_b64_tr_b16 v[52:53], v13 offset:6144
    ds_read_b64_tr_b16 v[54:55], v13 offset:6656
    s_waitcnt lgkmcnt(4)
    v_mfma_f32_32x32x16_bf16 v[64:79], v[36:39], v[104:107], v[64:79]
    ds_read_b64_tr_b16 v[56:57], v12 offset:8192
    ds_read_b64_tr_b16 v[58:59], v12 offset:8704
    v_mfma_f32_32x32x16_bf16 v[80:95], v[40:43], v[104:107], v[80:95]
    ds_read_b64_tr_b16 v[60:61], v13 offset:8192
    ds_read_b64_tr_b16 v[62:63], v13 offset:8704
    s_waitcnt lgkmcnt(4)
    v_mfma_f32_32x32x16_bf16 v[64:79], v[48:51], v[108:111], v[64:79]
    ds_read_b64_tr_b16 v[36:37], v12 offset:10240
    ds_read_b64_tr_b16 v[38:39], v12 offset:10752
    v_mfma_f32_32x32x16_bf16 v[80:95], v[52:55], v[108:111], v[80:95]
    ds_read_b64_tr_b16 v[40:41], v13 offset:10240
    ds_read_b64_tr_b16 v[42:43], v13 offset:10752
    s_waitcnt lgkmcnt(4)
    v_mfma_f32_32x32x16_bf16 v[64:79], v[56:59], v[112:115], v[64:79]
    ds_read_b64_tr_b16 v[48:49], v12 offset:12288
    ds_read_b64_tr_b16 v[50:51], v12 offset:12800
    v_mfma_f32_32x32x16_bf16 v[80:95], v[60:63], v[112:115], v[80:95]
    ds_read_b64_tr_b16 v[52:53], v13 offset:12288
    ds_read_b64_tr_b16 v[54:55], v13 offset:12800
    s_waitcnt lgkmcnt(4)
    v_mfma_f32_32x32x16_bf16 v[64:79], v[36:39], v[116:119], v[64:79]
    ds_read_b64_tr_b16 v[56:57], v12 offset:14336
    ds_read_b64_tr_b16 v[58:59], v12 offset:14848
    v_mfma_f32_32x32x16_bf16 v[80:95], v[40:43], v[116:119], v[80:95]
    ds_read_b64_tr_b16 v[60:61], v13 offset:14336
    ds_read_b64_tr_b16 v[62:63], v13 offset:14848
    s_waitcnt lgkmcnt(4)
    v_mfma_f32_32x32x16_bf16 v[64:79], v[48:51], v[120:123], v[64:79]
    ds_read_b64_tr_b16 v[36:37], v12 offset:16384
    ds_read_b64_tr_b16 v[38:39], v12 offset:16896
    v_mfma_f32_32x32x16_bf16 v[80:95], v[52:55], v[120:123], v[80:95]
    ds_read_b64_tr_b16 v[40:41], v13 offset:16384
    ds_read_b64_tr_b16 v[42:43], v13 offset:16896
    s_waitcnt lgkmcnt(4)
    v_mfma_f32_32x32x16_bf16 v[64:79], v[56:59], v[124:127], v[64:79]
    ds_read_b64_tr_b16 v[48:49], v12 offset:18432
    ds_read_b64_tr_b16 v[50:51], v12 offset:18944
    v_mfma_f32_32x32x16_bf16 v[80:95], v[60:63], v[124:127], v[80:95]
    ds_read_b64_tr_b16 v[52:53], v13 offset:18432
    ds_read_b64_tr_b16 v[54:55], v13 offset:18944
    s_waitcnt lgkmcnt(4)
    v_mfma_f32_32x32x16_bf16 v[64:79], v[36:39], v[128:131], v[64:79]
    ds_read_b64_tr_b16 v[56:57], v12 offset:20480
    ds_read_b64_tr_b16 v[58:59], v12 offset:20992
    v_mfma_f32_32x32x16_bf16 v[80:95], v[40:43], v[128:131], v[80:95]
    ds_read_b64_tr_b16 v[60:61], v13 offset:20480
    ds_read_b64_tr_b16 v[62:63], v13 offset:20992
    s_waitcnt lgkmcnt(4)
    v_mfma_f32_32x32x16_bf16 v[64:79], v[48:51], v[132:135], v[64:79]
    ds_read_b64_tr_b16 v[36:37], v12 offset:22528
    ds_read_b64_tr_b16 v[38:39], v12 offset:23040
    v_mfma_f32_32x32x16_bf16 v[80:95], v[52:55], v[132:135], v[80:95]
    ds_read_b64_tr_b16 v[40:41], v13 offset:22528
    ds_read_b64_tr_b16 v[42:43], v13 offset:23040
    s_waitcnt lgkmcnt(4)
    v_mfma_f32_32x32x16_bf16 v[64:79], v[56:59], v[136:139], v[64:79]
    ds_read_b64_tr_b16 v[48:49], v12 offset:24576
    ds_read_b64_tr_b16 v[50:51], v12 offset:25088
    v_mfma_f32_32x32x16_bf16 v[80:95], v[60:63], v[136:139], v[80:95]
    ds_read_b64_tr_b16 v[52:53], v13 offset:24576
    ds_read_b64_tr_b16 v[54:55], v13 offset:25088
    s_waitcnt lgkmcnt(4)
    v_mfma_f32_32x32x16_bf16 v[64:79], v[36:39], v[140:143], v[64:79]
    ds_read_b64_tr_b16 v[56:57], v12 offset:26624
    ds_read_b64_tr_b16 v[58:59], v12 offset:27136
    v_mfma_f32_32x32x16_bf16 v[80:95], v[40:43], v[140:143], v[80:95]
    ds_read_b64_tr_b16 v[60:61], v13 offset:26624
    ds_read_b64_tr_b16 v[62:63], v13 offset:27136
    s_waitcnt lgkmcnt(4)
    v_mfma_f32_32x32x16_bf16 v[64:79], v[48:51], v[144:147], v[64:79]
    ds_read_b64_tr_b16 v[36:37], v12 offset:28672
    ds_read_b64_tr_b16 v[38:39], v12 offset:29184
    v_mfma_f32_32x32x16_bf16 v[80:95], v[52:55], v[144:147], v[80:95]
    ds_read_b64_tr_b16 v[40:41], v13 offset:28672
    ds_read_b64_tr_b16 v[42:43], v13 offset:29184
    s_waitcnt lgkmcnt(4)
    v_mfma_f32_32x32x16_bf16 v[64:79], v[56:59], v[148:151], v[64:79]
    ds_read_b64_tr_b16 v[48:49], v12 offset:30720
    ds_read_b64_tr_b16 v[50:51], v12 offset:31232
    v_mfma_f32_32x32x16_bf16 v[80:95], v[60:63], v[148:151], v[80:95]
    ds_read_b64_tr_b16 v[52:53], v13 offset:30720
    ds_read_b64_tr_b16 v[54:55], v13 offset:31232
    s_waitcnt lgkmcnt(4)
    v_mfma_f32_32x32x16_bf16 v[64:79], v[36:39], v[152:155], v[64:79]
    ds_read_b64_tr_b16 v[56:57], v12 offset:32768
    ds_read_b64_tr_b16 v[58:59], v12 offset:33280
    v_mfma_f32_32x32x16_bf16 v[80:95], v[40:43], v[152:155], v[80:95]
    ds_read_b64_tr_b16 v[60:61], v13 offset:32768
    ds_read_b64_tr_b16 v[62:63], v13 offset:33280
    s_waitcnt lgkmcnt(4) vmcnt(0)
    v_mfma_f32_32x32x16_bf16 v[64:79], v[48:51], v[156:159], v[64:79]
    s_barrier
    ds_read_b64_tr_b16 v[36:37], v12 offset:34816
    ds_read_b64_tr_b16 v[38:39], v12 offset:35328
    v_mfma_f32_32x32x16_bf16 v[80:95], v[52:55], v[156:159], v[80:95]
    ds_read_b64_tr_b16 v[40:41], v13 offset:34816
    ds_read_b64_tr_b16 v[42:43], v13 offset:35328
    s_waitcnt lgkmcnt(4)
    v_mfma_f32_32x32x16_bf16 v[64:79], v[56:59], v[160:163], v[64:79]
    ds_read_b64_tr_b16 v[48:49], v12 offset:36864
    ds_read_b64_tr_b16 v[50:51], v12 offset:37376
    v_mfma_f32_32x32x16_bf16 v[80:95], v[60:63], v[160:163], v[80:95]
    ds_read_b64_tr_b16 v[52:53], v13 offset:36864
    ds_read_b64_tr_b16 v[54:55], v13 offset:37376
    s_waitcnt lgkmcnt(4)
    v_mfma_f32_32x32x16_bf16 v[64:79], v[36:39], v[164:167], v[64:79]
    ds_read_b64_tr_b16 v[56:57], v12 offset:38912
    ds_read_b64_tr_b16 v[58:59], v12 offset:39424
    v_mfma_f32_32x32x16_bf16 v[80:95], v[40:43], v[164:167], v[80:95]
    ds_read_b64_tr_b16 v[60:61], v13 offset:38912
    ds_read_b64_tr_b16 v[62:63], v13 offset:39424
    s_waitcnt lgkmcnt(4)
    v_mfma_f32_32x32x16_bf16 v[64:79], v[48:51], v[168:171], v[64:79]
    v_add_u32 v12, 40960, v12
    ds_read_b64_tr_b16 v[36:37], v12 offset:0
    ds_read_b64_tr_b16 v[38:39], v12 offset:512
    v_mfma_f32_32x32x16_bf16 v[80:95], v[52:55], v[168:171], v[80:95]
    v_add_u32 v13, 40960, v13
    ds_read_b64_tr_b16 v[40:41], v13 offset:0
    ds_read_b64_tr_b16 v[42:43], v13 offset:512
    s_waitcnt lgkmcnt(4)
    v_mfma_f32_32x32x16_bf16 v[64:79], v[56:59], v[172:175], v[64:79]
    ds_read_b64_tr_b16 v[48:49], v12 offset:2048
    ds_read_b64_tr_b16 v[50:51], v12 offset:2560
    v_mfma_f32_32x32x16_bf16 v[80:95], v[60:63], v[172:175], v[80:95]
    ds_read_b64_tr_b16 v[52:53], v13 offset:2048
    ds_read_b64_tr_b16 v[54:55], v13 offset:2560
    s_waitcnt lgkmcnt(4)
    v_mfma_f32_32x32x16_bf16 v[64:79], v[36:39], v[176:179], v[64:79]
    ds_read_b64_tr_b16 v[56:57], v12 offset:4096
    ds_read_b64_tr_b16 v[58:59], v12 offset:4608
    v_mfma_f32_32x32x16_bf16 v[80:95], v[40:43], v[176:179], v[80:95]
    ds_read_b64_tr_b16 v[60:61], v13 offset:4096
    ds_read_b64_tr_b16 v[62:63], v13 offset:4608
    s_waitcnt lgkmcnt(4)
    v_mfma_f32_32x32x16_bf16 v[64:79], v[48:51], v[180:183], v[64:79]
    ds_read_b64_tr_b16 v[36:37], v12 offset:6144
    ds_read_b64_tr_b16 v[38:39], v12 offset:6656
    v_mfma_f32_32x32x16_bf16 v[80:95], v[52:55], v[180:183], v[80:95]
    ds_read_b64_tr_b16 v[40:41], v13 offset:6144
    ds_read_b64_tr_b16 v[42:43], v13 offset:6656
    s_waitcnt lgkmcnt(4)
    v_mfma_f32_32x32x16_bf16 v[64:79], v[56:59], v[184:187], v[64:79]
    ds_read_b64_tr_b16 v[48:49], v12 offset:8192
    ds_read_b64_tr_b16 v[50:51], v12 offset:8704
    v_mfma_f32_32x32x16_bf16 v[80:95], v[60:63], v[184:187], v[80:95]
    ds_read_b64_tr_b16 v[52:53], v13 offset:8192
    ds_read_b64_tr_b16 v[54:55], v13 offset:8704
    s_waitcnt lgkmcnt(4)
    v_mfma_f32_32x32x16_bf16 v[64:79], v[36:39], v[188:191], v[64:79]
    ds_read_b64_tr_b16 v[56:57], v12 offset:10240
    ds_read_b64_tr_b16 v[58:59], v12 offset:10752
    v_mfma_f32_32x32x16_bf16 v[80:95], v[40:43], v[188:191], v[80:95]
    ds_read_b64_tr_b16 v[60:61], v13 offset:10240
    ds_read_b64_tr_b16 v[62:63], v13 offset:10752
    s_waitcnt lgkmcnt(4)
    v_mfma_f32_32x32x16_bf16 v[64:79], v[48:51], v[192:195], v[64:79]
    ds_read_b64_tr_b16 v[36:37], v12 offset:12288
    ds_read_b64_tr_b16 v[38:39], v12 offset:12800
    v_mfma_f32_32x32x16_bf16 v[80:95], v[52:55], v[192:195], v[80:95]
    ds_read_b64_tr_b16 v[40:41], v13 offset:12288
    ds_read_b64_tr_b16 v[42:43], v13 offset:12800
    s_waitcnt lgkmcnt(4)
    v_mfma_f32_32x32x16_bf16 v[64:79], v[56:59], v[196:199], v[64:79]
    ds_read_b64_tr_b16 v[48:49], v12 offset:14336
    ds_read_b64_tr_b16 v[50:51], v12 offset:14848
    v_mfma_f32_32x32x16_bf16 v[80:95], v[60:63], v[196:199], v[80:95]
    ds_read_b64_tr_b16 v[52:53], v13 offset:14336
    ds_read_b64_tr_b16 v[54:55], v13 offset:14848
    s_waitcnt lgkmcnt(4)
    v_mfma_f32_32x32x16_bf16 v[64:79], v[36:39], v[200:203], v[64:79]
    ds_read_b64_tr_b16 v[56:57], v12 offset:16384
    ds_read_b64_tr_b16 v[58:59], v12 offset:16896
    v_mfma_f32_32x32x16_bf16 v[80:95], v[40:43], v[200:203], v[80:95]
    ds_read_b64_tr_b16 v[60:61], v13 offset:16384
    ds_read_b64_tr_b16 v[62:63], v13 offset:16896
    s_waitcnt lgkmcnt(4)
    v_mfma_f32_32x32x16_bf16 v[64:79], v[48:51], v[204:207], v[64:79]
    ds_read_b64_tr_b16 v[36:37], v12 offset:18432
    ds_read_b64_tr_b16 v[38:39], v12 offset:18944
    v_mfma_f32_32x32x16_bf16 v[80:95], v[52:55], v[204:207], v[80:95]
    ds_read_b64_tr_b16 v[40:41], v13 offset:18432
    ds_read_b64_tr_b16 v[42:43], v13 offset:18944
    s_waitcnt lgkmcnt(4)
    v_mfma_f32_32x32x16_bf16 v[64:79], v[56:59], v[208:211], v[64:79]
    ds_read_b64_tr_b16 v[48:49], v12 offset:20480
    ds_read_b64_tr_b16 v[50:51], v12 offset:20992
    v_mfma_f32_32x32x16_bf16 v[80:95], v[60:63], v[208:211], v[80:95]
    ds_read_b64_tr_b16 v[52:53], v13 offset:20480
    ds_read_b64_tr_b16 v[54:55], v13 offset:20992
    s_waitcnt lgkmcnt(4)
    v_mfma_f32_32x32x16_bf16 v[64:79], v[36:39], v[212:215], v[64:79]
    ds_read_b64_tr_b16 v[56:57], v12 offset:22528
    ds_read_b64_tr_b16 v[58:59], v12 offset:23040
    v_mfma_f32_32x32x16_bf16 v[80:95], v[40:43], v[212:215], v[80:95]
    ds_read_b64_tr_b16 v[60:61], v13 offset:22528
    ds_read_b64_tr_b16 v[62:63], v13 offset:23040
    s_waitcnt lgkmcnt(4)
    v_mfma_f32_32x32x16_bf16 v[64:79], v[48:51], v[216:219], v[64:79]
    ds_read_b64_tr_b16 v[36:37], v12 offset:24576
    ds_read_b64_tr_b16 v[38:39], v12 offset:25088
    v_mfma_f32_32x32x16_bf16 v[80:95], v[52:55], v[216:219], v[80:95]
    ds_read_b64_tr_b16 v[40:41], v13 offset:24576
    ds_read_b64_tr_b16 v[42:43], v13 offset:25088
    s_waitcnt lgkmcnt(4)
    v_mfma_f32_32x32x16_bf16 v[64:79], v[56:59], v[220:223], v[64:79]
    ds_read_b64_tr_b16 v[48:49], v12 offset:26624
    ds_read_b64_tr_b16 v[50:51], v12 offset:27136
    v_mfma_f32_32x32x16_bf16 v[80:95], v[60:63], v[220:223], v[80:95]
    ds_read_b64_tr_b16 v[52:53], v13 offset:26624
    ds_read_b64_tr_b16 v[54:55], v13 offset:27136
    s_waitcnt lgkmcnt(4)
    v_mfma_f32_32x32x16_bf16 v[64:79], v[36:39], v[224:227], v[64:79]
    ds_read_b64_tr_b16 v[56:57], v12 offset:28672
    ds_read_b64_tr_b16 v[58:59], v12 offset:29184
    v_mfma_f32_32x32x16_bf16 v[80:95], v[40:43], v[224:227], v[80:95]
    ds_read_b64_tr_b16 v[60:61], v13 offset:28672
    ds_read_b64_tr_b16 v[62:63], v13 offset:29184
    s_waitcnt lgkmcnt(4)
    v_mfma_f32_32x32x16_bf16 v[64:79], v[48:51], v[228:231], v[64:79]
    ds_read_b64_tr_b16 v[36:37], v12 offset:30720
    ds_read_b64_tr_b16 v[38:39], v12 offset:31232
    v_mfma_f32_32x32x16_bf16 v[80:95], v[52:55], v[228:231], v[80:95]
    ds_read_b64_tr_b16 v[40:41], v13 offset:30720
    ds_read_b64_tr_b16 v[42:43], v13 offset:31232
    s_waitcnt lgkmcnt(4)
    v_mfma_f32_32x32x16_bf16 v[64:79], v[56:59], v[232:235], v[64:79]
    ds_read_b64_tr_b16 v[48:49], v12 offset:32768
    ds_read_b64_tr_b16 v[50:51], v12 offset:33280
    v_mfma_f32_32x32x16_bf16 v[80:95], v[60:63], v[232:235], v[80:95]
    ds_read_b64_tr_b16 v[52:53], v13 offset:32768
    ds_read_b64_tr_b16 v[54:55], v13 offset:33280
    s_waitcnt lgkmcnt(4)
    v_mfma_f32_32x32x16_bf16 v[64:79], v[36:39], v[236:239], v[64:79]
    ds_read_b64_tr_b16 v[56:57], v12 offset:34816
    ds_read_b64_tr_b16 v[58:59], v12 offset:35328
    v_mfma_f32_32x32x16_bf16 v[80:95], v[40:43], v[236:239], v[80:95]
    ds_read_b64_tr_b16 v[60:61], v13 offset:34816
    ds_read_b64_tr_b16 v[62:63], v13 offset:35328
    s_waitcnt lgkmcnt(4)
    v_mfma_f32_32x32x16_bf16 v[64:79], v[48:51], v[240:243], v[64:79]
    ds_read_b64_tr_b16 v[36:37], v12 offset:36864
    ds_read_b64_tr_b16 v[38:39], v12 offset:37376
    v_mfma_f32_32x32x16_bf16 v[80:95], v[52:55], v[240:243], v[80:95]
    ds_read_b64_tr_b16 v[40:41], v13 offset:36864
    ds_read_b64_tr_b16 v[42:43], v13 offset:37376
    v_lshlrev_b32 v3, 2, v1
    v_add_u32 v3, 155648, v3
    v_mov_b32 v5, 157188
    s_waitcnt lgkmcnt(4)
    v_mfma_f32_32x32x16_bf16 v[64:79], v[56:59], v[244:247], v[64:79]
    ds_read_b64_tr_b16 v[48:49], v12 offset:38912
    ds_read_b64_tr_b16 v[50:51], v12 offset:39424
    v_mfma_f32_32x32x16_bf16 v[80:95], v[60:63], v[244:247], v[80:95]
    ds_read_b64_tr_b16 v[52:53], v13 offset:38912
    ds_read_b64_tr_b16 v[54:55], v13 offset:39424
    s_waitcnt lgkmcnt(4)
    v_mfma_f32_32x32x16_bf16 v[64:79], v[36:39], v[248:251], v[64:79]
    v_mfma_f32_32x32x16_bf16 v[80:95], v[40:43], v[248:251], v[80:95]
    ds_read_b32 v6, v5
    ds_read_b32 v44, v3 offset:0
    ds_read_b32 v45, v3 offset:256
    ds_read_b32 v46, v3 offset:512
    ds_read_b32 v47, v3 offset:768
    s_waitcnt lgkmcnt(0)
    v_mfma_f32_32x32x16_bf16 v[64:79], v[48:51], v[252:255], v[64:79]
    v_mfma_f32_32x32x16_bf16 v[80:95], v[52:55], v[252:255], v[80:95]
    v_cmp_ne_u32 vcc, 4, v6
    s_cbranch_vccz p1s_25
p1s_24:
    ds_read_b32 v6, v5
    ds_read_b32 v44, v3 offset:0
    ds_read_b32 v45, v3 offset:256
    ds_read_b32 v46, v3 offset:512
    ds_read_b32 v47, v3 offset:768
    s_waitcnt lgkmcnt(0)
    v_cmp_ne_u32 vcc, 4, v6
    s_cbranch_vccnz p1s_24
p1s_25:
    v_add_f32 v44, v44, v45
    v_add_f32 v46, v46, v47
    v_add_f32 v44, v44, v46
    v_cvt_pk_bf16_f32 v2, v44, v44
    v_and_b32 v25, 0xffff0000, v2
    v_sub_f32 v25, v44, v25
    v_cvt_pk_bf16_f32 v24, v44, v25
    v_mov_b32 v25, v24
    v_mov_b32 v4, v19
    s_nop 0
    v_mfma_f32_32x32x8_bf16 v[64:79], v[24:25], v[20:21], v[64:79]
    v_mfma_f32_32x32x8_bf16 v[80:95], v[24:25], v[22:23], v[80:95]
    s_nop 7
    s_nop 1
    s_waitcnt lgkmcnt(0)
    v_pk_mul_f32 v[64:65], v[64:65], v[4:5] op_sel_hi:[1,0]
    v_pk_mul_f32 v[66:67], v[66:67], v[4:5] op_sel_hi:[1,0]
    v_pk_mul_f32 v[68:69], v[68:69], v[4:5] op_sel_hi:[1,0]
    v_pk_mul_f32 v[70:71], v[70:71], v[4:5] op_sel_hi:[1,0]
    v_pk_mul_f32 v[72:73], v[72:73], v[4:5] op_sel_hi:[1,0]
    v_pk_mul_f32 v[74:75], v[74:75], v[4:5] op_sel_hi:[1,0]
    v_pk_mul_f32 v[76:77], v[76:77], v[4:5] op_sel_hi:[1,0]
    v_pk_mul_f32 v[78:79], v[78:79], v[4:5] op_sel_hi:[1,0]
    v_cvt_pk_bf16_f32 v64, v64, v65
    v_cvt_pk_bf16_f32 v65, v66, v67
    v_cvt_pk_bf16_f32 v66, v68, v69
    v_cvt_pk_bf16_f32 v67, v70, v71
    v_cvt_pk_bf16_f32 v68, v72, v73
    v_cvt_pk_bf16_f32 v69, v74, v75
    v_cvt_pk_bf16_f32 v70, v76, v77
    v_cvt_pk_bf16_f32 v71, v78, v79
    v_permlane32_swap_b32 v64, v66
    v_permlane32_swap_b32 v65, v67
    s_nop 0
    v_permlane32_swap_b32 v68, v70
    v_permlane32_swap_b32 v69, v71
    s_mov_b64 exec, s[48:49]
    buffer_store_dwordx4 v[64:67], v30, s[32:35], s96 offen sc1
    s_mov_b64 exec, s[50:51]
    buffer_store_dwordx4 v[68:71], v31, s[32:35], s96 offen sc1
    s_mov_b64 exec, -1
    v_pk_mul_f32 v[80:81], v[80:81], v[4:5] op_sel_hi:[1,0]
    v_pk_mul_f32 v[82:83], v[82:83], v[4:5] op_sel_hi:[1,0]
    v_pk_mul_f32 v[84:85], v[84:85], v[4:5] op_sel_hi:[1,0]
    v_pk_mul_f32 v[86:87], v[86:87], v[4:5] op_sel_hi:[1,0]
    v_pk_mul_f32 v[88:89], v[88:89], v[4:5] op_sel_hi:[1,0]
    v_pk_mul_f32 v[90:91], v[90:91], v[4:5] op_sel_hi:[1,0]
    v_pk_mul_f32 v[92:93], v[92:93], v[4:5] op_sel_hi:[1,0]
    v_pk_mul_f32 v[94:95], v[94:95], v[4:5] op_sel_hi:[1,0]
    v_cvt_pk_bf16_f32 v80, v80, v81
    v_cvt_pk_bf16_f32 v81, v82, v83
    v_cvt_pk_bf16_f32 v82, v84, v85
    v_cvt_pk_bf16_f32 v83, v86, v87
    v_cvt_pk_bf16_f32 v84, v88, v89
    v_cvt_pk_bf16_f32 v85, v90, v91
    v_cvt_pk_bf16_f32 v86, v92, v93
    v_cvt_pk_bf16_f32 v87, v94, v95
    v_permlane32_swap_b32 v80, v82
    v_permlane32_swap_b32 v81, v83
    s_nop 0
    v_permlane32_swap_b32 v84, v86
    v_permlane32_swap_b32 v85, v87
    s_mov_b64 exec, s[52:53]
    buffer_store_dwordx4 v[80:83], v32, s[32:35], s96 offen sc1
    s_mov_b64 exec, s[54:55]
    buffer_store_dwordx4 v[84:87], v33, s[32:35], s96 offen sc1
    s_mov_b64 exec, -1
    s_not_b64 exec, s[48:49]
    s_cbranch_execz p1n_26
    v_sub_u32 v6, v30, v14
    buffer_store_dwordx2 v[64:65], v6, s[32:35], s96 offen sc1
    buffer_store_dwordx2 v[66:67], v6, s[32:35], s97 offen sc1
p1n_26:
    s_not_b64 exec, s[50:51]
    s_cbranch_execz p1n_27
    v_sub_u32 v6, v31, v14
    buffer_store_dwordx2 v[68:69], v6, s[32:35], s96 offen sc1
    buffer_store_dwordx2 v[70:71], v6, s[32:35], s97 offen sc1
p1n_27:
    s_not_b64 exec, s[52:53]
    s_cbranch_execz p1n_28
    v_sub_u32 v6, v32, v14
    buffer_store_dwordx2 v[80:81], v6, s[32:35], s96 offen sc1
    buffer_store_dwordx2 v[82:83], v6, s[32:35], s97 offen sc1
p1n_28:
    s_not_b64 exec, s[54:55]
    s_cbranch_execz p1n_29
    v_sub_u32 v6, v33, v14
    buffer_store_dwordx2 v[84:85], v6, s[32:35], s96 offen sc1
    buffer_store_dwordx2 v[86:87], v6, s[32:35], s97 offen sc1
p1n_29:
    s_mov_b64 exec, -1
    s_branch p2
p1_16:
    s_waitcnt lgkmcnt(2)
    v_mfma_f32_32x32x16_bf16 v[64:79], v[96:99], v[48:51], 0
    ds_read_b64_tr_b16 v[56:57], v12 offset:2048
    ds_read_b64_tr_b16 v[58:59], v12 offset:2560
    ds_read_b128 v[100:103], v9 offset:0
    s_waitcnt lgkmcnt(3)
    v_mfma_f32_32x32x16_bf16 v[80:95], v[96:99], v[52:55], 0
    ds_read_b64_tr_b16 v[60:61], v13 offset:2048
    ds_read_b64_tr_b16 v[62:63], v13 offset:2560
    s_waitcnt lgkmcnt(2)
    v_mfma_f32_32x32x16_bf16 v[64:79], v[100:103], v[56:59], v[64:79]
    ds_read_b64_tr_b16 v[48:49], v12 offset:4096
    ds_read_b64_tr_b16 v[50:51], v12 offset:4608
    ds_read_b128 v[104:107], v10 offset:0
    s_waitcnt lgkmcnt(3)
    v_mfma_f32_32x32x16_bf16 v[80:95], v[100:103], v[60:63], v[80:95]
    ds_read_b64_tr_b16 v[52:53], v13 offset:4096
    ds_read_b64_tr_b16 v[54:55], v13 offset:4608
    s_waitcnt lgkmcnt(2)
    v_mfma_f32_32x32x16_bf16 v[64:79], v[104:107], v[48:51], v[64:79]
    ds_read_b64_tr_b16 v[56:57], v12 offset:6144
    ds_read_b64_tr_b16 v[58:59], v12 offset:6656
    ds_read_b128 v[108:111], v11 offset:0
    s_waitcnt lgkmcnt(3)
    v_mfma_f32_32x32x16_bf16 v[80:95], v[104:107], v[52:55], v[80:95]
    ds_read_b64_tr_b16 v[60:61], v13 offset:6144
    ds_read_b64_tr_b16 v[62:63], v13 offset:6656
    s_waitcnt lgkmcnt(0)
    v_mfma_f32_32x32x16_bf16 v[64:79], v[108:111], v[56:59], v[64:79]
    s_barrier
    ds_read_b64_tr_b16 v[48:49], v12 offset:24576
    ds_read_b64_tr_b16 v[50:51], v12 offset:25088
    ds_read_b128 v[112:115], v8 offset:24576
    v_mfma_f32_32x32x16_bf16 v[80:95], v[108:111], v[60:63], v[80:95]
    ds_read_b64_tr_b16 v[52:53], v13 offset:24576
    ds_read_b64_tr_b16 v[54:55], v13 offset:25088
    s_waitcnt lgkmcnt(2)
    v_mfma_f32_32x32x16_bf16 v[64:79], v[112:115], v[48:51], v[64:79]
    ds_read_b64_tr_b16 v[56:57], v12 offset:26624
    ds_read_b64_tr_b16 v[58:59], v12 offset:27136
    ds_read_b128 v[116:119], v9 offset:24576
    s_waitcnt lgkmcnt(3)
    v_mfma_f32_32x32x16_bf16 v[80:95], v[112:115], v[52:55], v[80:95]
    ds_read_b64_tr_b16 v[60:61], v13 offset:26624
    ds_read_b64_tr_b16 v[62:63], v13 offset:27136
    s_waitcnt lgkmcnt(2)
    v_mfma_f32_32x32x16_bf16 v[64:79], v[116:119], v[56:59], v[64:79]
    ds_read_b64_tr_b16 v[48:49], v12 offset:28672
    ds_read_b64_tr_b16 v[50:51], v12 offset:29184
    ds_read_b128 v[120:123], v10 offset:24576
    s_waitcnt lgkmcnt(3)
    v_mfma_f32_32x32x16_bf16 v[80:95], v[116:119], v[60:63], v[80:95]
    ds_read_b64_tr_b16 v[52:53], v13 offset:28672
    ds_read_b64_tr_b16 v[54:55], v13 offset:29184
    s_waitcnt lgkmcnt(2)
    v_mfma_f32_32x32x16_bf16 v[64:79], v[120:123], v[48:51], v[64:79]
    ds_read_b64_tr_b16 v[56:57], v12 offset:30720
    ds_read_b64_tr_b16 v[58:59], v12 offset:31232
    ds_read_b128 v[124:127], v11 offset:24576
    s_waitcnt lgkmcnt(3)
    v_mfma_f32_32x32x16_bf16 v[80:95], v[120:123], v[52:55], v[80:95]
    ds_read_b64_tr_b16 v[60:61], v13 offset:30720
    ds_read_b64_tr_b16 v[62:63], v13 offset:31232
    s_waitcnt lgkmcnt(0)
    v_mfma_f32_32x32x16_bf16 v[64:79], v[124:127], v[56:59], v[64:79]
    s_barrier
    ds_read_b64_tr_b16 v[48:49], v12 offset:49152
    ds_read_b64_tr_b16 v[50:51], v12 offset:49664
    ds_read_b128 v[128:131], v8 offset:49152
    v_mfma_f32_32x32x16_bf16 v[80:95], v[124:127], v[60:63], v[80:95]
    ds_read_b64_tr_b16 v[52:53], v13 offset:49152
    ds_read_b64_tr_b16 v[54:55], v13 offset:49664
    s_cmp_lg_u32 s20, 0
    s_cbranch_scc1 p1t_30
    s_call_b64 s[58:59], p1_14
p1t_30:
    s_waitcnt lgkmcnt(2)
    v_mfma_f32_32x32x16_bf16 v[64:79], v[128:131], v[48:51], v[64:79]
    ds_read_b64_tr_b16 v[56:57], v12 offset:51200
    ds_read_b64_tr_b16 v[58:59], v12 offset:51712
    ds_read_b128 v[132:135], v9 offset:49152
    s_waitcnt lgkmcnt(3)
    v_mfma_f32_32x32x16_bf16 v[80:95], v[128:131], v[52:55], v[80:95]
    ds_read_b64_tr_b16 v[60:61], v13 offset:51200
    ds_read_b64_tr_b16 v[62:63], v13 offset:51712
    s_waitcnt lgkmcnt(2)
    v_mfma_f32_32x32x16_bf16 v[64:79], v[132:135], v[56:59], v[64:79]
    ds_read_b64_tr_b16 v[48:49], v12 offset:53248
    ds_read_b64_tr_b16 v[50:51], v12 offset:53760
    ds_read_b128 v[136:139], v10 offset:49152
    s_waitcnt lgkmcnt(3)
    v_mfma_f32_32x32x16_bf16 v[80:95], v[132:135], v[60:63], v[80:95]
    ds_read_b64_tr_b16 v[52:53], v13 offset:53248
    ds_read_b64_tr_b16 v[54:55], v13 offset:53760
    s_waitcnt lgkmcnt(2)
    v_mfma_f32_32x32x16_bf16 v[64:79], v[136:139], v[48:51], v[64:79]
    ds_read_b64_tr_b16 v[56:57], v12 offset:55296
    ds_read_b64_tr_b16 v[58:59], v12 offset:55808
    ds_read_b128 v[140:143], v11 offset:49152
    s_waitcnt lgkmcnt(3)
    v_mfma_f32_32x32x16_bf16 v[80:95], v[136:139], v[52:55], v[80:95]
    ds_read_b64_tr_b16 v[60:61], v13 offset:55296
    ds_read_b64_tr_b16 v[62:63], v13 offset:55808
    s_waitcnt lgkmcnt(0)
    v_mfma_f32_32x32x16_bf16 v[64:79], v[140:143], v[56:59], v[64:79]
    s_barrier
    ds_read_b64_tr_b16 v[48:49], v12 offset:0
    ds_read_b64_tr_b16 v[50:51], v12 offset:512
    ds_read_b128 v[144:147], v8 offset:0
    v_mfma_f32_32x32x16_bf16 v[80:95], v[140:143], v[60:63], v[80:95]
    ds_read_b64_tr_b16 v[52:53], v13 offset:0
    ds_read_b64_tr_b16 v[54:55], v13 offset:512
    s_waitcnt lgkmcnt(2)
    v_mfma_f32_32x32x16_bf16 v[64:79], v[144:147], v[48:51], v[64:79]
    ds_read_b64_tr_b16 v[56:57], v12 offset:2048
    ds_read_b64_tr_b16 v[58:59], v12 offset:2560
    ds_read_b128 v[148:151], v9 offset:0
    s_waitcnt lgkmcnt(3)
    v_mfma_f32_32x32x16_bf16 v[80:95], v[144:147], v[52:55], v[80:95]
    ds_read_b64_tr_b16 v[60:61], v13 offset:2048
    ds_read_b64_tr_b16 v[62:63], v13 offset:2560
    s_waitcnt lgkmcnt(2)
    v_mfma_f32_32x32x16_bf16 v[64:79], v[148:151], v[56:59], v[64:79]
    ds_read_b64_tr_b16 v[48:49], v12 offset:4096
    ds_read_b64_tr_b16 v[50:51], v12 offset:4608
    ds_read_b128 v[152:155], v10 offset:0
    s_waitcnt lgkmcnt(3)
    v_mfma_f32_32x32x16_bf16 v[80:95], v[148:151], v[60:63], v[80:95]
    ds_read_b64_tr_b16 v[52:53], v13 offset:4096
    ds_read_b64_tr_b16 v[54:55], v13 offset:4608
    s_waitcnt lgkmcnt(2)
    v_mfma_f32_32x32x16_bf16 v[64:79], v[152:155], v[48:51], v[64:79]
    ds_read_b64_tr_b16 v[56:57], v12 offset:6144
    ds_read_b64_tr_b16 v[58:59], v12 offset:6656
    ds_read_b128 v[156:159], v11 offset:0
    s_waitcnt lgkmcnt(3)
    v_mfma_f32_32x32x16_bf16 v[80:95], v[152:155], v[52:55], v[80:95]
    ds_read_b64_tr_b16 v[60:61], v13 offset:6144
    ds_read_b64_tr_b16 v[62:63], v13 offset:6656
    s_waitcnt lgkmcnt(0)
    v_mfma_f32_32x32x16_bf16 v[64:79], v[156:159], v[56:59], v[64:79]
    s_barrier
    ds_read_b64_tr_b16 v[48:49], v12 offset:24576
    ds_read_b64_tr_b16 v[50:51], v12 offset:25088
    ds_read_b128 v[160:163], v8 offset:24576
    v_mfma_f32_32x32x16_bf16 v[80:95], v[156:159], v[60:63], v[80:95]
    ds_read_b64_tr_b16 v[52:53], v13 offset:24576
    ds_read_b64_tr_b16 v[54:55], v13 offset:25088
    s_waitcnt lgkmcnt(2)
    v_mfma_f32_32x32x16_bf16 v[64:79], v[160:163], v[48:51], v[64:79]
    ds_read_b64_tr_b16 v[56:57], v12 offset:26624
    ds_read_b64_tr_b16 v[58:59], v12 offset:27136
    ds_read_b128 v[164:167], v9 offset:24576
    s_waitcnt lgkmcnt(3)
    v_mfma_f32_32x32x16_bf16 v[80:95], v[160:163], v[52:55], v[80:95]
    ds_read_b64_tr_b16 v[60:61], v13 offset:26624
    ds_read_b64_tr_b16 v[62:63], v13 offset:27136
    s_waitcnt lgkmcnt(2)
    v_mfma_f32_32x32x16_bf16 v[64:79], v[164:167], v[56:59], v[64:79]
    ds_read_b64_tr_b16 v[48:49], v12 offset:28672
    ds_read_b64_tr_b16 v[50:51], v12 offset:29184
    ds_read_b128 v[168:171], v10 offset:24576
    s_waitcnt lgkmcnt(3)
    v_mfma_f32_32x32x16_bf16 v[80:95], v[164:167], v[60:63], v[80:95]
    ds_read_b64_tr_b16 v[52:53], v13 offset:28672
    ds_read_b64_tr_b16 v[54:55], v13 offset:29184
    s_waitcnt lgkmcnt(2)
    v_mfma_f32_32x32x16_bf16 v[64:79], v[168:171], v[48:51], v[64:79]
    ds_read_b64_tr_b16 v[56:57], v12 offset:30720
    ds_read_b64_tr_b16 v[58:59], v12 offset:31232
    ds_read_b128 v[172:175], v11 offset:24576
    s_waitcnt lgkmcnt(3)
    v_mfma_f32_32x32x16_bf16 v[80:95], v[168:171], v[52:55], v[80:95]
    ds_read_b64_tr_b16 v[60:61], v13 offset:30720
    ds_read_b64_tr_b16 v[62:63], v13 offset:31232
    s_waitcnt lgkmcnt(0)
    v_mfma_f32_32x32x16_bf16 v[64:79], v[172:175], v[56:59], v[64:79]
    s_barrier
    ds_read_b64_tr_b16 v[48:49], v12 offset:49152
    ds_read_b64_tr_b16 v[50:51], v12 offset:49664
    ds_read_b128 v[176:179], v8 offset:49152
    v_mfma_f32_32x32x16_bf16 v[80:95], v[172:175], v[60:63], v[80:95]
    ds_read_b64_tr_b16 v[52:53], v13 offset:49152
    ds_read_b64_tr_b16 v[54:55], v13 offset:49664
    s_waitcnt lgkmcnt(2)
    v_mfma_f32_32x32x16_bf16 v[64:79], v[176:179], v[48:51], v[64:79]
    ds_read_b64_tr_b16 v[56:57], v12 offset:51200
    ds_read_b64_tr_b16 v[58:59], v12 offset:51712
    ds_read_b128 v[180:183], v9 offset:49152
    s_waitcnt lgkmcnt(3)
    v_mfma_f32_32x32x16_bf16 v[80:95], v[176:179], v[52:55], v[80:95]
    ds_read_b64_tr_b16 v[60:61], v13 offset:51200
    ds_read_b64_tr_b16 v[62:63], v13 offset:51712
    s_waitcnt lgkmcnt(2)
    v_mfma_f32_32x32x16_bf16 v[64:79], v[180:183], v[56:59], v[64:79]
    ds_read_b64_tr_b16 v[48:49], v12 offset:53248
    ds_read_b64_tr_b16 v[50:51], v12 offset:53760
    ds_read_b128 v[184:187], v10 offset:49152
    s_waitcnt lgkmcnt(3)
    v_mfma_f32_32x32x16_bf16 v[80:95], v[180:183], v[60:63], v[80:95]
    ds_read_b64_tr_b16 v[52:53], v13 offset:53248
    ds_read_b64_tr_b16 v[54:55], v13 offset:53760
    s_waitcnt lgkmcnt(2)
    v_mfma_f32_32x32x16_bf16 v[64:79], v[184:187], v[48:51], v[64:79]
    ds_read_b64_tr_b16 v[56:57], v12 offset:55296
    ds_read_b64_tr_b16 v[58:59], v12 offset:55808
    ds_read_b128 v[188:191], v11 offset:49152
    s_waitcnt lgkmcnt(3)
    v_mfma_f32_32x32x16_bf16 v[80:95], v[184:187], v[52:55], v[80:95]
    ds_read_b64_tr_b16 v[60:61], v13 offset:55296
    ds_read_b64_tr_b16 v[62:63], v13 offset:55808
    s_waitcnt lgkmcnt(0)
    v_mfma_f32_32x32x16_bf16 v[64:79], v[188:191], v[56:59], v[64:79]
    s_barrier
    ds_read_b64_tr_b16 v[48:49], v12 offset:0
    ds_read_b64_tr_b16 v[50:51], v12 offset:512
    ds_read_b128 v[192:195], v8 offset:0
    v_mfma_f32_32x32x16_bf16 v[80:95], v[188:191], v[60:63], v[80:95]
    ds_read_b64_tr_b16 v[52:53], v13 offset:0
    ds_read_b64_tr_b16 v[54:55], v13 offset:512
    buffer_load_dword v15, v16, s[32:35], 0 offen sc1
    s_waitcnt lgkmcnt(2)
    v_mfma_f32_32x32x16_bf16 v[64:79], v[192:195], v[48:51], v[64:79]
    ds_read_b64_tr_b16 v[56:57], v12 offset:2048
    ds_read_b64_tr_b16 v[58:59], v12 offset:2560
    ds_read_b128 v[196:199], v9 offset:0
    s_waitcnt lgkmcnt(3)
    v_mfma_f32_32x32x16_bf16 v[80:95], v[192:195], v[52:55], v[80:95]
    ds_read_b64_tr_b16 v[60:61], v13 offset:2048
    ds_read_b64_tr_b16 v[62:63], v13 offset:2560
    s_waitcnt lgkmcnt(2)
    v_mfma_f32_32x32x16_bf16 v[64:79], v[196:199], v[56:59], v[64:79]
    ds_read_b64_tr_b16 v[48:49], v12 offset:4096
    ds_read_b64_tr_b16 v[50:51], v12 offset:4608
    ds_read_b128 v[200:203], v10 offset:0
    s_waitcnt lgkmcnt(3)
    v_mfma_f32_32x32x16_bf16 v[80:95], v[196:199], v[60:63], v[80:95]
    ds_read_b64_tr_b16 v[52:53], v13 offset:4096
    ds_read_b64_tr_b16 v[54:55], v13 offset:4608
    s_waitcnt lgkmcnt(2)
    v_mfma_f32_32x32x16_bf16 v[64:79], v[200:203], v[48:51], v[64:79]
    ds_read_b64_tr_b16 v[56:57], v12 offset:6144
    ds_read_b64_tr_b16 v[58:59], v12 offset:6656
    ds_read_b128 v[204:207], v11 offset:0
    s_waitcnt lgkmcnt(3)
    v_mfma_f32_32x32x16_bf16 v[80:95], v[200:203], v[52:55], v[80:95]
    ds_read_b64_tr_b16 v[60:61], v13 offset:6144
    ds_read_b64_tr_b16 v[62:63], v13 offset:6656
    s_waitcnt lgkmcnt(0)
    v_mfma_f32_32x32x16_bf16 v[64:79], v[204:207], v[56:59], v[64:79]
    s_barrier
    ds_read_b64_tr_b16 v[48:49], v12 offset:24576
    ds_read_b64_tr_b16 v[50:51], v12 offset:25088
    ds_read_b128 v[208:211], v8 offset:24576
    v_mfma_f32_32x32x16_bf16 v[80:95], v[204:207], v[60:63], v[80:95]
    ds_read_b64_tr_b16 v[52:53], v13 offset:24576
    ds_read_b64_tr_b16 v[54:55], v13 offset:25088
    s_waitcnt lgkmcnt(2)
    v_mfma_f32_32x32x16_bf16 v[64:79], v[208:211], v[48:51], v[64:79]
    ds_read_b64_tr_b16 v[56:57], v12 offset:26624
    ds_read_b64_tr_b16 v[58:59], v12 offset:27136
    ds_read_b128 v[212:215], v9 offset:24576
    s_waitcnt lgkmcnt(3)
    v_mfma_f32_32x32x16_bf16 v[80:95], v[208:211], v[52:55], v[80:95]
    ds_read_b64_tr_b16 v[60:61], v13 offset:26624
    ds_read_b64_tr_b16 v[62:63], v13 offset:27136
    s_waitcnt lgkmcnt(2)
    v_mfma_f32_32x32x16_bf16 v[64:79], v[212:215], v[56:59], v[64:79]
    ds_read_b64_tr_b16 v[48:49], v12 offset:28672
    ds_read_b64_tr_b16 v[50:51], v12 offset:29184
    ds_read_b128 v[216:219], v10 offset:24576
    s_waitcnt lgkmcnt(3)
    v_mfma_f32_32x32x16_bf16 v[80:95], v[212:215], v[60:63], v[80:95]
    ds_read_b64_tr_b16 v[52:53], v13 offset:28672
    ds_read_b64_tr_b16 v[54:55], v13 offset:29184
    s_waitcnt lgkmcnt(2)
    v_mfma_f32_32x32x16_bf16 v[64:79], v[216:219], v[48:51], v[64:79]
    ds_read_b64_tr_b16 v[56:57], v12 offset:30720
    ds_read_b64_tr_b16 v[58:59], v12 offset:31232
    ds_read_b128 v[220:223], v11 offset:24576
    s_waitcnt lgkmcnt(3)
    v_mfma_f32_32x32x16_bf16 v[80:95], v[216:219], v[52:55], v[80:95]
    ds_read_b64_tr_b16 v[60:61], v13 offset:30720
    ds_read_b64_tr_b16 v[62:63], v13 offset:31232
    s_waitcnt lgkmcnt(0)
    v_mfma_f32_32x32x16_bf16 v[64:79], v[220:223], v[56:59], v[64:79]
    s_barrier
    ds_read_b64_tr_b16 v[48:49], v12 offset:49152
    ds_read_b64_tr_b16 v[50:51], v12 offset:49664
    ds_read_b128 v[224:227], v8 offset:49152
    v_mfma_f32_32x32x16_bf16 v[80:95], v[220:223], v[60:63], v[80:95]
    ds_read_b64_tr_b16 v[52:53], v13 offset:49152
    ds_read_b64_tr_b16 v[54:55], v13 offset:49664
    s_call_b64 s[58:59], p1_15
    s_waitcnt lgkmcnt(2)
    v_mfma_f32_32x32x16_bf16 v[64:79], v[224:227], v[48:51], v[64:79]
    ds_read_b64_tr_b16 v[56:57], v12 offset:51200
    ds_read_b64_tr_b16 v[58:59], v12 offset:51712
    ds_read_b128 v[228:231], v9 offset:49152
    s_waitcnt lgkmcnt(3)
    v_mfma_f32_32x32x16_bf16 v[80:95], v[224:227], v[52:55], v[80:95]
    ds_read_b64_tr_b16 v[60:61], v13 offset:51200
    ds_read_b64_tr_b16 v[62:63], v13 offset:51712
    s_waitcnt lgkmcnt(2)
    v_mfma_f32_32x32x16_bf16 v[64:79], v[228:231], v[56:59], v[64:79]
    ds_read_b64_tr_b16 v[48:49], v12 offset:53248
    ds_read_b64_tr_b16 v[50:51], v12 offset:53760
    ds_read_b128 v[232:235], v10 offset:49152
    s_waitcnt lgkmcnt(3)
    v_mfma_f32_32x32x16_bf16 v[80:95], v[228:231], v[60:63], v[80:95]
    ds_read_b64_tr_b16 v[52:53], v13 offset:53248
    ds_read_b64_tr_b16 v[54:55], v13 offset:53760
    s_waitcnt lgkmcnt(2)
    v_mfma_f32_32x32x16_bf16 v[64:79], v[232:235], v[48:51], v[64:79]
    ds_read_b64_tr_b16 v[56:57], v12 offset:55296
    ds_read_b64_tr_b16 v[58:59], v12 offset:55808
    ds_read_b128 v[236:239], v11 offset:49152
    s_waitcnt lgkmcnt(3)
    v_mfma_f32_32x32x16_bf16 v[80:95], v[232:235], v[52:55], v[80:95]
    ds_read_b64_tr_b16 v[60:61], v13 offset:55296
    ds_read_b64_tr_b16 v[62:63], v13 offset:55808
    s_waitcnt lgkmcnt(0)
    v_mfma_f32_32x32x16_bf16 v[64:79], v[236:239], v[56:59], v[64:79]
    s_barrier
    ds_read_b64_tr_b16 v[48:49], v12 offset:0
    ds_read_b64_tr_b16 v[50:51], v12 offset:512
    ds_read_b128 v[240:243], v8 offset:0
    v_mfma_f32_32x32x16_bf16 v[80:95], v[236:239], v[60:63], v[80:95]
    ds_read_b64_tr_b16 v[52:53], v13 offset:0
    ds_read_b64_tr_b16 v[54:55], v13 offset:512
    s_waitcnt lgkmcnt(2)
    v_mfma_f32_32x32x16_bf16 v[64:79], v[240:243], v[48:51], v[64:79]
    ds_read_b64_tr_b16 v[56:57], v12 offset:2048
    ds_read_b64_tr_b16 v[58:59], v12 offset:2560
    ds_read_b128 v[244:247], v9 offset:0
    s_waitcnt lgkmcnt(3)
    v_mfma_f32_32x32x16_bf16 v[80:95], v[240:243], v[52:55], v[80:95]
    ds_read_b64_tr_b16 v[60:61], v13 offset:2048
    ds_read_b64_tr_b16 v[62:63], v13 offset:2560
    s_waitcnt lgkmcnt(2)
    v_mfma_f32_32x32x16_bf16 v[64:79], v[244:247], v[56:59], v[64:79]
    ds_read_b64_tr_b16 v[48:49], v12 offset:4096
    ds_read_b64_tr_b16 v[50:51], v12 offset:4608
    ds_read_b128 v[248:251], v10 offset:0
    s_waitcnt lgkmcnt(3)
    v_mfma_f32_32x32x16_bf16 v[80:95], v[244:247], v[60:63], v[80:95]
    ds_read_b64_tr_b16 v[52:53], v13 offset:4096
    ds_read_b64_tr_b16 v[54:55], v13 offset:4608
    s_waitcnt lgkmcnt(2)
    v_mfma_f32_32x32x16_bf16 v[64:79], v[248:251], v[48:51], v[64:79]
    ds_read_b64_tr_b16 v[56:57], v12 offset:6144
    ds_read_b64_tr_b16 v[58:59], v12 offset:6656
    ds_read_b128 v[252:255], v11 offset:0
    s_waitcnt lgkmcnt(3)
    v_mfma_f32_32x32x16_bf16 v[80:95], v[248:251], v[52:55], v[80:95]
    ds_read_b64_tr_b16 v[60:61], v13 offset:6144
    ds_read_b64_tr_b16 v[62:63], v13 offset:6656
    v_lshlrev_b32 v7, 2, v1
    v_add_u32 v7, 157696, v7
    s_waitcnt lgkmcnt(0)
    v_mfma_f32_32x32x16_bf16 v[64:79], v[252:255], v[56:59], v[64:79]
    s_barrier
    v_mfma_f32_32x32x16_bf16 v[80:95], v[252:255], v[60:63], v[80:95]
    ds_read_b32 v44, v7 offset:0
    ds_read_b32 v45, v7 offset:256
    ds_read_b32 v46, v7 offset:512
    ds_read_b32 v47, v7 offset:768
    s_waitcnt vmcnt(0)
    v_cvt_pk_bf16_f32 v2, v18, v18
    v_and_b32 v21, 0xffff0000, v2
    v_sub_f32 v21, v18, v21
    v_cvt_pk_bf16_f32 v21, v21, v21
    v_mov_b32 v20, v2
    v_lshrrev_b32 v3, 1, v14
    v_add_u32 v3, v3, v34
    v_mov_b32 v22, v20
    v_mov_b32 v23, v21
    s_mov_b32 exec_hi, 0
    ds_write_b32 v3, v19
    v_mov_b32 v22, 0
    v_mov_b32 v23, 0
    s_not_b64 exec, exec
    v_mov_b32 v20, 0
    v_mov_b32 v21, 0
    s_mov_b64 exec, -1
    v_add_u32 v12, 57344, v12
    v_add_u32 v13, 57344, v13
    s_waitcnt lgkmcnt(1)
    v_add_f32 v44, v44, v45
    v_add_f32 v46, v46, v47
    v_add_f32 v44, v44, v46
    v_cvt_pk_bf16_f32 v2, v44, v44
    v_and_b32 v25, 0xffff0000, v2
    v_sub_f32 v25, v44, v25
    v_cvt_pk_bf16_f32 v24, v44, v25
    v_mov_b32 v25, v24
    ds_read_b128 v[48:51], v34 offset:0
    ds_read_b128 v[52:55], v34 offset:32
    ds_read_b128 v[56:59], v34 offset:64
    ds_read_b128 v[60:63], v34 offset:96
    s_nop 0
    v_mfma_f32_32x32x8_bf16 v[64:79], v[20:21], v[24:25], v[64:79]
    v_mfma_f32_32x32x8_bf16 v[80:95], v[22:23], v[24:25], v[80:95]
    s_nop 7
    s_nop 1
    s_waitcnt lgkmcnt(0)
    v_pk_mul_f32 v[64:65], v[64:65], v[48:49]
    v_pk_mul_f32 v[66:67], v[66:67], v[50:51]
    v_pk_mul_f32 v[68:69], v[68:69], v[52:53]
    v_pk_mul_f32 v[70:71], v[70:71], v[54:55]
    v_pk_mul_f32 v[72:73], v[72:73], v[56:57]
    v_pk_mul_f32 v[74:75], v[74:75], v[58:59]
    v_pk_mul_f32 v[76:77], v[76:77], v[60:61]
    v_pk_mul_f32 v[78:79], v[78:79], v[62:63]
    v_cvt_pk_bf16_f32 v64, v64, v65
    v_cvt_pk_bf16_f32 v65, v66, v67
    v_cvt_pk_bf16_f32 v66, v68, v69
    v_cvt_pk_bf16_f32 v67, v70, v71
    v_cvt_pk_bf16_f32 v68, v72, v73
    v_cvt_pk_bf16_f32 v69, v74, v75
    v_cvt_pk_bf16_f32 v70, v76, v77
    v_cvt_pk_bf16_f32 v71, v78, v79
    v_permlane32_swap_b32 v64, v66
    v_permlane32_swap_b32 v65, v67
    s_nop 0
    v_permlane32_swap_b32 v68, v70
    v_permlane32_swap_b32 v69, v71
    buffer_store_dwordx4 v[64:67], v26, s[32:35], s43 offen offset:0 sc1
    buffer_store_dwordx4 v[68:71], v26, s[32:35], s43 offen offset:640 sc1
    v_pk_mul_f32 v[80:81], v[80:81], v[48:49]
    v_pk_mul_f32 v[82:83], v[82:83], v[50:51]
    v_pk_mul_f32 v[84:85], v[84:85], v[52:53]
    v_pk_mul_f32 v[86:87], v[86:87], v[54:55]
    v_pk_mul_f32 v[88:89], v[88:89], v[56:57]
    v_pk_mul_f32 v[90:91], v[90:91], v[58:59]
    v_pk_mul_f32 v[92:93], v[92:93], v[60:61]
    v_pk_mul_f32 v[94:95], v[94:95], v[62:63]
    v_cvt_pk_bf16_f32 v80, v80, v81
    v_cvt_pk_bf16_f32 v81, v82, v83
    v_cvt_pk_bf16_f32 v82, v84, v85
    v_cvt_pk_bf16_f32 v83, v86, v87
    v_cvt_pk_bf16_f32 v84, v88, v89
    v_cvt_pk_bf16_f32 v85, v90, v91
    v_cvt_pk_bf16_f32 v86, v92, v93
    v_cvt_pk_bf16_f32 v87, v94, v95
    v_permlane32_swap_b32 v80, v82
    v_permlane32_swap_b32 v81, v83
    s_nop 0
    v_permlane32_swap_b32 v84, v86
    v_permlane32_swap_b32 v85, v87
    buffer_store_dwordx4 v[80:83], v27, s[32:35], s43 offen offset:0 sc1
    buffer_store_dwordx4 v[84:87], v27, s[32:35], s43 offen offset:640 sc1
p1_17:
    ds_read_b64_tr_b16 v[48:49], v12 offset:0
    ds_read_b64_tr_b16 v[50:51], v12 offset:512
    ds_read_b64_tr_b16 v[52:53], v13 offset:0
    ds_read_b64_tr_b16 v[54:55], v13 offset:512
    ds_read_b64_tr_b16 v[56:57], v12 offset:2048
    ds_read_b64_tr_b16 v[58:59], v12 offset:2560
    ds_read_b64_tr_b16 v[60:61], v13 offset:2048
    ds_read_b64_tr_b16 v[62:63], v13 offset:2560
    s_waitcnt lgkmcnt(4)
    v_mfma_f32_32x32x16_bf16 v[64:79], v[96:99], v[48:51], 0
    s_barrier
    ds_read_b64_tr_b16 v[36:37], v12 offset:4096
    ds_read_b64_tr_b16 v[38:39], v12 offset:4608
    v_mfma_f32_32x32x16_bf16 v[80:95], v[96:99], v[52:55], 0
    ds_read_b64_tr_b16 v[40:41], v13 offset:4096
    ds_read_b64_tr_b16 v[42:43], v13 offset:4608
    s_waitcnt lgkmcnt(4)
    v_mfma_f32_32x32x16_bf16 v[64:79], v[100:103], v[56:59], v[64:79]
    ds_read_b64_tr_b16 v[48:49], v12 offset:6144
    ds_read_b64_tr_b16 v[50:51], v12 offset:6656
    v_mfma_f32_32x32x16_bf16 v[80:95], v[100:103], v[60:63], v[80:95]
    ds_read_b64_tr_b16 v[52:53], v13 offset:6144
    ds_read_b64_tr_b16 v[54:55], v13 offset:6656
    s_waitcnt lgkmcnt(4)
    v_mfma_f32_32x32x16_bf16 v[64:79], v[104:107], v[36:39], v[64:79]
    ds_read_b64_tr_b16 v[56:57], v12 offset:8192
    ds_read_b64_tr_b16 v[58:59], v12 offset:8704
    v_mfma_f32_32x32x16_bf16 v[80:95], v[104:107], v[40:43], v[80:95]
    ds_read_b64_tr_b16 v[60:61], v13 offset:8192
    ds_read_b64_tr_b16 v[62:63], v13 offset:8704
    s_waitcnt lgkmcnt(4)
    v_mfma_f32_32x32x16_bf16 v[64:79], v[108:111], v[48:51], v[64:79]
    ds_read_b64_tr_b16 v[36:37], v12 offset:10240
    ds_read_b64_tr_b16 v[38:39], v12 offset:10752
    v_mfma_f32_32x32x16_bf16 v[80:95], v[108:111], v[52:55], v[80:95]
    ds_read_b64_tr_b16 v[40:41], v13 offset:10240
    ds_read_b64_tr_b16 v[42:43], v13 offset:10752
    s_waitcnt lgkmcnt(4)
    v_mfma_f32_32x32x16_bf16 v[64:79], v[112:115], v[56:59], v[64:79]
    ds_read_b64_tr_b16 v[48:49], v12 offset:12288
    ds_read_b64_tr_b16 v[50:51], v12 offset:12800
    v_mfma_f32_32x32x16_bf16 v[80:95], v[112:115], v[60:63], v[80:95]
    ds_read_b64_tr_b16 v[52:53], v13 offset:12288
    ds_read_b64_tr_b16 v[54:55], v13 offset:12800
    s_waitcnt lgkmcnt(4)
    v_mfma_f32_32x32x16_bf16 v[64:79], v[116:119], v[36:39], v[64:79]
    ds_read_b64_tr_b16 v[56:57], v12 offset:14336
    ds_read_b64_tr_b16 v[58:59], v12 offset:14848
    v_mfma_f32_32x32x16_bf16 v[80:95], v[116:119], v[40:43], v[80:95]
    ds_read_b64_tr_b16 v[60:61], v13 offset:14336
    ds_read_b64_tr_b16 v[62:63], v13 offset:14848
    s_waitcnt lgkmcnt(4)
    v_mfma_f32_32x32x16_bf16 v[64:79], v[120:123], v[48:51], v[64:79]
    ds_read_b64_tr_b16 v[36:37], v12 offset:16384
    ds_read_b64_tr_b16 v[38:39], v12 offset:16896
    v_mfma_f32_32x32x16_bf16 v[80:95], v[120:123], v[52:55], v[80:95]
    ds_read_b64_tr_b16 v[40:41], v13 offset:16384
    ds_read_b64_tr_b16 v[42:43], v13 offset:16896
    s_waitcnt lgkmcnt(4)
    v_mfma_f32_32x32x16_bf16 v[64:79], v[124:127], v[56:59], v[64:79]
    ds_read_b64_tr_b16 v[48:49], v12 offset:18432
    ds_read_b64_tr_b16 v[50:51], v12 offset:18944
    v_mfma_f32_32x32x16_bf16 v[80:95], v[124:127], v[60:63], v[80:95]
    ds_read_b64_tr_b16 v[52:53], v13 offset:18432
    ds_read_b64_tr_b16 v[54:55], v13 offset:18944
    s_waitcnt lgkmcnt(4)
    v_mfma_f32_32x32x16_bf16 v[64:79], v[128:131], v[36:39], v[64:79]
    ds_read_b64_tr_b16 v[56:57], v12 offset:20480
    ds_read_b64_tr_b16 v[58:59], v12 offset:20992
    v_mfma_f32_32x32x16_bf16 v[80:95], v[128:131], v[40:43], v[80:95]
    ds_read_b64_tr_b16 v[60:61], v13 offset:20480
    ds_read_b64_tr_b16 v[62:63], v13 offset:20992
    s_waitcnt lgkmcnt(4)
    v_mfma_f32_32x32x16_bf16 v[64:79], v[132:135], v[48:51], v[64:79]
    ds_read_b64_tr_b16 v[36:37], v12 offset:22528
    ds_read_b64_tr_b16 v[38:39], v12 offset:23040
    v_mfma_f32_32x32x16_bf16 v[80:95], v[132:135], v[52:55], v[80:95]
    ds_read_b64_tr_b16 v[40:41], v13 offset:22528
    ds_read_b64_tr_b16 v[42:43], v13 offset:23040
    s_waitcnt lgkmcnt(4)
    v_mfma_f32_32x32x16_bf16 v[64:79], v[136:139], v[56:59], v[64:79]
    ds_read_b64_tr_b16 v[48:49], v12 offset:24576
    ds_read_b64_tr_b16 v[50:51], v12 offset:25088
    v_mfma_f32_32x32x16_bf16 v[80:95], v[136:139], v[60:63], v[80:95]
    ds_read_b64_tr_b16 v[52:53], v13 offset:24576
    ds_read_b64_tr_b16 v[54:55], v13 offset:25088
    s_waitcnt lgkmcnt(4)
    v_mfma_f32_32x32x16_bf16 v[64:79], v[140:143], v[36:39], v[64:79]
    ds_read_b64_tr_b16 v[56:57], v12 offset:26624
    ds_read_b64_tr_b16 v[58:59], v12 offset:27136
    v_mfma_f32_32x32x16_bf16 v[80:95], v[140:143], v[40:43], v[80:95]
    ds_read_b64_tr_b16 v[60:61], v13 offset:26624
    ds_read_b64_tr_b16 v[62:63], v13 offset:27136
    s_waitcnt lgkmcnt(4)
    v_mfma_f32_32x32x16_bf16 v[64:79], v[144:147], v[48:51], v[64:79]
    ds_read_b64_tr_b16 v[36:37], v12 offset:28672
    ds_read_b64_tr_b16 v[38:39], v12 offset:29184
    v_mfma_f32_32x32x16_bf16 v[80:95], v[144:147], v[52:55], v[80:95]
    ds_read_b64_tr_b16 v[40:41], v13 offset:28672
    ds_read_b64_tr_b16 v[42:43], v13 offset:29184
    s_waitcnt lgkmcnt(4)
    v_mfma_f32_32x32x16_bf16 v[64:79], v[148:151], v[56:59], v[64:79]
    ds_read_b64_tr_b16 v[48:49], v12 offset:30720
    ds_read_b64_tr_b16 v[50:51], v12 offset:31232
    v_mfma_f32_32x32x16_bf16 v[80:95], v[148:151], v[60:63], v[80:95]
    ds_read_b64_tr_b16 v[52:53], v13 offset:30720
    ds_read_b64_tr_b16 v[54:55], v13 offset:31232
    s_waitcnt lgkmcnt(4)
    v_mfma_f32_32x32x16_bf16 v[64:79], v[152:155], v[36:39], v[64:79]
    ds_read_b64_tr_b16 v[56:57], v12 offset:32768
    ds_read_b64_tr_b16 v[58:59], v12 offset:33280
    v_mfma_f32_32x32x16_bf16 v[80:95], v[152:155], v[40:43], v[80:95]
    ds_read_b64_tr_b16 v[60:61], v13 offset:32768
    ds_read_b64_tr_b16 v[62:63], v13 offset:33280
    s_waitcnt lgkmcnt(4) vmcnt(0)
    v_mfma_f32_32x32x16_bf16 v[64:79], v[156:159], v[48:51], v[64:79]
    s_barrier
    ds_read_b64_tr_b16 v[36:37], v12 offset:34816
    ds_read_b64_tr_b16 v[38:39], v12 offset:35328
    v_mfma_f32_32x32x16_bf16 v[80:95], v[156:159], v[52:55], v[80:95]
    ds_read_b64_tr_b16 v[40:41], v13 offset:34816
    ds_read_b64_tr_b16 v[42:43], v13 offset:35328
    s_waitcnt lgkmcnt(4)
    v_mfma_f32_32x32x16_bf16 v[64:79], v[160:163], v[56:59], v[64:79]
    ds_read_b64_tr_b16 v[48:49], v12 offset:36864
    ds_read_b64_tr_b16 v[50:51], v12 offset:37376
    v_mfma_f32_32x32x16_bf16 v[80:95], v[160:163], v[60:63], v[80:95]
    ds_read_b64_tr_b16 v[52:53], v13 offset:36864
    ds_read_b64_tr_b16 v[54:55], v13 offset:37376
    s_waitcnt lgkmcnt(4)
    v_mfma_f32_32x32x16_bf16 v[64:79], v[164:167], v[36:39], v[64:79]
    ds_read_b64_tr_b16 v[56:57], v12 offset:38912
    ds_read_b64_tr_b16 v[58:59], v12 offset:39424
    v_mfma_f32_32x32x16_bf16 v[80:95], v[164:167], v[40:43], v[80:95]
    ds_read_b64_tr_b16 v[60:61], v13 offset:38912
    ds_read_b64_tr_b16 v[62:63], v13 offset:39424
    s_waitcnt lgkmcnt(4)
    v_mfma_f32_32x32x16_bf16 v[64:79], v[168:171], v[48:51], v[64:79]
    v_add_u32 v12, 40960, v12
    ds_read_b64_tr_b16 v[36:37], v12 offset:0
    ds_read_b64_tr_b16 v[38:39], v12 offset:512
    v_mfma_f32_32x32x16_bf16 v[80:95], v[168:171], v[52:55], v[80:95]
    v_add_u32 v13, 40960, v13
    ds_read_b64_tr_b16 v[40:41], v13 offset:0
    ds_read_b64_tr_b16 v[42:43], v13 offset:512
    s_waitcnt lgkmcnt(4)
    v_mfma_f32_32x32x16_bf16 v[64:79], v[172:175], v[56:59], v[64:79]
    ds_read_b64_tr_b16 v[48:49], v12 offset:2048
    ds_read_b64_tr_b16 v[50:51], v12 offset:2560
    v_mfma_f32_32x32x16_bf16 v[80:95], v[172:175], v[60:63], v[80:95]
    ds_read_b64_tr_b16 v[52:53], v13 offset:2048
    ds_read_b64_tr_b16 v[54:55], v13 offset:2560
    s_waitcnt lgkmcnt(4)
    v_mfma_f32_32x32x16_bf16 v[64:79], v[176:179], v[36:39], v[64:79]
    ds_read_b64_tr_b16 v[56:57], v12 offset:4096
    ds_read_b64_tr_b16 v[58:59], v12 offset:4608
    v_mfma_f32_32x32x16_bf16 v[80:95], v[176:179], v[40:43], v[80:95]
    ds_read_b64_tr_b16 v[60:61], v13 offset:4096
    ds_read_b64_tr_b16 v[62:63], v13 offset:4608
    s_waitcnt lgkmcnt(4)
    v_mfma_f32_32x32x16_bf16 v[64:79], v[180:183], v[48:51], v[64:79]
    ds_read_b64_tr_b16 v[36:37], v12 offset:6144
    ds_read_b64_tr_b16 v[38:39], v12 offset:6656
    v_mfma_f32_32x32x16_bf16 v[80:95], v[180:183], v[52:55], v[80:95]
    ds_read_b64_tr_b16 v[40:41], v13 offset:6144
    ds_read_b64_tr_b16 v[42:43], v13 offset:6656
    s_waitcnt lgkmcnt(4)
    v_mfma_f32_32x32x16_bf16 v[64:79], v[184:187], v[56:59], v[64:79]
    ds_read_b64_tr_b16 v[48:49], v12 offset:8192
    ds_read_b64_tr_b16 v[50:51], v12 offset:8704
    v_mfma_f32_32x32x16_bf16 v[80:95], v[184:187], v[60:63], v[80:95]
    ds_read_b64_tr_b16 v[52:53], v13 offset:8192
    ds_read_b64_tr_b16 v[54:55], v13 offset:8704
    s_waitcnt lgkmcnt(4)
    v_mfma_f32_32x32x16_bf16 v[64:79], v[188:191], v[36:39], v[64:79]
    ds_read_b64_tr_b16 v[56:57], v12 offset:10240
    ds_read_b64_tr_b16 v[58:59], v12 offset:10752
    v_mfma_f32_32x32x16_bf16 v[80:95], v[188:191], v[40:43], v[80:95]
    ds_read_b64_tr_b16 v[60:61], v13 offset:10240
    ds_read_b64_tr_b16 v[62:63], v13 offset:10752
    s_waitcnt lgkmcnt(4)
    v_mfma_f32_32x32x16_bf16 v[64:79], v[192:195], v[48:51], v[64:79]
    ds_read_b64_tr_b16 v[36:37], v12 offset:12288
    ds_read_b64_tr_b16 v[38:39], v12 offset:12800
    v_mfma_f32_32x32x16_bf16 v[80:95], v[192:195], v[52:55], v[80:95]
    ds_read_b64_tr_b16 v[40:41], v13 offset:12288
    ds_read_b64_tr_b16 v[42:43], v13 offset:12800
    s_waitcnt lgkmcnt(4)
    v_mfma_f32_32x32x16_bf16 v[64:79], v[196:199], v[56:59], v[64:79]
    ds_read_b64_tr_b16 v[48:49], v12 offset:14336
    ds_read_b64_tr_b16 v[50:51], v12 offset:14848
    v_mfma_f32_32x32x16_bf16 v[80:95], v[196:199], v[60:63], v[80:95]
    ds_read_b64_tr_b16 v[52:53], v13 offset:14336
    ds_read_b64_tr_b16 v[54:55], v13 offset:14848
    s_waitcnt lgkmcnt(4)
    v_mfma_f32_32x32x16_bf16 v[64:79], v[200:203], v[36:39], v[64:79]
    ds_read_b64_tr_b16 v[56:57], v12 offset:16384
    ds_read_b64_tr_b16 v[58:59], v12 offset:16896
    v_mfma_f32_32x32x16_bf16 v[80:95], v[200:203], v[40:43], v[80:95]
    ds_read_b64_tr_b16 v[60:61], v13 offset:16384
    ds_read_b64_tr_b16 v[62:63], v13 offset:16896
    s_waitcnt lgkmcnt(4)
    v_mfma_f32_32x32x16_bf16 v[64:79], v[204:207], v[48:51], v[64:79]
    ds_read_b64_tr_b16 v[36:37], v12 offset:18432
    ds_read_b64_tr_b16 v[38:39], v12 offset:18944
    v_mfma_f32_32x32x16_bf16 v[80:95], v[204:207], v[52:55], v[80:95]
    ds_read_b64_tr_b16 v[40:41], v13 offset:18432
    ds_read_b64_tr_b16 v[42:43], v13 offset:18944
    s_waitcnt lgkmcnt(4)
    v_mfma_f32_32x32x16_bf16 v[64:79], v[208:211], v[56:59], v[64:79]
    ds_read_b64_tr_b16 v[48:49], v12 offset:20480
    ds_read_b64_tr_b16 v[50:51], v12 offset:20992
    v_mfma_f32_32x32x16_bf16 v[80:95], v[208:211], v[60:63], v[80:95]
    ds_read_b64_tr_b16 v[52:53], v13 offset:20480
    ds_read_b64_tr_b16 v[54:55], v13 offset:20992
    s_waitcnt lgkmcnt(4)
    v_mfma_f32_32x32x16_bf16 v[64:79], v[212:215], v[36:39], v[64:79]
    ds_read_b64_tr_b16 v[56:57], v12 offset:22528
    ds_read_b64_tr_b16 v[58:59], v12 offset:23040
    v_mfma_f32_32x32x16_bf16 v[80:95], v[212:215], v[40:43], v[80:95]
    ds_read_b64_tr_b16 v[60:61], v13 offset:22528
    ds_read_b64_tr_b16 v[62:63], v13 offset:23040
    s_waitcnt lgkmcnt(4)
    v_mfma_f32_32x32x16_bf16 v[64:79], v[216:219], v[48:51], v[64:79]
    ds_read_b64_tr_b16 v[36:37], v12 offset:24576
    ds_read_b64_tr_b16 v[38:39], v12 offset:25088
    v_mfma_f32_32x32x16_bf16 v[80:95], v[216:219], v[52:55], v[80:95]
    ds_read_b64_tr_b16 v[40:41], v13 offset:24576
    ds_read_b64_tr_b16 v[42:43], v13 offset:25088
    s_waitcnt lgkmcnt(4)
    v_mfma_f32_32x32x16_bf16 v[64:79], v[220:223], v[56:59], v[64:79]
    ds_read_b64_tr_b16 v[48:49], v12 offset:26624
    ds_read_b64_tr_b16 v[50:51], v12 offset:27136
    v_mfma_f32_32x32x16_bf16 v[80:95], v[220:223], v[60:63], v[80:95]
    ds_read_b64_tr_b16 v[52:53], v13 offset:26624
    ds_read_b64_tr_b16 v[54:55], v13 offset:27136
    s_waitcnt lgkmcnt(4)
    v_mfma_f32_32x32x16_bf16 v[64:79], v[224:227], v[36:39], v[64:79]
    ds_read_b64_tr_b16 v[56:57], v12 offset:28672
    ds_read_b64_tr_b16 v[58:59], v12 offset:29184
    v_mfma_f32_32x32x16_bf16 v[80:95], v[224:227], v[40:43], v[80:95]
    ds_read_b64_tr_b16 v[60:61], v13 offset:28672
    ds_read_b64_tr_b16 v[62:63], v13 offset:29184
    s_waitcnt lgkmcnt(4)
    v_mfma_f32_32x32x16_bf16 v[64:79], v[228:231], v[48:51], v[64:79]
    ds_read_b64_tr_b16 v[36:37], v12 offset:30720
    ds_read_b64_tr_b16 v[38:39], v12 offset:31232
    v_mfma_f32_32x32x16_bf16 v[80:95], v[228:231], v[52:55], v[80:95]
    ds_read_b64_tr_b16 v[40:41], v13 offset:30720
    ds_read_b64_tr_b16 v[42:43], v13 offset:31232
    s_waitcnt lgkmcnt(4)
    v_mfma_f32_32x32x16_bf16 v[64:79], v[232:235], v[56:59], v[64:79]
    ds_read_b64_tr_b16 v[48:49], v12 offset:32768
    ds_read_b64_tr_b16 v[50:51], v12 offset:33280
    v_mfma_f32_32x32x16_bf16 v[80:95], v[232:235], v[60:63], v[80:95]
    ds_read_b64_tr_b16 v[52:53], v13 offset:32768
    ds_read_b64_tr_b16 v[54:55], v13 offset:33280
    s_waitcnt lgkmcnt(4)
    v_mfma_f32_32x32x16_bf16 v[64:79], v[236:239], v[36:39], v[64:79]
    ds_read_b64_tr_b16 v[56:57], v12 offset:34816
    ds_read_b64_tr_b16 v[58:59], v12 offset:35328
    v_mfma_f32_32x32x16_bf16 v[80:95], v[236:239], v[40:43], v[80:95]
    ds_read_b64_tr_b16 v[60:61], v13 offset:34816
    ds_read_b64_tr_b16 v[62:63], v13 offset:35328
    s_waitcnt lgkmcnt(4)
    v_mfma_f32_32x32x16_bf16 v[64:79], v[240:243], v[48:51], v[64:79]
    ds_read_b64_tr_b16 v[36:37], v12 offset:36864
    ds_read_b64_tr_b16 v[38:39], v12 offset:37376
    v_mfma_f32_32x32x16_bf16 v[80:95], v[240:243], v[52:55], v[80:95]
    ds_read_b64_tr_b16 v[40:41], v13 offset:36864
    ds_read_b64_tr_b16 v[42:43], v13 offset:37376
    v_lshlrev_b32 v3, 2, v1
    v_add_u32 v3, 155648, v3
    v_mov_b32 v5, 157188
    s_waitcnt lgkmcnt(4)
    v_mfma_f32_32x32x16_bf16 v[64:79], v[244:247], v[56:59], v[64:79]
    ds_read_b64_tr_b16 v[48:49], v12 offset:38912
    ds_read_b64_tr_b16 v[50:51], v12 offset:39424
    v_mfma_f32_32x32x16_bf16 v[80:95], v[244:247], v[60:63], v[80:95]
    ds_read_b64_tr_b16 v[52:53], v13 offset:38912
    ds_read_b64_tr_b16 v[54:55], v13 offset:39424
    s_waitcnt lgkmcnt(4)
    v_mfma_f32_32x32x16_bf16 v[64:79], v[248:251], v[36:39], v[64:79]
    v_mfma_f32_32x32x16_bf16 v[80:95], v[248:251], v[40:43], v[80:95]
    ds_read_b32 v6, v5
    ds_read_b32 v44, v3 offset:0
    ds_read_b32 v45, v3 offset:256
    ds_read_b32 v46, v3 offset:512
    ds_read_b32 v47, v3 offset:768
    s_waitcnt lgkmcnt(0)
    v_mfma_f32_32x32x16_bf16 v[64:79], v[252:255], v[48:51], v[64:79]
    v_mfma_f32_32x32x16_bf16 v[80:95], v[252:255], v[52:55], v[80:95]
    v_cmp_ne_u32 vcc, 4, v6
    s_cbranch_vccz p1s_32
p1s_31:
    ds_read_b32 v6, v5
    ds_read_b32 v44, v3 offset:0
    ds_read_b32 v45, v3 offset:256
    ds_read_b32 v46, v3 offset:512
    ds_read_b32 v47, v3 offset:768
    s_waitcnt lgkmcnt(0)
    v_cmp_ne_u32 vcc, 4, v6
    s_cbranch_vccnz p1s_31
p1s_32:
    v_add_f32 v44, v44, v45
    v_add_f32 v46, v46, v47
    v_add_f32 v44, v44, v46
    v_cvt_pk_bf16_f32 v2, v44, v44
    v_and_b32 v25, 0xffff0000, v2
    v_sub_f32 v25, v44, v25
    v_cvt_pk_bf16_f32 v24, v44, v25
    v_mov_b32 v25, v24
    ds_read_b128 v[48:51], v34 offset:0
    ds_read_b128 v[52:55], v34 offset:32
    ds_read_b128 v[56:59], v34 offset:64
    ds_read_b128 v[60:63], v34 offset:96
    s_nop 0
    v_mfma_f32_32x32x8_bf16 v[64:79], v[20:21], v[24:25], v[64:79]
    v_mfma_f32_32x32x8_bf16 v[80:95], v[22:23], v[24:25], v[80:95]
    s_nop 7
    s_nop 1
    s_waitcnt lgkmcnt(0)
    v_pk_mul_f32 v[64:65], v[64:65], v[48:49]
    v_pk_mul_f32 v[66:67], v[66:67], v[50:51]
    v_pk_mul_f32 v[68:69], v[68:69], v[52:53]
    v_pk_mul_f32 v[70:71], v[70:71], v[54:55]
    v_pk_mul_f32 v[72:73], v[72:73], v[56:57]
    v_pk_mul_f32 v[74:75], v[74:75], v[58:59]
    v_pk_mul_f32 v[76:77], v[76:77], v[60:61]
    v_pk_mul_f32 v[78:79], v[78:79], v[62:63]
    v_cvt_pk_bf16_f32 v64, v64, v65
    v_cvt_pk_bf16_f32 v65, v66, v67
    v_cvt_pk_bf16_f32 v66, v68, v69
    v_cvt_pk_bf16_f32 v67, v70, v71
    v_cvt_pk_bf16_f32 v68, v72, v73
    v_cvt_pk_bf16_f32 v69, v74, v75
    v_cvt_pk_bf16_f32 v70, v76, v77
    v_cvt_pk_bf16_f32 v71, v78, v79
    v_permlane32_swap_b32 v64, v66
    v_permlane32_swap_b32 v65, v67
    s_nop 0
    v_permlane32_swap_b32 v68, v70
    v_permlane32_swap_b32 v69, v71
    buffer_store_dwordx4 v[64:67], v30, s[32:35], s96 offen offset:0 sc1
    buffer_store_dwordx4 v[68:71], v30, s[32:35], s96 offen offset:640 sc1
    v_pk_mul_f32 v[80:81], v[80:81], v[48:49]
    v_pk_mul_f32 v[82:83], v[82:83], v[50:51]
    v_pk_mul_f32 v[84:85], v[84:85], v[52:53]
    v_pk_mul_f32 v[86:87], v[86:87], v[54:55]
    v_pk_mul_f32 v[88:89], v[88:89], v[56:57]
    v_pk_mul_f32 v[90:91], v[90:91], v[58:59]
    v_pk_mul_f32 v[92:93], v[92:93], v[60:61]
    v_pk_mul_f32 v[94:95], v[94:95], v[62:63]
    v_cvt_pk_bf16_f32 v80, v80, v81
    v_cvt_pk_bf16_f32 v81, v82, v83
    v_cvt_pk_bf16_f32 v82, v84, v85
    v_cvt_pk_bf16_f32 v83, v86, v87
    v_cvt_pk_bf16_f32 v84, v88, v89
    v_cvt_pk_bf16_f32 v85, v90, v91
    v_cvt_pk_bf16_f32 v86, v92, v93
    v_cvt_pk_bf16_f32 v87, v94, v95
    v_permlane32_swap_b32 v80, v82
    v_permlane32_swap_b32 v81, v83
    s_nop 0
    v_permlane32_swap_b32 v84, v86
    v_permlane32_swap_b32 v85, v87
    buffer_store_dwordx4 v[80:83], v31, s[32:35], s96 offen offset:0 sc1
    buffer_store_dwordx4 v[84:87], v31, s[32:35], s96 offen offset:640 sc1
    s_branch p2
sequential_preLN__mha_block__dense_activation_relu__prompt_kernel_end:
    s_endpgm
p1_5:
    s_mov_b32 s36, s31
    s_call_b64 s[58:59], p1_4
    v_mov_b32 v30, v26
    s_mov_b64 s[48:49], s[76:77]
    v_mov_b32 v31, v27
    s_mov_b64 s[50:51], s[78:79]
    v_mov_b32 v32, v28
    s_mov_b64 s[52:53], s[80:81]
    v_mov_b32 v33, v29
    s_mov_b64 s[54:55], s[82:83]
    s_mov_b32 s96, s43
    s_mov_b32 s97, s57
    s_setpc_b64 s[98:99]
p1_4:
    s_cmp_ge_u32 s36, 20
    s_cbranch_scc1 p1a_33
    s_lshl_b32 s27, s21, 2
    s_add_u32 s27, s27, s20
    s_mul_i32 s43, s27, 1280
    s_lshr_b32 s27, s27, 3
    s_mul_i32 s27, s27, 10240
    s_add_u32 s27, s27, 2621440
    s_cmp_lt_u32 s36, 10
    s_cselect_b32 s27, 0, s27
    s_mov_b32 s39, 163840
    s_cselect_b32 s39, 81920, s39
    s_cselect_b32 s38, 0, 10
    s_cselect_b32 s42, 0x3ea52b5c, 1.0
    s_add_u32 s43, s43, s27
    s_add_u32 s57, s43, s39
    s_sub_u32 s26, s36, s38
    s_lshl_b32 s26, s26, 3
    v_add_u32 v2, s26, v17
    v_mul_u32_u24 v3, 13108, v2
    v_lshrrev_b32 v3, 16, v3
    v_mad_i32_i24 v4, v3, -5, v2
    v_cmp_ne_u32 s[76:77], 2, v4
    v_cmp_lt_u32 vcc, 2, v4
    v_lshlrev_b32 v3, 1, v3
    v_add_u32 v2, -3, v4
    v_cndmask_b32 v4, v4, v2, vcc
    v_addc_co_u32 v3, vcc, 0, v3, vcc
    v_mul_lo_u32 v3, v3, s39
    v_lshl_add_u32 v3, v4, 9, v3
    v_lshl_add_u32 v26, v14, 1, v3
    v_add_u32 v2, s26, v17
    v_add_u32 v2, 2, v2
    v_mul_u32_u24 v3, 13108, v2
    v_lshrrev_b32 v3, 16, v3
    v_mad_i32_i24 v4, v3, -5, v2
    v_cmp_ne_u32 s[78:79], 2, v4
    v_cmp_lt_u32 vcc, 2, v4
    v_lshlrev_b32 v3, 1, v3
    v_add_u32 v2, -3, v4
    v_cndmask_b32 v4, v4, v2, vcc
    v_addc_co_u32 v3, vcc, 0, v3, vcc
    v_mul_lo_u32 v3, v3, s39
    v_lshl_add_u32 v3, v4, 9, v3
    v_lshl_add_u32 v27, v14, 1, v3
    v_add_u32 v2, s26, v17
    v_add_u32 v2, 4, v2
    v_mul_u32_u24 v3, 13108, v2
    v_lshrrev_b32 v3, 16, v3
    v_mad_i32_i24 v4, v3, -5, v2
    v_cmp_ne_u32 s[80:81], 2, v4
    v_cmp_lt_u32 vcc, 2, v4
    v_lshlrev_b32 v3, 1, v3
    v_add_u32 v2, -3, v4
    v_cndmask_b32 v4, v4, v2, vcc
    v_addc_co_u32 v3, vcc, 0, v3, vcc
    v_mul_lo_u32 v3, v3, s39
    v_lshl_add_u32 v3, v4, 9, v3
    v_lshl_add_u32 v28, v14, 1, v3
    v_add_u32 v2, s26, v17
    v_add_u32 v2, 6, v2
    v_mul_u32_u24 v3, 13108, v2
    v_lshrrev_b32 v3, 16, v3
    v_mad_i32_i24 v4, v3, -5, v2
    v_cmp_ne_u32 s[82:83], 2, v4
    v_cmp_lt_u32 vcc, 2, v4
    v_lshlrev_b32 v3, 1, v3
    v_add_u32 v2, -3, v4
    v_cndmask_b32 v4, v4, v2, vcc
    v_addc_co_u32 v3, vcc, 0, v3, vcc
    v_mul_lo_u32 v3, v3, s39
    v_lshl_add_u32 v3, v4, 9, v3
    v_lshl_add_u32 v29, v14, 1, v3
    s_setpc_b64 s[58:59]
p1a_33:
    s_sub_u32 s38, s36, 20
    s_lshl_b32 s38, s38, 6
    v_lshrrev_b32 v4, 3, v14
    v_add_u32 v4, s38, v4
    v_mul_u32_u24 v5, 3277, v4
    v_lshrrev_b32 v5, 16, v5
    v_mul_u32_u24 v6, 20, v5
    v_sub_u32 v4, v4, v6
    v_mul_u32_u24 v5, 163840, v5
    v_lshl_add_u32 v5, v4, 5, v5
    v_lshl_add_u32 v26, v17, 4, v5
    v_mov_b32 v28, 0
    s_add_u32 s38, s38, 32
    v_lshrrev_b32 v4, 3, v14
    v_add_u32 v4, s38, v4
    v_mul_u32_u24 v5, 3277, v4
    v_lshrrev_b32 v5, 16, v5
    v_mul_u32_u24 v6, 20, v5
    v_sub_u32 v4, v4, v6
    v_mul_u32_u24 v5, 163840, v5
    v_lshl_add_u32 v5, v4, 5, v5
    v_lshl_add_u32 v27, v17, 4, v5
    v_mov_b32 v29, 0
    s_add_u32 s38, s38, 32
    s_lshr_b32 s27, s21, 1
    s_mul_i32 s27, s27, 20480
    s_and_b32 s38, s21, 1
    s_lshl_b32 s38, s38, 2
    s_add_u32 s38, s38, s20
    s_mul_i32 s38, s38, 1280
    s_add_u32 s43, s27, s38
    s_add_u32 s43, s43, 2631680
    s_mov_b32 s57, s43
    s_setpc_b64 s[58:59]
p1_3:
    v_mov_b32 v243, 0x3f803f80
    v_mov_b32 v241, 0
    v_mov_b32 v242, 0
    s_lshr_b32 s38, s56, 4
    s_lshl_b32 s38, s38, 10
    s_and_b32 s40, s56, 15
    s_lshl_b32 s40, s40, 5
    s_add_u32 s38, s38, s40
    s_add_u32 s38, s38, 25663488
    v_lshlrev_b32 v240, 2, v240
    s_waitcnt vmcnt(0)
    v_dot2c_f32_bf16 v241, v200, v243
    v_dot2c_f32_bf16 v242, v200, v200
    v_dot2c_f32_bf16 v241, v201, v243
    v_dot2c_f32_bf16 v242, v201, v201
    v_dot2c_f32_bf16 v241, v202, v243
    v_dot2c_f32_bf16 v242, v202, v202
    v_dot2c_f32_bf16 v241, v203, v243
    v_dot2c_f32_bf16 v242, v203, v203
    v_dot2c_f32_bf16 v241, v204, v243
    v_dot2c_f32_bf16 v242, v204, v204
    v_dot2c_f32_bf16 v241, v205, v243
    v_dot2c_f32_bf16 v242, v205, v205
    v_dot2c_f32_bf16 v241, v206, v243
    v_dot2c_f32_bf16 v242, v206, v206
    v_dot2c_f32_bf16 v241, v207, v243
    v_dot2c_f32_bf16 v242, v207, v207
    v_dot2c_f32_bf16 v241, v208, v243
    v_dot2c_f32_bf16 v242, v208, v208
    v_dot2c_f32_bf16 v241, v209, v243
    v_dot2c_f32_bf16 v242, v209, v209
    v_dot2c_f32_bf16 v241, v210, v243
    v_dot2c_f32_bf16 v242, v210, v210
    v_dot2c_f32_bf16 v241, v211, v243
    v_dot2c_f32_bf16 v242, v211, v211
    v_dot2c_f32_bf16 v241, v212, v243
    v_dot2c_f32_bf16 v242, v212, v212
    v_dot2c_f32_bf16 v241, v213, v243
    v_dot2c_f32_bf16 v242, v213, v213
    v_dot2c_f32_bf16 v241, v214, v243
    v_dot2c_f32_bf16 v242, v214, v214
    v_dot2c_f32_bf16 v241, v215, v243
    v_dot2c_f32_bf16 v242, v215, v215
    v_dot2c_f32_bf16 v241, v216, v243
    v_dot2c_f32_bf16 v242, v216, v216
    v_dot2c_f32_bf16 v241, v217, v243
    v_dot2c_f32_bf16 v242, v217, v217
    v_dot2c_f32_bf16 v241, v218, v243
    v_dot2c_f32_bf16 v242, v218, v218
    v_dot2c_f32_bf16 v241, v219, v243
    v_dot2c_f32_bf16 v242, v219, v219
    v_dot2c_f32_bf16 v241, v220, v243
    v_dot2c_f32_bf16 v242, v220, v220
    v_dot2c_f32_bf16 v241, v221, v243
    v_dot2c_f32_bf16 v242, v221, v221
    v_dot2c_f32_bf16 v241, v222, v243
    v_dot2c_f32_bf16 v242, v222, v222
    v_dot2c_f32_bf16 v241, v223, v243
    v_dot2c_f32_bf16 v242, v223, v223
    v_dot2c_f32_bf16 v241, v224, v243
    v_dot2c_f32_bf16 v242, v224, v224
    v_dot2c_f32_bf16 v241, v225, v243
    v_dot2c_f32_bf16 v242, v225, v225
    v_dot2c_f32_bf16 v241, v226, v243
    v_dot2c_f32_bf16 v242, v226, v226
    v_dot2c_f32_bf16 v241, v227, v243
    v_dot2c_f32_bf16 v242, v227, v227
    v_dot2c_f32_bf16 v241, v228, v243
    v_dot2c_f32_bf16 v242, v228, v228
    v_dot2c_f32_bf16 v241, v229, v243
    v_dot2c_f32_bf16 v242, v229, v229
    v_dot2c_f32_bf16 v241, v230, v243
    v_dot2c_f32_bf16 v242, v230, v230
    v_dot2c_f32_bf16 v241, v231, v243
    v_dot2c_f32_bf16 v242, v231, v231
    v_dot2c_f32_bf16 v241, v232, v243
    v_dot2c_f32_bf16 v242, v232, v232
    v_dot2c_f32_bf16 v241, v233, v243
    v_dot2c_f32_bf16 v242, v233, v233
    v_dot2c_f32_bf16 v241, v234, v243
    v_dot2c_f32_bf16 v242, v234, v234
    v_dot2c_f32_bf16 v241, v235, v243
    v_dot2c_f32_bf16 v242, v235, v235
    v_dot2c_f32_bf16 v241, v236, v243
    v_dot2c_f32_bf16 v242, v236, v236
    v_dot2c_f32_bf16 v241, v237, v243
    v_dot2c_f32_bf16 v242, v237, v237
    v_dot2c_f32_bf16 v241, v238, v243
    v_dot2c_f32_bf16 v242, v238, v238
    v_dot2c_f32_bf16 v241, v239, v243
    v_dot2c_f32_bf16 v242, v239, v239
    s_nop 2
    v_add_f32_dpp v241, v241, v241 quad_perm:[1,0,3,2] row_mask:0xf bank_mask:0xf
    v_add_f32_dpp v242, v242, v242 quad_perm:[1,0,3,2] row_mask:0xf bank_mask:0xf
    s_nop 0
    v_add_f32_dpp v241, v241, v241 quad_perm:[2,3,0,1] row_mask:0xf bank_mask:0xf
    v_add_f32_dpp v242, v242, v242 quad_perm:[2,3,0,1] row_mask:0xf bank_mask:0xf
    s_nop 0
    v_add_f32_dpp v241, v241, v241 row_half_mirror row_mask:0xf bank_mask:0xf
    v_add_f32_dpp v242, v242, v242 row_half_mirror row_mask:0xf bank_mask:0xf
    s_nop 0
    v_mul_f32 v241, 0xbacccccd, v241
    v_mul_f32 v242, 0x3acccccd, v242
    v_fma_f32 v242, -v241, v241, v242
    v_max_f32 v242, 0, v242
    v_add_f32 v242, 0x3727c5ac, v242
    v_rsq_f32 v242, v242
    s_mov_b32 exec_lo, 0x01010101
    s_mov_b32 exec_hi, 0x01010101
    buffer_store_dword v241, v240, s[32:35], s38 offen sc1
    buffer_store_dword v242, v240, s[32:35], s38 offen offset:512 sc1
    s_mov_b64 exec, 1
    buffer_load_dword v15, v0, s[44:47], 0 offen sc1
    s_mov_b64 exec, -1
    s_setpc_b64 s[58:59]
p1_14:
    s_lshr_b32 s38, s56, 4
    s_lshl_b32 s38, s38, 8
    s_and_b32 s40, s56, 15
    s_lshl_b32 s40, s40, 2
    s_add_u32 s38, s38, s40
    s_add_u32 s38, s38, 25679872
    s_mov_b32 s40, 0
    s_mov_b64 exec, 1
    s_branch p1f_35
p1f_34:
    buffer_load_dword v15, v0, s[44:47], 0 offen sc1
    s_add_u32 s40, s40, 1
    s_cmp_gt_u32 s40, 200000
    s_cbranch_scc1 p1f_36
p1f_35:
    s_waitcnt vmcnt(0)
    v_cmp_ne_u32 vcc, 1, v15
    s_cbranch_vccnz p1f_34
    buffer_store_dword v15, v0, s[32:35], s38 offen sc1
p1f_36:
    s_mov_b64 exec, -1
    s_setpc_b64 s[58:59]
p1_15:
    s_mov_b32 s40, 0
    s_branch p1c_38
p1c_37:
    buffer_load_dword v15, v16, s[32:35], 0 offen sc1
    s_add_u32 s40, s40, 1
    s_cmp_gt_u32 s40, 200000
    s_cbranch_scc1 p1c_39
p1c_38:
    s_waitcnt vmcnt(0)
    v_cmp_ne_u32 vcc, 1, v15
    s_cbranch_vccnz p1c_37
p1c_39:
    v_lshrrev_b32 v3, 1, v14
    buffer_load_dword v18, v3, s[32:35], s41 offen sc1
    buffer_load_dword v19, v3, s[32:35], s41 offen offset:512 sc1
    s_setpc_b64 s[58:59]
p1_1:
    s_cmp_ge_u32 s2, 256
    s_cbranch_scc1 sequential_preLN__mha_block__dense_activation_relu__prompt_kernel_end
    s_load_dwordx2 s[4:5], s[0:1], 0
    s_load_dwordx2 s[50:51], s[0:1], 8
    s_load_dwordx4 s[8:11], s[0:1], 56
    s_cmp_ge_u32 s2, 248
    s_cbranch_scc1 p1h_41
    s_getpc_b64 s[6:7]
p1h_40:
    s_sub_u32 s6, s6, p1h_40-sequential_preLN__mha_block__dense_activation_relu__prompt_kernel
    s_subb_u32 s7, s7, 0
    v_subrev_u32 v1, 64, v0
    v_lshlrev_b32 v1, 7, v1
    v_cmp_gt_u32 vcc, code_end-sequential_preLN__mha_block__dense_activation_relu__prompt_kernel, v1
    s_and_saveexec_b64 s[52:53], vcc
    s_cbranch_execz p1h_41
    global_load_dword v2, v1, s[6:7]
p1h_41:
    s_mov_b64 exec, -1
    v_lshrrev_b32 v3, 6, v0
    s_waitcnt lgkmcnt(0)
    v_readfirstlane_b32 s20, v3
    s_mov_b32 s12, s4
    s_mov_b32 s13, s5
    s_mov_b32 s14, 2621440
    s_mov_b32 s15, 0x20000
    s_mov_b32 s32, s10
    s_mov_b32 s33, s11
    s_mov_b32 s34, 25794560
    s_mov_b32 s35, 0x20000
    s_mov_b32 s44, s8
    s_mov_b32 s45, s9
    s_mov_b32 s46, 256
    s_mov_b32 s47, 0x20000
    s_cmp_lg_u32 s2, 255
    s_cbranch_scc1 p1z_42
    v_mov_b32 v20, 0
    v_mov_b32 v21, 0
    v_mov_b32 v22, 0
    v_mov_b32 v23, 0
    v_lshlrev_b32 v4, 4, v0
    s_mov_b32 s27, 25679872
    buffer_store_dwordx4 v[20:23], v4, s[32:35], s27 offen sc1
    v_lshrrev_b32 v6, 1, v0
    v_lshlrev_b32 v6, 8, v6
    v_and_b32 v5, 1, v0
    v_lshl_add_u32 v6, v5, 4, v6
    s_mov_b32 s27, 25683968
    buffer_store_dwordx4 v[20:23], v6, s[32:35], s27 offen sc1
    buffer_store_dwordx4 v[20:23], v6, s[32:35], s27 offen offset:128 sc1
    v_mov_b32 v5, 1
    s_waitcnt vmcnt(0)
    s_barrier
    s_cmp_lg_u32 s20, 0
    s_cbranch_scc1 p1z_43
    s_mov_b64 exec, 1
    buffer_store_dword v5, v0, s[44:47], 0 offen sc1
    s_mov_b64 exec, -1
p1z_43:
    s_mov_b32 s27, 25749504
    buffer_store_dwordx4 v[20:23], v4, s[32:35], s27 offen sc1
    s_add_u32 s27, s27, 8192
    buffer_store_dwordx4 v[20:23], v4, s[32:35], s27 offen sc1
    s_add_u32 s27, s27, 8192
    buffer_store_dwordx4 v[20:23], v4, s[32:35], s27 offen sc1
    s_add_u32 s27, s27, 8192
    buffer_store_dwordx4 v[20:23], v4, s[32:35], s27 offen sc1
    s_add_u32 s27, s27, 8192
    buffer_store_dwordx4 v[20:23], v4, s[32:35], s27 offen sc1
    s_add_u32 s27, s27, 8192
p1z_42:
    s_cmp_lg_u32 s20, 0
    s_cbranch_scc1 p1z_44
    s_and_b32 s56, s2, 7
    s_lshl_b32 s56, s56, 5
    s_lshr_b32 s38, s2, 3
    s_add_u32 s56, s56, s38
    s_mul_i32 s38, s56, 10240
    v_lshrrev_b32 v240, 3, v0
    v_mul_u32_u24 v241, 1280, v240
    v_and_b32 v242, 7, v0
    v_lshl_add_u32 v241, v242, 4, v241
    buffer_load_dwordx4 v[200:203], v241, s[12:15], s38 offen offset:0
    buffer_load_dwordx4 v[204:207], v241, s[12:15], s38 offen offset:128
    buffer_load_dwordx4 v[208:211], v241, s[12:15], s38 offen offset:256
    buffer_load_dwordx4 v[212:215], v241, s[12:15], s38 offen offset:384
    buffer_load_dwordx4 v[216:219], v241, s[12:15], s38 offen offset:512
    buffer_load_dwordx4 v[220:223], v241, s[12:15], s38 offen offset:640
    buffer_load_dwordx4 v[224:227], v241, s[12:15], s38 offen offset:768
    buffer_load_dwordx4 v[228:231], v241, s[12:15], s38 offen offset:896
    buffer_load_dwordx4 v[232:235], v241, s[12:15], s38 offen offset:1024
    buffer_load_dwordx4 v[236:239], v241, s[12:15], s38 offen offset:1152
    s_call_b64 s[58:59], p1_3
    s_call_b64 s[58:59], p1_14
    s_bfe_u32 s27, s2, 0x50002
    s_lshl_b32 s27, s27, 8
    s_lshr_b32 s38, s2, 7
    s_lshl_b32 s38, s38, 4
    s_add_u32 s27, s27, s38
    s_and_b32 s38, s2, 3
    s_lshl_b32 s38, s38, 2
    s_add_u32 s27, s27, s38
    s_add_u32 s27, s27, 25683968
    v_and_b32 v2, 63, v0
    v_lshlrev_b32 v2, 13, v2
    v_mov_b32 v3, 1
    s_mov_b64 exec, 0xff
    buffer_store_dword v3, v2, s[32:35], s27 offen sc1
    s_mov_b64 exec, -1
    s_barrier
    s_bfe_u32 s27, s2, 0x50002
    s_lshl_b32 s27, s27, 8
    s_lshr_b32 s38, s2, 7
    s_lshl_b32 s38, s38, 4
    s_add_u32 s27, s27, s38
    s_and_b32 s38, s2, 3
    s_lshl_b32 s38, s38, 2
    s_add_u32 s27, s27, s38
    s_add_u32 s27, s27, 25684096
    v_and_b32 v2, 63, v0
    v_lshlrev_b32 v2, 13, v2
    v_mov_b32 v3, 1
    s_mov_b64 exec, 0xff
    buffer_store_dword v3, v2, s[32:35], s27 offen sc1
    s_mov_b64 exec, -1
    s_branch p2
p1z_44:
    s_cmp_lt_u32 s2, 248
    s_cbranch_scc1 p1z_45
    s_mov_b32 s16, s50
    s_mov_b32 s17, s51
    s_mov_b32 s18, 2457600
    s_mov_b32 s19, 0x20000
    v_and_b32 v4, 63, v0
    v_min_u32 v4, 59, v4
    v_mul_u32_u24 v5, 6554, v4
    v_lshrrev_b32 v5, 16, v5
    v_mul_u32_u24 v5, 2560, v5
    v_lshl_add_u32 v4, v4, 7, v5
    s_sub_u32 s27, s2, 248
    s_mul_i32 s27, s27, 7
    s_add_u32 s27, s27, s20
    s_sub_u32 s27, s27, 1
    s_mul_i32 s27, s27, 46080
    v_add_u32 v4, s27, v4
    v_add_u32 v5, 23040, v4
    buffer_load_dword v6, v4, s[16:19], 0 offen offset:1280 sc1
    buffer_load_dword v6, v5, s[16:19], 0 offen offset:1280 sc1
    buffer_load_dword v6, v4, s[16:19], 0 offen offset:2560 sc1
    buffer_load_dword v6, v5, s[16:19], 0 offen offset:2560 sc1
p1z_45:
    s_waitcnt vmcnt(0)
    s_barrier
    s_branch p2
p2:
    s_mov_b64 exec, -1
    s_load_dwordx2 s[4:5], s[0:1], 64
    s_load_dwordx2 s[6:7], s[0:1], 0
    s_load_dwordx8 s[48:55], s[0:1], 16
    s_load_dwordx2 s[56:57], s[0:1], 48
    v_lshrrev_b32 v6, 6, v0
    v_and_b32 v1, 63, v0
    v_readfirstlane_b32 s20, v6
    v_lshlrev_b32 v2, 4, v1
    v_lshrrev_b32 v205, 4, v1
    v_lshrrev_b32 v204, 5, v1
    v_and_b32 v206, 1, v205
    v_and_b32 v207, 15, v1
    v_and_b32 v208, 31, v1
    s_waitcnt lgkmcnt(0)
    s_mov_b32 s8, s4
    s_mov_b32 s9, s5
    s_mov_b32 s10, 25794560
    s_mov_b32 s11, 0x20000
    s_mov_b32 s12, s6
    s_mov_b32 s13, s7
    s_mov_b32 s14, 2621440
    s_mov_b32 s15, 0x20000
    s_mov_b32 s16, s4
    s_mov_b32 s17, s5
    s_mov_b32 s18, 0
    s_mov_b32 s19, 0x20000
    s_and_b32 s21, s2, 7
    s_lshr_b32 s22, s2, 3
    s_lshr_b32 s24, s20, 2
    s_lshl_b32 s96, s21, 2
    s_lshr_b32 s25, s2, 6
    s_add_u32 s96, s96, s25
    s_and_b32 s97, s22, 7
    s_mul_i32 s31, s96, 163840
    s_add_u32 s31, s31, 2621440
    s_and_b32 s26, s20, 3
    s_lshl_b32 s26, s26, 1
    s_lshl_b32 s25, s97, 3
    s_add_u32 s25, s25, s26
    s_add_u32 s23, s25, s24
    v_mov_b32 v52, 0
    v_mov_b32 v53, 0
    v_mov_b32 v54, 0
    v_mov_b32 v55, 0
    v_and_b32 v6, 0x13, v1
    v_bfe_u32 v7, v1, 2, 1
    v_lshl_add_u32 v6, v7, 3, v6
    v_bfe_u32 v7, v1, 3, 1
    v_lshl_add_u32 v6, v7, 2, v6
    s_mul_i32 s25, s24, 1280
    v_lshl_add_u32 v30, v6, 3, s25
    v_add_u32 v30, 1024, v30
    v_lshl_add_u32 v29, v6, 4, s25
    v_lshl_add_u32 v29, v204, 9, v29
    v_lshl_add_u32 v31, v208, 5, s25
    v_lshl_add_u32 v31, v204, 4, v31
    v_add_u32 v31, 10240, v31
    s_mov_b32 s44, 0xfffff
    s_mov_b32 s45, 0xfffff
    v_cmp_eq_u32 vcc, 20, v208
    v_mov_b32 v7, 0x3f803f80
    s_nop 0
    v_cndmask_b32 v60, 0, v7, vcc
    v_cndmask_b32 v61, 0, v7, vcc
    v_cndmask_b32 v62, 0, v7, vcc
    v_cndmask_b32 v63, 0, v7, vcc
    v_cndmask_b32 v64, 0, v7, vcc
    v_cndmask_b32 v65, 0, v7, vcc
    v_cndmask_b32 v66, 0, v7, vcc
    v_cndmask_b32 v67, 0, v7, vcc
    v_mov_b32 v4, 1
    s_mov_b32 s3, 0
    v_lshlrev_b32 v210, 8, v208
    v_lshl_add_u32 v210, v204, 4, v210
    s_bfe_u32 s82, s2, 0x50002
    s_lshl_b32 s82, s82, 8
    s_lshr_b32 s26, s2, 7
    s_lshl_b32 s26, s26, 4
    s_add_u32 s82, s82, s26
    s_and_b32 s26, s2, 3
    s_lshl_b32 s26, s26, 2
    s_add_u32 s82, s82, s26
    s_add_u32 s82, s82, 25684096
    s_mov_b32 s98, s21
    s_mul_i32 s30, s98, 20480
    s_add_u32 s98, s98, 1
    s_add_u32 s30, s30, s31
    s_and_b32 s98, s98, 7
    s_cmp_ge_u32 s20, 4
    s_cbranch_scc1 fu_54
    s_cmp_ge_u32 s2, 240
    s_cbranch_scc1 fu_52
    v_mov_b32 v6, 157184
    s_waitcnt vmcnt(0)
    s_mov_b64 exec, 1
    ds_add_rtn_u32 v7, v6, v4
    s_waitcnt lgkmcnt(0)
    v_cmp_eq_u32 vcc, 3, v7
    s_mov_b64 exec, -1
    s_cbranch_vccz fu_52
    v_lshlrev_b32 v6, 13, v1
    s_mov_b64 exec, 0xff
    buffer_store_dword v4, v6, s[8:11], s82 offen sc1
    s_mov_b64 exec, -1
    s_branch fu_52
fu_54:
    s_cmp_lg_u32 s20, 7
    s_cbranch_scc1 fu_55
    s_sleep 8
    s_lshl_b32 s25, s21, 13
    s_add_u32 s25, s25, 25683968
    s_mov_b32 s26, 0
fu_56:
    buffer_load_dwordx4 v[168:171], v210, s[8:11], s25 offen sc1
    s_add_u32 s26, s26, 1
    s_cmp_gt_u32 s26, 200000
    s_cbranch_scc1 fu_57
    s_waitcnt vmcnt(0)
    v_min3_u32 v8, v168, v169, v170
    v_min_u32 v8, v8, v171
    v_cmp_eq_u32 vcc, 0, v8
    s_cbranch_vccz fu_57
    s_sleep 4
    s_branch fu_56
fu_57:
    s_mul_i32 s27, s96, 81920
    s_mul_i32 s26, s97, 10240
    s_add_u32 s27, s27, s26
    s_mov_b32 m0, 0
    s_add_u32 s25, s27, 0
    buffer_load_dwordx4 v2, s[8:11], s25 offen offset:0 sc1 lds
    buffer_load_dwordx4 v2, s[8:11], s25 offen offset:1024 sc1 lds
    buffer_load_dwordx4 v2, s[8:11], s25 offen offset:2048 sc1 lds
    buffer_load_dwordx4 v2, s[8:11], s25 offen offset:3072 sc1 lds
    s_mov_b32 m0, 4096
    s_add_u32 s25, s27, 4096
    buffer_load_dwordx4 v2, s[8:11], s25 offen offset:0 sc1 lds
    buffer_load_dwordx4 v2, s[8:11], s25 offen offset:1024 sc1 lds
    buffer_load_dwordx4 v2, s[8:11], s25 offen offset:2048 sc1 lds
    buffer_load_dwordx4 v2, s[8:11], s25 offen offset:3072 sc1 lds
    s_mov_b32 m0, 8192
    s_add_u32 s25, s27, 8192
    buffer_load_dwordx4 v2, s[8:11], s25 offen offset:0 sc1 lds
    buffer_load_dwordx4 v2, s[8:11], s25 offen offset:1024 sc1 lds
    s_mov_b32 m0, 20480
    s_add_u32 s25, s30, 0
    buffer_load_dwordx4 v2, s[8:11], s25 offen offset:0 sc1 lds
    buffer_load_dwordx4 v2, s[8:11], s25 offen offset:1024 sc1 lds
    buffer_load_dwordx4 v2, s[8:11], s25 offen offset:2048 sc1 lds
    buffer_load_dwordx4 v2, s[8:11], s25 offen offset:3072 sc1 lds
    s_mov_b32 m0, 24576
    s_add_u32 s25, s30, 4096
    buffer_load_dwordx4 v2, s[8:11], s25 offen offset:0 sc1 lds
    buffer_load_dwordx4 v2, s[8:11], s25 offen offset:1024 sc1 lds
    buffer_load_dwordx4 v2, s[8:11], s25 offen offset:2048 sc1 lds
    buffer_load_dwordx4 v2, s[8:11], s25 offen offset:3072 sc1 lds
    s_mov_b32 m0, 28672
    s_add_u32 s25, s30, 8192
    buffer_load_dwordx4 v2, s[8:11], s25 offen offset:0 sc1 lds
    buffer_load_dwordx4 v2, s[8:11], s25 offen offset:1024 sc1 lds
    buffer_load_dwordx4 v2, s[8:11], s25 offen offset:2048 sc1 lds
    buffer_load_dwordx4 v2, s[8:11], s25 offen offset:3072 sc1 lds
    s_mov_b32 m0, 32768
    s_add_u32 s25, s30, 12288
    buffer_load_dwordx4 v2, s[8:11], s25 offen offset:0 sc1 lds
    buffer_load_dwordx4 v2, s[8:11], s25 offen offset:1024 sc1 lds
    buffer_load_dwordx4 v2, s[8:11], s25 offen offset:2048 sc1 lds
    buffer_load_dwordx4 v2, s[8:11], s25 offen offset:3072 sc1 lds
    s_mov_b32 m0, 36864
    s_add_u32 s25, s30, 16384
    buffer_load_dwordx4 v2, s[8:11], s25 offen offset:0 sc1 lds
    buffer_load_dwordx4 v2, s[8:11], s25 offen offset:1024 sc1 lds
    buffer_load_dwordx4 v2, s[8:11], s25 offen offset:2048 sc1 lds
    buffer_load_dwordx4 v2, s[8:11], s25 offen offset:3072 sc1 lds
fu_55:
    s_call_b64 s[100:101], su_53
    s_waitcnt vmcnt(0)
fu_52:
    s_and_b32 s26, s23, 7
    s_mul_i32 s25, s26, 1280
    s_xor_b32 s26, s26, 1
    s_mul_i32 s26, s26, 1280
    v_add_u32 v6, s26, v2
    v_add_u32 v7, s25, v2
    v_lshl_add_u32 v8, v1, 3, s26
    v_lshl_add_u32 v9, v1, 3, s25
    s_barrier
    ds_read_b128 v[44:47], v6
    ds_read_b128 v[48:51], v7
    s_mov_b32 exec_hi, 0
    ds_read_b64 v[52:53], v8 offset:1024
    ds_read_b64 v[54:55], v9 offset:1024
    s_mov_b32 exec_hi, -1
    ds_read_b128 v[56:59], v29 offset:20480
    ds_read_b64 v[68:69], v30 offset:20480
    s_waitcnt lgkmcnt(0)
    v_mfma_f32_32x32x8_bf16 v[120:135], v[68:69], v[52:53], 0
    v_mfma_f32_32x32x16_bf16 v[120:135], v[56:59], v[44:47], v[120:135]
    s_nop 7
    s_mul_i32 s30, s98, 20480
    s_add_u32 s98, s98, 1
    s_add_u32 s30, s30, s31
    s_and_b32 s98, s98, 7
    s_setprio 2
    v_mfma_f32_32x32x8_bf16 v[136:151], v[68:69], v[54:55], 0
    v_exp_f32 v120, v120
    v_exp_f32 v121, v121
    v_exp_f32 v122, v122
    v_exp_f32 v123, v123
    v_cvt_pk_bf16_f32 v104, v120, v121
    v_cvt_pk_bf16_f32 v105, v122, v123
    v_mfma_f32_32x32x16_bf16 v[136:151], v[56:59], v[48:51], v[136:151]
    ds_read_b128 v[56:59], v29 offset:23040
    ds_read_b64 v[68:69], v30 offset:23040
    v_exp_f32 v124, v124
    v_exp_f32 v125, v125
    v_exp_f32 v126, v126
    v_exp_f32 v127, v127
    v_cvt_pk_bf16_f32 v106, v124, v125
    v_cvt_pk_bf16_f32 v107, v126, v127
    v_exp_f32 v128, v128
    v_exp_f32 v129, v129
    v_exp_f32 v130, v130
    v_exp_f32 v131, v131
    v_cvt_pk_bf16_f32 v108, v128, v129
    v_cvt_pk_bf16_f32 v109, v130, v131
    s_mov_b64 exec, s[44:45]
    ds_read_b128 v[60:63], v31 offset:20480
    ds_read_b128 v[64:67], v31 offset:21120
    s_mov_b64 exec, -1
    v_exp_f32 v132, v132
    v_exp_f32 v133, v133
    v_exp_f32 v134, v134
    v_exp_f32 v135, v135
    v_cvt_pk_bf16_f32 v110, v132, v133
    v_cvt_pk_bf16_f32 v111, v134, v135
    s_waitcnt lgkmcnt(2)
    v_mfma_f32_32x32x8_bf16 v[120:135], v[68:69], v[52:53], 0
    v_exp_f32 v136, v136
    v_exp_f32 v137, v137
    v_exp_f32 v138, v138
    v_exp_f32 v139, v139
    v_cvt_pk_bf16_f32 v112, v136, v137
    v_cvt_pk_bf16_f32 v113, v138, v139
    v_mfma_f32_32x32x16_bf16 v[120:135], v[56:59], v[44:47], v[120:135]
    v_exp_f32 v140, v140
    v_exp_f32 v141, v141
    v_exp_f32 v142, v142
    v_exp_f32 v143, v143
    v_cvt_pk_bf16_f32 v114, v140, v141
    v_cvt_pk_bf16_f32 v115, v142, v143
    s_waitcnt lgkmcnt(0)
    v_mfma_f32_32x32x16_bf16 v[72:87], v[60:63], v[104:107], 0
    v_exp_f32 v144, v144
    v_exp_f32 v145, v145
    v_exp_f32 v146, v146
    v_exp_f32 v147, v147
    v_cvt_pk_bf16_f32 v116, v144, v145
    v_cvt_pk_bf16_f32 v117, v146, v147
    v_mfma_f32_32x32x16_bf16 v[72:87], v[64:67], v[108:111], v[72:87]
    s_cmp_lg_u32 s20, 7
    s_cbranch_scc1 fu_58
    s_lshl_b32 s25, s21, 13
    s_add_u32 s25, s25, 25684096
    s_mov_b32 s26, 0
fu_59:
    buffer_load_dwordx4 v[168:171], v210, s[8:11], s25 offen sc1
    s_add_u32 s26, s26, 1
    s_cmp_gt_u32 s26, 200000
    s_cbranch_scc1 fu_60
    s_waitcnt vmcnt(0)
    v_min3_u32 v8, v168, v169, v170
    v_min_u32 v8, v8, v171
    v_cmp_eq_u32 vcc, 0, v8
    s_cbranch_vccz fu_60
    s_sleep 4
    s_branch fu_59
fu_60:
    s_mov_b32 m0, 40960
    s_add_u32 s25, s30, 0
    buffer_load_dwordx4 v2, s[8:11], s25 offen offset:0 sc1 lds
    buffer_load_dwordx4 v2, s[8:11], s25 offen offset:1024 sc1 lds
    buffer_load_dwordx4 v2, s[8:11], s25 offen offset:2048 sc1 lds
    buffer_load_dwordx4 v2, s[8:11], s25 offen offset:3072 sc1 lds
    s_mov_b32 m0, 45056
    s_add_u32 s25, s30, 4096
    buffer_load_dwordx4 v2, s[8:11], s25 offen offset:0 sc1 lds
    buffer_load_dwordx4 v2, s[8:11], s25 offen offset:1024 sc1 lds
    buffer_load_dwordx4 v2, s[8:11], s25 offen offset:2048 sc1 lds
    buffer_load_dwordx4 v2, s[8:11], s25 offen offset:3072 sc1 lds
    s_mov_b32 m0, 49152
    s_add_u32 s25, s30, 8192
    buffer_load_dwordx4 v2, s[8:11], s25 offen offset:0 sc1 lds
    buffer_load_dwordx4 v2, s[8:11], s25 offen offset:1024 sc1 lds
    buffer_load_dwordx4 v2, s[8:11], s25 offen offset:2048 sc1 lds
    buffer_load_dwordx4 v2, s[8:11], s25 offen offset:3072 sc1 lds
    s_mov_b32 m0, 53248
    s_add_u32 s25, s30, 12288
    buffer_load_dwordx4 v2, s[8:11], s25 offen offset:0 sc1 lds
    buffer_load_dwordx4 v2, s[8:11], s25 offen offset:1024 sc1 lds
    buffer_load_dwordx4 v2, s[8:11], s25 offen offset:2048 sc1 lds
    buffer_load_dwordx4 v2, s[8:11], s25 offen offset:3072 sc1 lds
    s_mov_b32 m0, 57344
    s_add_u32 s25, s30, 16384
    buffer_load_dwordx4 v2, s[8:11], s25 offen offset:0 sc1 lds
    buffer_load_dwordx4 v2, s[8:11], s25 offen offset:1024 sc1 lds
    buffer_load_dwordx4 v2, s[8:11], s25 offen offset:2048 sc1 lds
    buffer_load_dwordx4 v2, s[8:11], s25 offen offset:3072 sc1 lds
fu_58:
    v_exp_f32 v148, v148
    v_exp_f32 v149, v149
    v_exp_f32 v150, v150
    v_exp_f32 v151, v151
    v_cvt_pk_bf16_f32 v118, v148, v149
    v_cvt_pk_bf16_f32 v119, v150, v151
    s_setprio 1
    v_mfma_f32_32x32x8_bf16 v[136:151], v[68:69], v[54:55], 0
    v_exp_f32 v120, v120
    v_exp_f32 v121, v121
    v_exp_f32 v122, v122
    v_exp_f32 v123, v123
    v_cvt_pk_bf16_f32 v104, v120, v121
    v_cvt_pk_bf16_f32 v105, v122, v123
    v_mfma_f32_32x32x16_bf16 v[136:151], v[56:59], v[48:51], v[136:151]
    ds_read_b128 v[56:59], v29 offset:25600
    ds_read_b64 v[68:69], v30 offset:25600
    v_exp_f32 v124, v124
    v_exp_f32 v125, v125
    v_exp_f32 v126, v126
    v_exp_f32 v127, v127
    v_cvt_pk_bf16_f32 v106, v124, v125
    v_cvt_pk_bf16_f32 v107, v126, v127
    v_mfma_f32_32x32x16_bf16 v[88:103], v[60:63], v[112:115], 0
    v_exp_f32 v128, v128
    v_exp_f32 v129, v129
    v_exp_f32 v130, v130
    v_exp_f32 v131, v131
    v_cvt_pk_bf16_f32 v108, v128, v129
    v_cvt_pk_bf16_f32 v109, v130, v131
    v_mfma_f32_32x32x16_bf16 v[88:103], v[64:67], v[116:119], v[88:103]
    s_mov_b64 exec, s[44:45]
    ds_read_b128 v[60:63], v31 offset:23040
    ds_read_b128 v[64:67], v31 offset:23680
    s_mov_b64 exec, -1
    v_exp_f32 v132, v132
    v_exp_f32 v133, v133
    v_exp_f32 v134, v134
    v_exp_f32 v135, v135
    v_cvt_pk_bf16_f32 v110, v132, v133
    v_cvt_pk_bf16_f32 v111, v134, v135
    s_waitcnt lgkmcnt(2)
    v_mfma_f32_32x32x8_bf16 v[120:135], v[68:69], v[52:53], 0
    v_exp_f32 v136, v136
    v_exp_f32 v137, v137
    v_exp_f32 v138, v138
    v_exp_f32 v139, v139
    v_cvt_pk_bf16_f32 v112, v136, v137
    v_cvt_pk_bf16_f32 v113, v138, v139
    v_mfma_f32_32x32x16_bf16 v[120:135], v[56:59], v[44:47], v[120:135]
    v_exp_f32 v140, v140
    v_exp_f32 v141, v141
    v_exp_f32 v142, v142
    v_exp_f32 v143, v143
    v_cvt_pk_bf16_f32 v114, v140, v141
    v_cvt_pk_bf16_f32 v115, v142, v143
    s_waitcnt lgkmcnt(0)
    v_mfma_f32_32x32x16_bf16 v[72:87], v[60:63], v[104:107], v[72:87]
    v_exp_f32 v144, v144
    v_exp_f32 v145, v145
    v_exp_f32 v146, v146
    v_exp_f32 v147, v147
    v_cvt_pk_bf16_f32 v116, v144, v145
    v_cvt_pk_bf16_f32 v117, v146, v147
    v_mfma_f32_32x32x16_bf16 v[72:87], v[64:67], v[108:111], v[72:87]
    v_exp_f32 v148, v148
    v_exp_f32 v149, v149
    v_exp_f32 v150, v150
    v_exp_f32 v151, v151
    v_cvt_pk_bf16_f32 v118, v148, v149
    v_cvt_pk_bf16_f32 v119, v150, v151
    s_setprio 0
    v_mfma_f32_32x32x8_bf16 v[136:151], v[68:69], v[54:55], 0
    v_exp_f32 v120, v120
    v_exp_f32 v121, v121
    v_exp_f32 v122, v122
    v_exp_f32 v123, v123
    v_cvt_pk_bf16_f32 v104, v120, v121
    v_cvt_pk_bf16_f32 v105, v122, v123
    v_mfma_f32_32x32x16_bf16 v[136:151], v[56:59], v[48:51], v[136:151]
    ds_read_b128 v[56:59], v29 offset:28160
    ds_read_b64 v[68:69], v30 offset:28160
    v_exp_f32 v124, v124
    v_exp_f32 v125, v125
    v_exp_f32 v126, v126
    v_exp_f32 v127, v127
    v_cvt_pk_bf16_f32 v106, v124, v125
    v_cvt_pk_bf16_f32 v107, v126, v127
    v_mfma_f32_32x32x16_bf16 v[88:103], v[60:63], v[112:115], v[88:103]
    v_exp_f32 v128, v128
    v_exp_f32 v129, v129
    v_exp_f32 v130, v130
    v_exp_f32 v131, v131
    v_cvt_pk_bf16_f32 v108, v128, v129
    v_cvt_pk_bf16_f32 v109, v130, v131
    v_mfma_f32_32x32x16_bf16 v[88:103], v[64:67], v[116:119], v[88:103]
    s_mov_b64 exec, s[44:45]
    ds_read_b128 v[60:63], v31 offset:25600
    ds_read_b128 v[64:67], v31 offset:26240
    s_mov_b64 exec, -1
    v_exp_f32 v132, v132
    v_exp_f32 v133, v133
    v_exp_f32 v134, v134
    v_exp_f32 v135, v135
    v_cvt_pk_bf16_f32 v110, v132, v133
    v_cvt_pk_bf16_f32 v111, v134, v135
    s_waitcnt lgkmcnt(2)
    v_mfma_f32_32x32x8_bf16 v[120:135], v[68:69], v[52:53], 0
    v_exp_f32 v136, v136
    v_exp_f32 v137, v137
    v_exp_f32 v138, v138
    v_exp_f32 v139, v139
    v_cvt_pk_bf16_f32 v112, v136, v137
    v_cvt_pk_bf16_f32 v113, v138, v139
    v_mfma_f32_32x32x16_bf16 v[120:135], v[56:59], v[44:47], v[120:135]
    v_exp_f32 v140, v140
    v_exp_f32 v141, v141
    v_exp_f32 v142, v142
    v_exp_f32 v143, v143
    v_cvt_pk_bf16_f32 v114, v140, v141
    v_cvt_pk_bf16_f32 v115, v142, v143
    s_waitcnt lgkmcnt(0)
    v_mfma_f32_32x32x16_bf16 v[72:87], v[60:63], v[104:107], v[72:87]
    v_exp_f32 v144, v144
    v_exp_f32 v145, v145
    v_exp_f32 v146, v146
    v_exp_f32 v147, v147
    v_cvt_pk_bf16_f32 v116, v144, v145
    v_cvt_pk_bf16_f32 v117, v146, v147
    v_mfma_f32_32x32x16_bf16 v[72:87], v[64:67], v[108:111], v[72:87]
    v_exp_f32 v148, v148
    v_exp_f32 v149, v149
    v_exp_f32 v150, v150
    v_exp_f32 v151, v151
    v_cvt_pk_bf16_f32 v118, v148, v149
    v_cvt_pk_bf16_f32 v119, v150, v151
    s_setprio 3
    v_mfma_f32_32x32x8_bf16 v[136:151], v[68:69], v[54:55], 0
    v_exp_f32 v120, v120
    v_exp_f32 v121, v121
    v_exp_f32 v122, v122
    v_exp_f32 v123, v123
    v_cvt_pk_bf16_f32 v104, v120, v121
    v_cvt_pk_bf16_f32 v105, v122, v123
    v_mfma_f32_32x32x16_bf16 v[136:151], v[56:59], v[48:51], v[136:151]
    v_exp_f32 v124, v124
    v_exp_f32 v125, v125
    v_exp_f32 v126, v126
    v_exp_f32 v127, v127
    v_cvt_pk_bf16_f32 v106, v124, v125
    v_cvt_pk_bf16_f32 v107, v126, v127
    v_mfma_f32_32x32x16_bf16 v[88:103], v[60:63], v[112:115], v[88:103]
    v_exp_f32 v128, v128
    v_exp_f32 v129, v129
    v_exp_f32 v130, v130
    v_exp_f32 v131, v131
    v_cvt_pk_bf16_f32 v108, v128, v129
    v_cvt_pk_bf16_f32 v109, v130, v131
    v_mfma_f32_32x32x16_bf16 v[88:103], v[64:67], v[116:119], v[88:103]
    s_mov_b64 exec, s[44:45]
    ds_read_b128 v[60:63], v31 offset:28160
    ds_read_b128 v[64:67], v31 offset:28800
    s_mov_b64 exec, -1
    v_exp_f32 v132, v132
    v_exp_f32 v133, v133
    v_exp_f32 v134, v134
    v_exp_f32 v135, v135
    v_cvt_pk_bf16_f32 v110, v132, v133
    v_cvt_pk_bf16_f32 v111, v134, v135
    s_cmp_eq_u32 s3, 1
    s_cbranch_scc1 fu_61
    s_call_b64 s[100:101], su_53
fu_61:
    s_waitcnt vmcnt(0)
    s_barrier
    ds_read_b128 v[56:59], v29 offset:40960
    ds_read_b64 v[68:69], v30 offset:40960
    v_exp_f32 v136, v136
    v_exp_f32 v137, v137
    v_exp_f32 v138, v138
    v_exp_f32 v139, v139
    v_cvt_pk_bf16_f32 v112, v136, v137
    v_cvt_pk_bf16_f32 v113, v138, v139
    s_waitcnt lgkmcnt(0)
    v_mfma_f32_32x32x8_bf16 v[120:135], v[68:69], v[52:53], 0
    s_add_u32 m0, s29, 0
    s_nop 0
    buffer_load_dwordx4 v209, s[16:19], s39 offen lds
    v_exp_f32 v140, v140
    v_exp_f32 v141, v141
    v_exp_f32 v142, v142
    v_exp_f32 v143, v143
    v_cvt_pk_bf16_f32 v114, v140, v141
    v_cvt_pk_bf16_f32 v115, v142, v143
    v_mfma_f32_32x32x16_bf16 v[120:135], v[56:59], v[44:47], v[120:135]
    s_add_u32 m0, s29, 1024
    s_add_u32 s39, s39, s40
    buffer_load_dwordx4 v209, s[16:19], s39 offen lds
    v_exp_f32 v144, v144
    v_exp_f32 v145, v145
    v_exp_f32 v146, v146
    v_exp_f32 v147, v147
    v_cvt_pk_bf16_f32 v116, v144, v145
    v_cvt_pk_bf16_f32 v117, v146, v147
    v_mfma_f32_32x32x16_bf16 v[72:87], v[60:63], v[104:107], v[72:87]
    s_add_u32 m0, s29, 2048
    s_add_u32 s39, s39, s41
    buffer_load_dwordx4 v209, s[16:19], s39 offen lds
    v_exp_f32 v148, v148
    v_exp_f32 v149, v149
    v_exp_f32 v150, v150
    v_exp_f32 v151, v151
    v_cvt_pk_bf16_f32 v118, v148, v149
    v_cvt_pk_bf16_f32 v119, v150, v151
    v_mfma_f32_32x32x16_bf16 v[72:87], v[64:67], v[108:111], v[72:87]
    s_add_u32 m0, s29, 3072
    s_add_u32 s39, s39, s40
    buffer_load_dwordx4 v209, s[16:19], s39 offen lds
    s_mul_i32 s30, s98, 20480
    s_add_u32 s98, s98, 1
    s_add_u32 s30, s30, s31
    s_and_b32 s98, s98, 7
    s_add_u32 m0, s32, 0
    s_setprio 2
    v_mfma_f32_32x32x8_bf16 v[136:151], v[68:69], v[54:55], 0
    v_exp_f32 v120, v120
    v_exp_f32 v121, v121
    v_exp_f32 v122, v122
    v_exp_f32 v123, v123
    v_cvt_pk_bf16_f32 v104, v120, v121
    v_cvt_pk_bf16_f32 v105, v122, v123
    v_mfma_f32_32x32x16_bf16 v[136:151], v[56:59], v[48:51], v[136:151]
    ds_read_b128 v[56:59], v29 offset:43520
    ds_read_b64 v[68:69], v30 offset:43520
    buffer_load_dwordx4 v28, s[8:11], s30 offen offset:0 sc1 lds
    v_exp_f32 v124, v124
    v_exp_f32 v125, v125
    v_exp_f32 v126, v126
    v_exp_f32 v127, v127
    v_cvt_pk_bf16_f32 v106, v124, v125
    v_cvt_pk_bf16_f32 v107, v126, v127
    v_mfma_f32_32x32x16_bf16 v[88:103], v[60:63], v[112:115], v[88:103]
    v_exp_f32 v128, v128
    v_exp_f32 v129, v129
    v_exp_f32 v130, v130
    v_exp_f32 v131, v131
    v_cvt_pk_bf16_f32 v108, v128, v129
    v_cvt_pk_bf16_f32 v109, v130, v131
    v_mfma_f32_32x32x16_bf16 v[88:103], v[64:67], v[116:119], v[88:103]
    s_mov_b64 exec, s[44:45]
    ds_read_b128 v[60:63], v31 offset:40960
    ds_read_b128 v[64:67], v31 offset:41600
    s_mov_b64 exec, -1
    buffer_load_dwordx4 v28, s[8:11], s30 offen offset:1024 sc1 lds
    v_exp_f32 v132, v132
    v_exp_f32 v133, v133
    v_exp_f32 v134, v134
    v_exp_f32 v135, v135
    v_cvt_pk_bf16_f32 v110, v132, v133
    v_cvt_pk_bf16_f32 v111, v134, v135
    s_waitcnt lgkmcnt(2)
    v_mfma_f32_32x32x8_bf16 v[120:135], v[68:69], v[52:53], 0
    s_mov_b32 exec_hi, 0
    buffer_load_dwordx4 v28, s[8:11], s30 offen offset:2048 sc1 lds
    s_mov_b32 exec_hi, -1
    v_exp_f32 v136, v136
    v_exp_f32 v137, v137
    v_exp_f32 v138, v138
    v_exp_f32 v139, v139
    v_cvt_pk_bf16_f32 v112, v136, v137
    v_cvt_pk_bf16_f32 v113, v138, v139
    v_mfma_f32_32x32x16_bf16 v[120:135], v[56:59], v[44:47], v[120:135]
    v_exp_f32 v140, v140
    v_exp_f32 v141, v141
    v_exp_f32 v142, v142
    v_exp_f32 v143, v143
    v_cvt_pk_bf16_f32 v114, v140, v141
    v_cvt_pk_bf16_f32 v115, v142, v143
    s_waitcnt lgkmcnt(0)
    v_mfma_f32_32x32x16_bf16 v[72:87], v[60:63], v[104:107], v[72:87]
    v_exp_f32 v144, v144
    v_exp_f32 v145, v145
    v_exp_f32 v146, v146
    v_exp_f32 v147, v147
    v_cvt_pk_bf16_f32 v116, v144, v145
    v_cvt_pk_bf16_f32 v117, v146, v147
    v_mfma_f32_32x32x16_bf16 v[72:87], v[64:67], v[108:111], v[72:87]
    v_exp_f32 v148, v148
    v_exp_f32 v149, v149
    v_exp_f32 v150, v150
    v_exp_f32 v151, v151
    v_cvt_pk_bf16_f32 v118, v148, v149
    v_cvt_pk_bf16_f32 v119, v150, v151
    s_setprio 1
    v_mfma_f32_32x32x8_bf16 v[136:151], v[68:69], v[54:55], 0
    v_exp_f32 v120, v120
    v_exp_f32 v121, v121
    v_exp_f32 v122, v122
    v_exp_f32 v123, v123
    v_cvt_pk_bf16_f32 v104, v120, v121
    v_cvt_pk_bf16_f32 v105, v122, v123
    v_mfma_f32_32x32x16_bf16 v[136:151], v[56:59], v[48:51], v[136:151]
    ds_read_b128 v[56:59], v29 offset:46080
    ds_read_b64 v[68:69], v30 offset:46080
    v_exp_f32 v124, v124
    v_exp_f32 v125, v125
    v_exp_f32 v126, v126
    v_exp_f32 v127, v127
    v_cvt_pk_bf16_f32 v106, v124, v125
    v_cvt_pk_bf16_f32 v107, v126, v127
    v_mfma_f32_32x32x16_bf16 v[88:103], v[60:63], v[112:115], v[88:103]
    v_exp_f32 v128, v128
    v_exp_f32 v129, v129
    v_exp_f32 v130, v130
    v_exp_f32 v131, v131
    v_cvt_pk_bf16_f32 v108, v128, v129
    v_cvt_pk_bf16_f32 v109, v130, v131
    v_mfma_f32_32x32x16_bf16 v[88:103], v[64:67], v[116:119], v[88:103]
    s_mov_b64 exec, s[44:45]
    ds_read_b128 v[60:63], v31 offset:43520
    ds_read_b128 v[64:67], v31 offset:44160
    s_mov_b64 exec, -1
    v_exp_f32 v132, v132
    v_exp_f32 v133, v133
    v_exp_f32 v134, v134
    v_exp_f32 v135, v135
    v_cvt_pk_bf16_f32 v110, v132, v133
    v_cvt_pk_bf16_f32 v111, v134, v135
    s_waitcnt lgkmcnt(2)
    v_mfma_f32_32x32x8_bf16 v[120:135], v[68:69], v[52:53], 0
    v_exp_f32 v136, v136
    v_exp_f32 v137, v137
    v_exp_f32 v138, v138
    v_exp_f32 v139, v139
    v_cvt_pk_bf16_f32 v112, v136, v137
    v_cvt_pk_bf16_f32 v113, v138, v139
    v_mfma_f32_32x32x16_bf16 v[120:135], v[56:59], v[44:47], v[120:135]
    v_exp_f32 v140, v140
    v_exp_f32 v141, v141
    v_exp_f32 v142, v142
    v_exp_f32 v143, v143
    v_cvt_pk_bf16_f32 v114, v140, v141
    v_cvt_pk_bf16_f32 v115, v142, v143
    s_waitcnt lgkmcnt(0)
    v_mfma_f32_32x32x16_bf16 v[72:87], v[60:63], v[104:107], v[72:87]
    v_exp_f32 v144, v144
    v_exp_f32 v145, v145
    v_exp_f32 v146, v146
    v_exp_f32 v147, v147
    v_cvt_pk_bf16_f32 v116, v144, v145
    v_cvt_pk_bf16_f32 v117, v146, v147
    v_mfma_f32_32x32x16_bf16 v[72:87], v[64:67], v[108:111], v[72:87]
    v_exp_f32 v148, v148
    v_exp_f32 v149, v149
    v_exp_f32 v150, v150
    v_exp_f32 v151, v151
    v_cvt_pk_bf16_f32 v118, v148, v149
    v_cvt_pk_bf16_f32 v119, v150, v151
    s_setprio 0
    v_mfma_f32_32x32x8_bf16 v[136:151], v[68:69], v[54:55], 0
    v_exp_f32 v120, v120
    v_exp_f32 v121, v121
    v_exp_f32 v122, v122
    v_exp_f32 v123, v123
    v_cvt_pk_bf16_f32 v104, v120, v121
    v_cvt_pk_bf16_f32 v105, v122, v123
    v_mfma_f32_32x32x16_bf16 v[136:151], v[56:59], v[48:51], v[136:151]
    ds_read_b128 v[56:59], v29 offset:48640
    ds_read_b64 v[68:69], v30 offset:48640
    v_exp_f32 v124, v124
    v_exp_f32 v125, v125
    v_exp_f32 v126, v126
    v_exp_f32 v127, v127
    v_cvt_pk_bf16_f32 v106, v124, v125
    v_cvt_pk_bf16_f32 v107, v126, v127
    v_mfma_f32_32x32x16_bf16 v[88:103], v[60:63], v[112:115], v[88:103]
    v_exp_f32 v128, v128
    v_exp_f32 v129, v129
    v_exp_f32 v130, v130
    v_exp_f32 v131, v131
    v_cvt_pk_bf16_f32 v108, v128, v129
    v_cvt_pk_bf16_f32 v109, v130, v131
    v_mfma_f32_32x32x16_bf16 v[88:103], v[64:67], v[116:119], v[88:103]
    s_mov_b64 exec, s[44:45]
    ds_read_b128 v[60:63], v31 offset:46080
    ds_read_b128 v[64:67], v31 offset:46720
    s_mov_b64 exec, -1
    v_exp_f32 v132, v132
    v_exp_f32 v133, v133
    v_exp_f32 v134, v134
    v_exp_f32 v135, v135
    v_cvt_pk_bf16_f32 v110, v132, v133
    v_cvt_pk_bf16_f32 v111, v134, v135
    s_waitcnt lgkmcnt(2)
    v_mfma_f32_32x32x8_bf16 v[120:135], v[68:69], v[52:53], 0
    v_exp_f32 v136, v136
    v_exp_f32 v137, v137
    v_exp_f32 v138, v138
    v_exp_f32 v139, v139
    v_cvt_pk_bf16_f32 v112, v136, v137
    v_cvt_pk_bf16_f32 v113, v138, v139
    v_mfma_f32_32x32x16_bf16 v[120:135], v[56:59], v[44:47], v[120:135]
    v_exp_f32 v140, v140
    v_exp_f32 v141, v141
    v_exp_f32 v142, v142
    v_exp_f32 v143, v143
    v_cvt_pk_bf16_f32 v114, v140, v141
    v_cvt_pk_bf16_f32 v115, v142, v143
    s_waitcnt lgkmcnt(0)
    v_mfma_f32_32x32x16_bf16 v[72:87], v[60:63], v[104:107], v[72:87]
    v_exp_f32 v144, v144
    v_exp_f32 v145, v145
    v_exp_f32 v146, v146
    v_exp_f32 v147, v147
    v_cvt_pk_bf16_f32 v116, v144, v145
    v_cvt_pk_bf16_f32 v117, v146, v147
    v_mfma_f32_32x32x16_bf16 v[72:87], v[64:67], v[108:111], v[72:87]
    v_exp_f32 v148, v148
    v_exp_f32 v149, v149
    v_exp_f32 v150, v150
    v_exp_f32 v151, v151
    v_cvt_pk_bf16_f32 v118, v148, v149
    v_cvt_pk_bf16_f32 v119, v150, v151
    s_waitcnt vmcnt(0)
    s_barrier
    s_setprio 3
    v_mfma_f32_32x32x8_bf16 v[136:151], v[68:69], v[54:55], 0
    v_exp_f32 v120, v120
    v_exp_f32 v121, v121
    v_exp_f32 v122, v122
    v_exp_f32 v123, v123
    v_cvt_pk_bf16_f32 v104, v120, v121
    v_cvt_pk_bf16_f32 v105, v122, v123
    v_mfma_f32_32x32x16_bf16 v[136:151], v[56:59], v[48:51], v[136:151]
    ds_read_b128 v[56:59], v29 offset:0
    ds_read_b64 v[68:69], v30 offset:0
    v_exp_f32 v124, v124
    v_exp_f32 v125, v125
    v_exp_f32 v126, v126
    v_exp_f32 v127, v127
    v_cvt_pk_bf16_f32 v106, v124, v125
    v_cvt_pk_bf16_f32 v107, v126, v127
    v_mfma_f32_32x32x16_bf16 v[88:103], v[60:63], v[112:115], v[88:103]
    v_exp_f32 v128, v128
    v_exp_f32 v129, v129
    v_exp_f32 v130, v130
    v_exp_f32 v131, v131
    v_cvt_pk_bf16_f32 v108, v128, v129
    v_cvt_pk_bf16_f32 v109, v130, v131
    v_mfma_f32_32x32x16_bf16 v[88:103], v[64:67], v[116:119], v[88:103]
    s_mov_b64 exec, s[44:45]
    ds_read_b128 v[60:63], v31 offset:48640
    ds_read_b128 v[64:67], v31 offset:49280
    s_mov_b64 exec, -1
    v_exp_f32 v132, v132
    v_exp_f32 v133, v133
    v_exp_f32 v134, v134
    v_exp_f32 v135, v135
    v_cvt_pk_bf16_f32 v110, v132, v133
    v_cvt_pk_bf16_f32 v111, v134, v135
    s_waitcnt lgkmcnt(2)
    v_mfma_f32_32x32x8_bf16 v[120:135], v[68:69], v[52:53], 0
    v_exp_f32 v136, v136
    v_exp_f32 v137, v137
    v_exp_f32 v138, v138
    v_exp_f32 v139, v139
    v_cvt_pk_bf16_f32 v112, v136, v137
    v_cvt_pk_bf16_f32 v113, v138, v139
    v_mfma_f32_32x32x16_bf16 v[120:135], v[56:59], v[44:47], v[120:135]
    v_exp_f32 v140, v140
    v_exp_f32 v141, v141
    v_exp_f32 v142, v142
    v_exp_f32 v143, v143
    v_cvt_pk_bf16_f32 v114, v140, v141
    v_cvt_pk_bf16_f32 v115, v142, v143
    s_waitcnt lgkmcnt(0)
    v_mfma_f32_32x32x16_bf16 v[72:87], v[60:63], v[104:107], v[72:87]
    v_exp_f32 v144, v144
    v_exp_f32 v145, v145
    v_exp_f32 v146, v146
    v_exp_f32 v147, v147
    v_cvt_pk_bf16_f32 v116, v144, v145
    v_cvt_pk_bf16_f32 v117, v146, v147
    v_mfma_f32_32x32x16_bf16 v[72:87], v[64:67], v[108:111], v[72:87]
    v_exp_f32 v148, v148
    v_exp_f32 v149, v149
    v_exp_f32 v150, v150
    v_exp_f32 v151, v151
    v_cvt_pk_bf16_f32 v118, v148, v149
    v_cvt_pk_bf16_f32 v119, v150, v151
    s_mul_i32 s30, s98, 20480
    s_add_u32 s98, s98, 1
    s_add_u32 s30, s30, s31
    s_and_b32 s98, s98, 7
    s_add_u32 m0, s32, 20480
    s_setprio 2
    v_mfma_f32_32x32x8_bf16 v[136:151], v[68:69], v[54:55], 0
    v_exp_f32 v120, v120
    v_exp_f32 v121, v121
    v_exp_f32 v122, v122
    v_exp_f32 v123, v123
    v_cvt_pk_bf16_f32 v104, v120, v121
    v_cvt_pk_bf16_f32 v105, v122, v123
    v_mfma_f32_32x32x16_bf16 v[136:151], v[56:59], v[48:51], v[136:151]
    ds_read_b128 v[56:59], v29 offset:2560
    ds_read_b64 v[68:69], v30 offset:2560
    buffer_load_dwordx4 v28, s[8:11], s30 offen offset:0 sc1 lds
    v_exp_f32 v124, v124
    v_exp_f32 v125, v125
    v_exp_f32 v126, v126
    v_exp_f32 v127, v127
    v_cvt_pk_bf16_f32 v106, v124, v125
    v_cvt_pk_bf16_f32 v107, v126, v127
    v_mfma_f32_32x32x16_bf16 v[88:103], v[60:63], v[112:115], v[88:103]
    v_exp_f32 v128, v128
    v_exp_f32 v129, v129
    v_exp_f32 v130, v130
    v_exp_f32 v131, v131
    v_cvt_pk_bf16_f32 v108, v128, v129
    v_cvt_pk_bf16_f32 v109, v130, v131
    v_mfma_f32_32x32x16_bf16 v[88:103], v[64:67], v[116:119], v[88:103]
    s_mov_b64 exec, s[44:45]
    ds_read_b128 v[60:63], v31 offset:0
    ds_read_b128 v[64:67], v31 offset:640
    s_mov_b64 exec, -1
    buffer_load_dwordx4 v28, s[8:11], s30 offen offset:1024 sc1 lds
    v_exp_f32 v132, v132
    v_exp_f32 v133, v133
    v_exp_f32 v134, v134
    v_exp_f32 v135, v135
    v_cvt_pk_bf16_f32 v110, v132, v133
    v_cvt_pk_bf16_f32 v111, v134, v135
    s_waitcnt lgkmcnt(2)
    v_mfma_f32_32x32x8_bf16 v[120:135], v[68:69], v[52:53], 0
    s_mov_b32 exec_hi, 0
    buffer_load_dwordx4 v28, s[8:11], s30 offen offset:2048 sc1 lds
    s_mov_b32 exec_hi, -1
    v_exp_f32 v136, v136
    v_exp_f32 v137, v137
    v_exp_f32 v138, v138
    v_exp_f32 v139, v139
    v_cvt_pk_bf16_f32 v112, v136, v137
    v_cvt_pk_bf16_f32 v113, v138, v139
    v_mfma_f32_32x32x16_bf16 v[120:135], v[56:59], v[44:47], v[120:135]
    v_exp_f32 v140, v140
    v_exp_f32 v141, v141
    v_exp_f32 v142, v142
    v_exp_f32 v143, v143
    v_cvt_pk_bf16_f32 v114, v140, v141
    v_cvt_pk_bf16_f32 v115, v142, v143
    s_waitcnt lgkmcnt(0)
    v_mfma_f32_32x32x16_bf16 v[72:87], v[60:63], v[104:107], v[72:87]
    ds_read_b64_tr_b16 v[152:153], v211
    ds_read_b64_tr_b16 v[154:155], v212
    s_mov_b32 s16, s4
    s_mov_b32 s17, s5
    s_cmp_lt_u32 s20, 3
    s_cselect_b32 s18, 0, s10
    v_exp_f32 v144, v144
    v_exp_f32 v145, v145
    v_exp_f32 v146, v146
    v_exp_f32 v147, v147
    v_cvt_pk_bf16_f32 v116, v144, v145
    v_cvt_pk_bf16_f32 v117, v146, v147
    v_mfma_f32_32x32x16_bf16 v[72:87], v[64:67], v[108:111], v[72:87]
    ds_read_b64_tr_b16 v[156:157], v213
    ds_read_b64_tr_b16 v[158:159], v214
    v_exp_f32 v148, v148
    v_exp_f32 v149, v149
    v_exp_f32 v150, v150
    v_exp_f32 v151, v151
    v_cvt_pk_bf16_f32 v118, v148, v149
    v_cvt_pk_bf16_f32 v119, v150, v151
    s_setprio 1
    v_mfma_f32_32x32x8_bf16 v[136:151], v[68:69], v[54:55], 0
    v_exp_f32 v120, v120
    v_exp_f32 v121, v121
    v_exp_f32 v122, v122
    v_exp_f32 v123, v123
    v_cvt_pk_bf16_f32 v104, v120, v121
    v_cvt_pk_bf16_f32 v105, v122, v123
    v_mfma_f32_32x32x16_bf16 v[136:151], v[56:59], v[48:51], v[136:151]
    ds_read_b128 v[56:59], v29 offset:5120
    ds_read_b64 v[68:69], v30 offset:5120
    v_exp_f32 v124, v124
    v_exp_f32 v125, v125
    v_exp_f32 v126, v126
    v_exp_f32 v127, v127
    v_cvt_pk_bf16_f32 v106, v124, v125
    v_cvt_pk_bf16_f32 v107, v126, v127
    v_mfma_f32_32x32x16_bf16 v[88:103], v[60:63], v[112:115], v[88:103]
    v_exp_f32 v128, v128
    v_exp_f32 v129, v129
    v_exp_f32 v130, v130
    v_exp_f32 v131, v131
    v_cvt_pk_bf16_f32 v108, v128, v129
    v_cvt_pk_bf16_f32 v109, v130, v131
    v_mfma_f32_32x32x16_bf16 v[88:103], v[64:67], v[116:119], v[88:103]
    s_mov_b64 exec, s[44:45]
    ds_read_b128 v[60:63], v31 offset:2560
    ds_read_b128 v[64:67], v31 offset:3200
    s_mov_b64 exec, -1
    v_exp_f32 v132, v132
    v_exp_f32 v133, v133
    v_exp_f32 v134, v134
    v_exp_f32 v135, v135
    v_cvt_pk_bf16_f32 v110, v132, v133
    v_cvt_pk_bf16_f32 v111, v134, v135
    s_waitcnt lgkmcnt(2)
    v_mfma_f32_32x32x8_bf16 v[120:135], v[68:69], v[52:53], 0
    v_exp_f32 v136, v136
    v_exp_f32 v137, v137
    v_exp_f32 v138, v138
    v_exp_f32 v139, v139
    v_cvt_pk_bf16_f32 v112, v136, v137
    v_cvt_pk_bf16_f32 v113, v138, v139
    v_mfma_f32_32x32x16_bf16 v[120:135], v[56:59], v[44:47], v[120:135]
    v_exp_f32 v140, v140
    v_exp_f32 v141, v141
    v_exp_f32 v142, v142
    v_exp_f32 v143, v143
    v_cvt_pk_bf16_f32 v114, v140, v141
    v_cvt_pk_bf16_f32 v115, v142, v143
    s_waitcnt lgkmcnt(0)
    v_mfma_f32_32x32x16_bf16 v[72:87], v[60:63], v[104:107], v[72:87]
    ds_read_b64_tr_b16 v[160:161], v215
    ds_read_b64_tr_b16 v[162:163], v216
    v_exp_f32 v144, v144
    v_exp_f32 v145, v145
    v_exp_f32 v146, v146
    v_exp_f32 v147, v147
    v_cvt_pk_bf16_f32 v116, v144, v145
    v_cvt_pk_bf16_f32 v117, v146, v147
    v_mfma_f32_32x32x16_bf16 v[72:87], v[64:67], v[108:111], v[72:87]
    ds_read_b64_tr_b16 v[164:165], v217
    ds_read_b64_tr_b16 v[166:167], v218
    v_exp_f32 v148, v148
    v_exp_f32 v149, v149
    v_exp_f32 v150, v150
    v_exp_f32 v151, v151
    v_cvt_pk_bf16_f32 v118, v148, v149
    v_cvt_pk_bf16_f32 v119, v150, v151
    s_setprio 0
    v_mfma_f32_32x32x8_bf16 v[136:151], v[68:69], v[54:55], 0
    buffer_store_dwordx4 v[152:155], v2, s[16:19], s36 offen sc1
    v_exp_f32 v120, v120
    v_exp_f32 v121, v121
    v_exp_f32 v122, v122
    v_mfma_f32_16x16x32_bf16 v[172:175], v[176:179], v[152:155], 0
    v_exp_f32 v123, v123
    v_cvt_pk_bf16_f32 v104, v120, v121
    v_cvt_pk_bf16_f32 v105, v122, v123
    v_mfma_f32_32x32x16_bf16 v[136:151], v[56:59], v[48:51], v[136:151]
    ds_read_b128 v[56:59], v29 offset:7680
    ds_read_b64 v[68:69], v30 offset:7680
    v_exp_f32 v124, v124
    v_exp_f32 v125, v125
    v_exp_f32 v126, v126
    v_exp_f32 v127, v127
    v_cvt_pk_bf16_f32 v106, v124, v125
    v_cvt_pk_bf16_f32 v107, v126, v127
    v_mfma_f32_32x32x16_bf16 v[88:103], v[60:63], v[112:115], v[88:103]
    s_add_u32 s25, s36, s37
    buffer_store_dwordx4 v[156:159], v2, s[16:19], s25 offen sc1
    v_exp_f32 v128, v128
    v_exp_f32 v129, v129
    v_exp_f32 v130, v130
    v_mfma_f32_16x16x32_bf16 v[172:175], v[180:183], v[156:159], v[172:175]
    v_exp_f32 v131, v131
    v_cvt_pk_bf16_f32 v108, v128, v129
    v_cvt_pk_bf16_f32 v109, v130, v131
    v_mfma_f32_32x32x16_bf16 v[88:103], v[64:67], v[116:119], v[88:103]
    s_mov_b64 exec, s[44:45]
    ds_read_b128 v[60:63], v31 offset:5120
    ds_read_b128 v[64:67], v31 offset:5760
    s_mov_b64 exec, -1
    v_exp_f32 v132, v132
    v_exp_f32 v133, v133
    v_exp_f32 v134, v134
    v_exp_f32 v135, v135
    v_cvt_pk_bf16_f32 v110, v132, v133
    v_cvt_pk_bf16_f32 v111, v134, v135
    s_waitcnt lgkmcnt(2)
    v_mfma_f32_32x32x8_bf16 v[120:135], v[68:69], v[52:53], 0
    v_exp_f32 v136, v136
    v_exp_f32 v137, v137
    v_exp_f32 v138, v138
    v_exp_f32 v139, v139
    v_cvt_pk_bf16_f32 v112, v136, v137
    v_cvt_pk_bf16_f32 v113, v138, v139
    v_mfma_f32_32x32x16_bf16 v[120:135], v[56:59], v[44:47], v[120:135]
    v_exp_f32 v140, v140
    v_exp_f32 v141, v141
    v_exp_f32 v142, v142
    v_exp_f32 v143, v143
    v_cvt_pk_bf16_f32 v114, v140, v141
    v_cvt_pk_bf16_f32 v115, v142, v143
    s_waitcnt lgkmcnt(0)
    v_mfma_f32_32x32x16_bf16 v[72:87], v[60:63], v[104:107], v[72:87]
    v_exp_f32 v144, v144
    v_exp_f32 v145, v145
    v_exp_f32 v146, v146
    v_exp_f32 v147, v147
    v_cvt_pk_bf16_f32 v116, v144, v145
    v_cvt_pk_bf16_f32 v117, v146, v147
    v_mfma_f32_32x32x16_bf16 v[72:87], v[64:67], v[108:111], v[72:87]
    s_add_u32 s36, s36, s43
    s_mov_b32 s43, 0
    buffer_store_dwordx4 v[160:163], v2, s[16:19], s36 offen sc1
    v_exp_f32 v148, v148
    v_exp_f32 v149, v149
    v_exp_f32 v150, v150
    v_mfma_f32_16x16x32_bf16 v[172:175], v[176:179], v[160:163], v[172:175]
    v_exp_f32 v151, v151
    v_cvt_pk_bf16_f32 v118, v148, v149
    v_cvt_pk_bf16_f32 v119, v150, v151
    s_waitcnt vmcnt(3)
    s_barrier
    s_setprio 3
    v_mfma_f32_32x32x8_bf16 v[136:151], v[68:69], v[54:55], 0
    v_exp_f32 v120, v120
    v_exp_f32 v121, v121
    v_exp_f32 v122, v122
    v_exp_f32 v123, v123
    v_cvt_pk_bf16_f32 v104, v120, v121
    v_cvt_pk_bf16_f32 v105, v122, v123
    v_mfma_f32_32x32x16_bf16 v[136:151], v[56:59], v[48:51], v[136:151]
    ds_read_b128 v[56:59], v29 offset:20480
    ds_read_b64 v[68:69], v30 offset:20480
    s_add_u32 s25, s36, s37
    buffer_store_dwordx4 v[164:167], v2, s[16:19], s25 offen sc1
    v_exp_f32 v124, v124
    v_exp_f32 v125, v125
    v_exp_f32 v126, v126
    v_mfma_f32_16x16x32_bf16 v[172:175], v[180:183], v[164:167], v[172:175]
    v_exp_f32 v127, v127
    v_cvt_pk_bf16_f32 v106, v124, v125
    v_cvt_pk_bf16_f32 v107, v126, v127
    v_mfma_f32_32x32x16_bf16 v[88:103], v[60:63], v[112:115], v[88:103]
    v_exp_f32 v128, v128
    v_exp_f32 v129, v129
    v_exp_f32 v130, v130
    v_exp_f32 v131, v131
    v_cvt_pk_bf16_f32 v108, v128, v129
    v_cvt_pk_bf16_f32 v109, v130, v131
    v_mfma_f32_32x32x16_bf16 v[88:103], v[64:67], v[116:119], v[88:103]
    s_mov_b64 exec, s[44:45]
    ds_read_b128 v[60:63], v31 offset:7680
    ds_read_b128 v[64:67], v31 offset:8320
    s_mov_b64 exec, -1
    v_exp_f32 v132, v132
    v_exp_f32 v133, v133
    v_exp_f32 v134, v134
    v_exp_f32 v135, v135
    v_cvt_pk_bf16_f32 v110, v132, v133
    v_cvt_pk_bf16_f32 v111, v134, v135
    s_waitcnt lgkmcnt(2)
    v_mfma_f32_32x32x8_bf16 v[120:135], v[68:69], v[52:53], 0
    v_exp_f32 v136, v136
    v_exp_f32 v137, v137
    v_exp_f32 v138, v138
    v_exp_f32 v139, v139
    v_cvt_pk_bf16_f32 v112, v136, v137
    v_cvt_pk_bf16_f32 v113, v138, v139
    v_mfma_f32_32x32x16_bf16 v[120:135], v[56:59], v[44:47], v[120:135]
    s_cmp_ge_u32 s35, 740
    s_cselect_b32 s18, s18, 0
    buffer_atomic_add_f32 v172, v3, s[16:19], s38 offen
    v_exp_f32 v140, v140
    v_exp_f32 v141, v141
    v_exp_f32 v142, v142
    v_exp_f32 v143, v143
    v_cvt_pk_bf16_f32 v114, v140, v141
    v_cvt_pk_bf16_f32 v115, v142, v143
    s_waitcnt lgkmcnt(0)
    v_mfma_f32_32x32x16_bf16 v[72:87], v[60:63], v[104:107], v[72:87]
    v_exp_f32 v144, v144
    v_exp_f32 v145, v145
    v_exp_f32 v146, v146
    v_exp_f32 v147, v147
    v_cvt_pk_bf16_f32 v116, v144, v145
    v_cvt_pk_bf16_f32 v117, v146, v147
    v_mfma_f32_32x32x16_bf16 v[72:87], v[64:67], v[108:111], v[72:87]
    v_exp_f32 v148, v148
    v_exp_f32 v149, v149
    v_exp_f32 v150, v150
    v_exp_f32 v151, v151
    v_cvt_pk_bf16_f32 v118, v148, v149
    v_cvt_pk_bf16_f32 v119, v150, v151
    s_mul_i32 s30, s98, 20480
    s_add_u32 s98, s98, 1
    s_add_u32 s30, s30, s31
    s_and_b32 s98, s98, 7
    s_add_u32 m0, s32, 40960
    s_setprio 2
    v_mfma_f32_32x32x8_bf16 v[136:151], v[68:69], v[54:55], 0
    v_exp_f32 v120, v120
    v_exp_f32 v121, v121
    v_exp_f32 v122, v122
    v_exp_f32 v123, v123
    v_cvt_pk_bf16_f32 v104, v120, v121
    v_cvt_pk_bf16_f32 v105, v122, v123
    v_mfma_f32_32x32x16_bf16 v[136:151], v[56:59], v[48:51], v[136:151]
    ds_read_b128 v[56:59], v29 offset:23040
    ds_read_b64 v[68:69], v30 offset:23040
    buffer_load_dwordx4 v28, s[8:11], s30 offen offset:0 sc1 lds
    v_exp_f32 v124, v124
    v_exp_f32 v125, v125
    v_exp_f32 v126, v126
    v_exp_f32 v127, v127
    v_cvt_pk_bf16_f32 v106, v124, v125
    v_cvt_pk_bf16_f32 v107, v126, v127
    v_mfma_f32_32x32x16_bf16 v[88:103], v[60:63], v[112:115], v[88:103]
    v_exp_f32 v128, v128
    v_exp_f32 v129, v129
    v_exp_f32 v130, v130
    v_exp_f32 v131, v131
    v_cvt_pk_bf16_f32 v108, v128, v129
    v_cvt_pk_bf16_f32 v109, v130, v131
    v_mfma_f32_32x32x16_bf16 v[88:103], v[64:67], v[116:119], v[88:103]
    s_mov_b64 exec, s[44:45]
    ds_read_b128 v[60:63], v31 offset:20480
    ds_read_b128 v[64:67], v31 offset:21120
    s_mov_b64 exec, -1
    buffer_load_dwordx4 v28, s[8:11], s30 offen offset:1024 sc1 lds
    v_exp_f32 v132, v132
    v_exp_f32 v133, v133
    v_exp_f32 v134, v134
    v_exp_f32 v135, v135
    v_cvt_pk_bf16_f32 v110, v132, v133
    v_cvt_pk_bf16_f32 v111, v134, v135
    s_waitcnt lgkmcnt(2)
    v_mfma_f32_32x32x8_bf16 v[120:135], v[68:69], v[52:53], 0
    s_mov_b32 exec_hi, 0
    buffer_load_dwordx4 v28, s[8:11], s30 offen offset:2048 sc1 lds
    s_mov_b32 exec_hi, -1
    v_exp_f32 v136, v136
    v_exp_f32 v137, v137
    v_exp_f32 v138, v138
    v_exp_f32 v139, v139
    v_cvt_pk_bf16_f32 v112, v136, v137
    v_cvt_pk_bf16_f32 v113, v138, v139
    v_mfma_f32_32x32x16_bf16 v[120:135], v[56:59], v[44:47], v[120:135]
    buffer_load_dwordx4 v[18:21], v15, s[12:15], s80 offen offset:0 sc1
    v_exp_f32 v140, v140
    v_exp_f32 v141, v141
    v_exp_f32 v142, v142
    v_exp_f32 v143, v143
    v_cvt_pk_bf16_f32 v114, v140, v141
    v_cvt_pk_bf16_f32 v115, v142, v143
    s_waitcnt lgkmcnt(0)
    v_mfma_f32_32x32x16_bf16 v[72:87], v[60:63], v[104:107], v[72:87]
    v_exp_f32 v144, v144
    v_exp_f32 v145, v145
    v_exp_f32 v146, v146
    v_exp_f32 v147, v147
    v_cvt_pk_bf16_f32 v116, v144, v145
    v_cvt_pk_bf16_f32 v117, v146, v147
    v_mfma_f32_32x32x16_bf16 v[72:87], v[64:67], v[108:111], v[72:87]
    v_exp_f32 v148, v148
    v_exp_f32 v149, v149
    v_exp_f32 v150, v150
    v_exp_f32 v151, v151
    v_cvt_pk_bf16_f32 v118, v148, v149
    v_cvt_pk_bf16_f32 v119, v150, v151
    s_setprio 1
    v_mfma_f32_32x32x8_bf16 v[136:151], v[68:69], v[54:55], 0
    v_exp_f32 v120, v120
    v_exp_f32 v121, v121
    v_exp_f32 v122, v122
    v_exp_f32 v123, v123
    v_cvt_pk_bf16_f32 v104, v120, v121
    v_cvt_pk_bf16_f32 v105, v122, v123
    v_mfma_f32_32x32x16_bf16 v[136:151], v[56:59], v[48:51], v[136:151]
    ds_read_b128 v[56:59], v29 offset:25600
    ds_read_b64 v[68:69], v30 offset:25600
    buffer_load_dwordx4 v[22:25], v15, s[12:15], s80 offen offset:64 sc1
    v_exp_f32 v124, v124
    v_exp_f32 v125, v125
    v_exp_f32 v126, v126
    v_exp_f32 v127, v127
    v_cvt_pk_bf16_f32 v106, v124, v125
    v_cvt_pk_bf16_f32 v107, v126, v127
    v_mfma_f32_32x32x16_bf16 v[88:103], v[60:63], v[112:115], v[88:103]
    v_exp_f32 v128, v128
    v_exp_f32 v129, v129
    v_exp_f32 v130, v130
    v_exp_f32 v131, v131
    v_cvt_pk_bf16_f32 v108, v128, v129
    v_cvt_pk_bf16_f32 v109, v130, v131
    v_mfma_f32_32x32x16_bf16 v[88:103], v[64:67], v[116:119], v[88:103]
    s_mov_b64 exec, s[44:45]
    ds_read_b128 v[60:63], v31 offset:23040
    ds_read_b128 v[64:67], v31 offset:23680
    s_mov_b64 exec, -1
    v_exp_f32 v132, v132
    v_exp_f32 v133, v133
    v_exp_f32 v134, v134
    v_exp_f32 v135, v135
    v_cvt_pk_bf16_f32 v110, v132, v133
    v_cvt_pk_bf16_f32 v111, v134, v135
    s_waitcnt lgkmcnt(2)
    v_mfma_f32_32x32x8_bf16 v[120:135], v[68:69], v[52:53], 0
    v_exp_f32 v136, v136
    v_exp_f32 v137, v137
    v_exp_f32 v138, v138
    v_exp_f32 v139, v139
    v_cvt_pk_bf16_f32 v112, v136, v137
    v_cvt_pk_bf16_f32 v113, v138, v139
    v_mfma_f32_32x32x16_bf16 v[120:135], v[56:59], v[44:47], v[120:135]
    v_lshrrev_b32 v6, 4, v1
    v_lshlrev_b32 v6, 3, v6
    v_sub_u32 v6, v15, v6
    buffer_load_dwordx2 v[26:27], v6, s[12:15], s99 offen offset:1024 sc1
    v_exp_f32 v140, v140
    v_exp_f32 v141, v141
    v_exp_f32 v142, v142
    v_exp_f32 v143, v143
    v_cvt_pk_bf16_f32 v114, v140, v141
    v_cvt_pk_bf16_f32 v115, v142, v143
    s_waitcnt lgkmcnt(0)
    v_mfma_f32_32x32x16_bf16 v[72:87], v[60:63], v[104:107], v[72:87]
    v_exp_f32 v144, v144
    v_exp_f32 v145, v145
    v_exp_f32 v146, v146
    v_exp_f32 v147, v147
    v_cvt_pk_bf16_f32 v116, v144, v145
    v_cvt_pk_bf16_f32 v117, v146, v147
    v_mfma_f32_32x32x16_bf16 v[72:87], v[64:67], v[108:111], v[72:87]
    v_exp_f32 v148, v148
    v_exp_f32 v149, v149
    v_exp_f32 v150, v150
    v_exp_f32 v151, v151
    v_cvt_pk_bf16_f32 v118, v148, v149
    v_cvt_pk_bf16_f32 v119, v150, v151
    s_setprio 0
    v_mfma_f32_32x32x8_bf16 v[136:151], v[68:69], v[54:55], 0
    v_exp_f32 v120, v120
    v_exp_f32 v121, v121
    v_exp_f32 v122, v122
    v_exp_f32 v123, v123
    v_cvt_pk_bf16_f32 v104, v120, v121
    v_cvt_pk_bf16_f32 v105, v122, v123
    v_mfma_f32_32x32x16_bf16 v[136:151], v[56:59], v[48:51], v[136:151]
    ds_read_b128 v[56:59], v29 offset:28160
    ds_read_b64 v[68:69], v30 offset:28160
    v_exp_f32 v124, v124
    v_exp_f32 v125, v125
    v_exp_f32 v126, v126
    v_exp_f32 v127, v127
    v_cvt_pk_bf16_f32 v106, v124, v125
    v_cvt_pk_bf16_f32 v107, v126, v127
    v_mfma_f32_32x32x16_bf16 v[88:103], v[60:63], v[112:115], v[88:103]
    v_exp_f32 v128, v128
    v_exp_f32 v129, v129
    v_exp_f32 v130, v130
    v_exp_f32 v131, v131
    v_cvt_pk_bf16_f32 v108, v128, v129
    v_cvt_pk_bf16_f32 v109, v130, v131
    v_mfma_f32_32x32x16_bf16 v[88:103], v[64:67], v[116:119], v[88:103]
    s_mov_b64 exec, s[44:45]
    ds_read_b128 v[60:63], v31 offset:25600
    ds_read_b128 v[64:67], v31 offset:26240
    s_mov_b64 exec, -1
    v_exp_f32 v132, v132
    v_exp_f32 v133, v133
    v_exp_f32 v134, v134
    v_exp_f32 v135, v135
    v_cvt_pk_bf16_f32 v110, v132, v133
    v_cvt_pk_bf16_f32 v111, v134, v135
    s_waitcnt lgkmcnt(2)
    v_mfma_f32_32x32x8_bf16 v[120:135], v[68:69], v[52:53], 0
    v_exp_f32 v136, v136
    v_exp_f32 v137, v137
    v_exp_f32 v138, v138
    v_exp_f32 v139, v139
    v_cvt_pk_bf16_f32 v112, v136, v137
    v_cvt_pk_bf16_f32 v113, v138, v139
    v_mfma_f32_32x32x16_bf16 v[120:135], v[56:59], v[44:47], v[120:135]
    v_exp_f32 v140, v140
    v_exp_f32 v141, v141
    v_exp_f32 v142, v142
    v_exp_f32 v143, v143
    v_cvt_pk_bf16_f32 v114, v140, v141
    v_cvt_pk_bf16_f32 v115, v142, v143
    s_waitcnt lgkmcnt(0)
    v_mfma_f32_32x32x16_bf16 v[72:87], v[60:63], v[104:107], v[72:87]
    v_exp_f32 v144, v144
    v_exp_f32 v145, v145
    v_exp_f32 v146, v146
    v_exp_f32 v147, v147
    v_cvt_pk_bf16_f32 v116, v144, v145
    v_cvt_pk_bf16_f32 v117, v146, v147
    v_mfma_f32_32x32x16_bf16 v[72:87], v[64:67], v[108:111], v[72:87]
    v_exp_f32 v148, v148
    v_exp_f32 v149, v149
    v_exp_f32 v150, v150
    v_exp_f32 v151, v151
    v_cvt_pk_bf16_f32 v118, v148, v149
    v_cvt_pk_bf16_f32 v119, v150, v151
    s_waitcnt vmcnt(3)
    s_barrier
    s_setprio 3
    v_mfma_f32_32x32x8_bf16 v[136:151], v[68:69], v[54:55], 0
    v_exp_f32 v120, v120
    v_exp_f32 v121, v121
    v_exp_f32 v122, v122
    v_exp_f32 v123, v123
    v_cvt_pk_bf16_f32 v104, v120, v121
    v_cvt_pk_bf16_f32 v105, v122, v123
    v_mfma_f32_32x32x16_bf16 v[136:151], v[56:59], v[48:51], v[136:151]
    ds_read_b128 v[56:59], v29 offset:40960
    ds_read_b64 v[68:69], v30 offset:40960
    s_cmp_lg_u32 s20, 7
    s_cbranch_scc1 pf_62
    s_lshl_b32 s25, s21, 5
    s_add_u32 s25, s25, s22
    s_lshl_b32 s25, s25, 2
    s_add_u32 s25, s25, 25782272
    s_getreg_b32 s26, hwreg(HW_REG_XCC_ID, 0, 4)
    s_add_u32 s26, s26, 1
    v_mov_b32 v11, s26
    s_mov_b64 exec, 1
    buffer_store_dword v11, v5, s[8:11], s25 offen sc1
    s_mov_b64 exec, -1
pf_62:
    v_exp_f32 v124, v124
    v_exp_f32 v125, v125
    v_exp_f32 v126, v126
    v_exp_f32 v127, v127
    v_cvt_pk_bf16_f32 v106, v124, v125
    v_cvt_pk_bf16_f32 v107, v126, v127
    v_mfma_f32_32x32x16_bf16 v[88:103], v[60:63], v[112:115], v[88:103]
    v_exp_f32 v128, v128
    v_exp_f32 v129, v129
    v_exp_f32 v130, v130
    v_exp_f32 v131, v131
    v_cvt_pk_bf16_f32 v108, v128, v129
    v_cvt_pk_bf16_f32 v109, v130, v131
    v_mfma_f32_32x32x16_bf16 v[88:103], v[64:67], v[116:119], v[88:103]
    s_mov_b64 exec, s[44:45]
    ds_read_b128 v[60:63], v31 offset:28160
    ds_read_b128 v[64:67], v31 offset:28800
    s_mov_b64 exec, -1
    v_exp_f32 v132, v132
    v_exp_f32 v133, v133
    v_exp_f32 v134, v134
    v_exp_f32 v135, v135
    v_cvt_pk_bf16_f32 v110, v132, v133
    v_cvt_pk_bf16_f32 v111, v134, v135
    s_waitcnt lgkmcnt(2)
    v_mfma_f32_32x32x8_bf16 v[120:135], v[68:69], v[52:53], 0
    v_exp_f32 v136, v136
    v_exp_f32 v137, v137
    v_exp_f32 v138, v138
    v_exp_f32 v139, v139
    v_cvt_pk_bf16_f32 v112, v136, v137
    v_cvt_pk_bf16_f32 v113, v138, v139
    v_mfma_f32_32x32x16_bf16 v[120:135], v[56:59], v[44:47], v[120:135]
    v_exp_f32 v140, v140
    v_exp_f32 v141, v141
    v_exp_f32 v142, v142
    v_exp_f32 v143, v143
    v_cvt_pk_bf16_f32 v114, v140, v141
    v_cvt_pk_bf16_f32 v115, v142, v143
    s_waitcnt lgkmcnt(0)
    v_mfma_f32_32x32x16_bf16 v[72:87], v[60:63], v[104:107], v[72:87]
    v_exp_f32 v144, v144
    v_exp_f32 v145, v145
    v_exp_f32 v146, v146
    v_exp_f32 v147, v147
    v_cvt_pk_bf16_f32 v116, v144, v145
    v_cvt_pk_bf16_f32 v117, v146, v147
    v_mfma_f32_32x32x16_bf16 v[72:87], v[64:67], v[108:111], v[72:87]
    v_exp_f32 v148, v148
    v_exp_f32 v149, v149
    v_exp_f32 v150, v150
    v_exp_f32 v151, v151
    v_cvt_pk_bf16_f32 v118, v148, v149
    v_cvt_pk_bf16_f32 v119, v150, v151
    s_mul_i32 s30, s98, 20480
    s_add_u32 s98, s98, 1
    s_add_u32 s30, s30, s31
    s_and_b32 s98, s98, 7
    s_add_u32 m0, s32, 0
    s_setprio 2
    v_mfma_f32_32x32x8_bf16 v[136:151], v[68:69], v[54:55], 0
    v_exp_f32 v120, v120
    v_exp_f32 v121, v121
    v_exp_f32 v122, v122
    v_exp_f32 v123, v123
    v_cvt_pk_bf16_f32 v104, v120, v121
    v_cvt_pk_bf16_f32 v105, v122, v123
    v_mfma_f32_32x32x16_bf16 v[136:151], v[56:59], v[48:51], v[136:151]
    ds_read_b128 v[56:59], v29 offset:43520
    ds_read_b64 v[68:69], v30 offset:43520
    buffer_load_dwordx4 v28, s[8:11], s30 offen offset:0 sc1 lds
    v_exp_f32 v124, v124
    v_exp_f32 v125, v125
    v_exp_f32 v126, v126
    v_exp_f32 v127, v127
    v_cvt_pk_bf16_f32 v106, v124, v125
    v_cvt_pk_bf16_f32 v107, v126, v127
    v_mfma_f32_32x32x16_bf16 v[88:103], v[60:63], v[112:115], v[88:103]
    v_exp_f32 v128, v128
    v_exp_f32 v129, v129
    v_exp_f32 v130, v130
    v_exp_f32 v131, v131
    v_cvt_pk_bf16_f32 v108, v128, v129
    v_cvt_pk_bf16_f32 v109, v130, v131
    v_mfma_f32_32x32x16_bf16 v[88:103], v[64:67], v[116:119], v[88:103]
    s_mov_b64 exec, s[44:45]
    ds_read_b128 v[60:63], v31 offset:40960
    ds_read_b128 v[64:67], v31 offset:41600
    s_mov_b64 exec, -1
    buffer_load_dwordx4 v28, s[8:11], s30 offen offset:1024 sc1 lds
    v_exp_f32 v132, v132
    v_exp_f32 v133, v133
    v_exp_f32 v134, v134
    v_exp_f32 v135, v135
    v_cvt_pk_bf16_f32 v110, v132, v133
    v_cvt_pk_bf16_f32 v111, v134, v135
    s_waitcnt lgkmcnt(2)
    v_mfma_f32_32x32x8_bf16 v[120:135], v[68:69], v[52:53], 0
    s_mov_b32 exec_hi, 0
    buffer_load_dwordx4 v28, s[8:11], s30 offen offset:2048 sc1 lds
    s_mov_b32 exec_hi, -1
    v_exp_f32 v136, v136
    v_exp_f32 v137, v137
    v_exp_f32 v138, v138
    v_exp_f32 v139, v139
    v_cvt_pk_bf16_f32 v112, v136, v137
    v_cvt_pk_bf16_f32 v113, v138, v139
    v_mfma_f32_32x32x16_bf16 v[120:135], v[56:59], v[44:47], v[120:135]
    v_exp_f32 v140, v140
    v_exp_f32 v141, v141
    v_exp_f32 v142, v142
    v_exp_f32 v143, v143
    v_cvt_pk_bf16_f32 v114, v140, v141
    v_cvt_pk_bf16_f32 v115, v142, v143
    s_waitcnt lgkmcnt(0)
    v_mfma_f32_32x32x16_bf16 v[72:87], v[60:63], v[104:107], v[72:87]
    v_exp_f32 v144, v144
    v_exp_f32 v145, v145
    v_exp_f32 v146, v146
    v_exp_f32 v147, v147
    v_cvt_pk_bf16_f32 v116, v144, v145
    v_cvt_pk_bf16_f32 v117, v146, v147
    v_mfma_f32_32x32x16_bf16 v[72:87], v[64:67], v[108:111], v[72:87]
    v_exp_f32 v148, v148
    v_exp_f32 v149, v149
    v_exp_f32 v150, v150
    v_exp_f32 v151, v151
    v_cvt_pk_bf16_f32 v118, v148, v149
    v_cvt_pk_bf16_f32 v119, v150, v151
    s_setprio 1
    v_mfma_f32_32x32x8_bf16 v[136:151], v[68:69], v[54:55], 0
    v_exp_f32 v120, v120
    v_exp_f32 v121, v121
    v_exp_f32 v122, v122
    v_exp_f32 v123, v123
    v_cvt_pk_bf16_f32 v104, v120, v121
    v_cvt_pk_bf16_f32 v105, v122, v123
    v_mfma_f32_32x32x16_bf16 v[136:151], v[56:59], v[48:51], v[136:151]
    ds_read_b128 v[56:59], v29 offset:46080
    ds_read_b64 v[68:69], v30 offset:46080
    v_exp_f32 v124, v124
    v_exp_f32 v125, v125
    v_exp_f32 v126, v126
    v_exp_f32 v127, v127
    v_cvt_pk_bf16_f32 v106, v124, v125
    v_cvt_pk_bf16_f32 v107, v126, v127
    v_mfma_f32_32x32x16_bf16 v[88:103], v[60:63], v[112:115], v[88:103]
    v_exp_f32 v128, v128
    v_exp_f32 v129, v129
    v_exp_f32 v130, v130
    v_exp_f32 v131, v131
    v_cvt_pk_bf16_f32 v108, v128, v129
    v_cvt_pk_bf16_f32 v109, v130, v131
    v_mfma_f32_32x32x16_bf16 v[88:103], v[64:67], v[116:119], v[88:103]
    s_mov_b64 exec, s[44:45]
    ds_read_b128 v[60:63], v31 offset:43520
    ds_read_b128 v[64:67], v31 offset:44160
    s_mov_b64 exec, -1
    v_exp_f32 v132, v132
    v_exp_f32 v133, v133
    v_exp_f32 v134, v134
    v_exp_f32 v135, v135
    v_cvt_pk_bf16_f32 v110, v132, v133
    v_cvt_pk_bf16_f32 v111, v134, v135
    s_waitcnt lgkmcnt(2)
    v_mfma_f32_32x32x8_bf16 v[120:135], v[68:69], v[52:53], 0
    v_exp_f32 v136, v136
    v_exp_f32 v137, v137
    v_exp_f32 v138, v138
    v_exp_f32 v139, v139
    v_cvt_pk_bf16_f32 v112, v136, v137
    v_cvt_pk_bf16_f32 v113, v138, v139
    v_mfma_f32_32x32x16_bf16 v[120:135], v[56:59], v[44:47], v[120:135]
    v_exp_f32 v140, v140
    v_exp_f32 v141, v141
    v_exp_f32 v142, v142
    v_exp_f32 v143, v143
    v_cvt_pk_bf16_f32 v114, v140, v141
    v_cvt_pk_bf16_f32 v115, v142, v143
    s_waitcnt lgkmcnt(0)
    v_mfma_f32_32x32x16_bf16 v[72:87], v[60:63], v[104:107], v[72:87]
    v_exp_f32 v144, v144
    v_exp_f32 v145, v145
    v_exp_f32 v146, v146
    v_exp_f32 v147, v147
    v_cvt_pk_bf16_f32 v116, v144, v145
    v_cvt_pk_bf16_f32 v117, v146, v147
    v_mfma_f32_32x32x16_bf16 v[72:87], v[64:67], v[108:111], v[72:87]
    v_exp_f32 v148, v148
    v_exp_f32 v149, v149
    v_exp_f32 v150, v150
    v_exp_f32 v151, v151
    v_cvt_pk_bf16_f32 v118, v148, v149
    v_cvt_pk_bf16_f32 v119, v150, v151
    s_setprio 0
    v_mfma_f32_32x32x8_bf16 v[136:151], v[68:69], v[54:55], 0
    v_exp_f32 v120, v120
    v_exp_f32 v121, v121
    v_exp_f32 v122, v122
    v_exp_f32 v123, v123
    v_cvt_pk_bf16_f32 v104, v120, v121
    v_cvt_pk_bf16_f32 v105, v122, v123
    v_mfma_f32_32x32x16_bf16 v[136:151], v[56:59], v[48:51], v[136:151]
    ds_read_b128 v[56:59], v29 offset:48640
    ds_read_b64 v[68:69], v30 offset:48640
    v_exp_f32 v124, v124
    v_exp_f32 v125, v125
    v_exp_f32 v126, v126
    v_exp_f32 v127, v127
    v_cvt_pk_bf16_f32 v106, v124, v125
    v_cvt_pk_bf16_f32 v107, v126, v127
    v_mfma_f32_32x32x16_bf16 v[88:103], v[60:63], v[112:115], v[88:103]
    v_exp_f32 v128, v128
    v_exp_f32 v129, v129
    v_exp_f32 v130, v130
    v_exp_f32 v131, v131
    v_cvt_pk_bf16_f32 v108, v128, v129
    v_cvt_pk_bf16_f32 v109, v130, v131
    v_mfma_f32_32x32x16_bf16 v[88:103], v[64:67], v[116:119], v[88:103]
    s_mov_b64 exec, s[44:45]
    ds_read_b128 v[60:63], v31 offset:46080
    ds_read_b128 v[64:67], v31 offset:46720
    s_mov_b64 exec, -1
    v_exp_f32 v132, v132
    v_exp_f32 v133, v133
    v_exp_f32 v134, v134
    v_exp_f32 v135, v135
    v_cvt_pk_bf16_f32 v110, v132, v133
    v_cvt_pk_bf16_f32 v111, v134, v135
    s_waitcnt lgkmcnt(2)
    v_mfma_f32_32x32x8_bf16 v[120:135], v[68:69], v[52:53], 0
    v_exp_f32 v136, v136
    v_exp_f32 v137, v137
    v_exp_f32 v138, v138
    v_exp_f32 v139, v139
    v_cvt_pk_bf16_f32 v112, v136, v137
    v_cvt_pk_bf16_f32 v113, v138, v139
    v_mfma_f32_32x32x16_bf16 v[120:135], v[56:59], v[44:47], v[120:135]
    v_exp_f32 v140, v140
    v_exp_f32 v141, v141
    v_exp_f32 v142, v142
    v_exp_f32 v143, v143
    v_cvt_pk_bf16_f32 v114, v140, v141
    v_cvt_pk_bf16_f32 v115, v142, v143
    s_waitcnt lgkmcnt(0)
    v_mfma_f32_32x32x16_bf16 v[72:87], v[60:63], v[104:107], v[72:87]
    v_exp_f32 v144, v144
    v_exp_f32 v145, v145
    v_exp_f32 v146, v146
    v_exp_f32 v147, v147
    v_cvt_pk_bf16_f32 v116, v144, v145
    v_cvt_pk_bf16_f32 v117, v146, v147
    v_mfma_f32_32x32x16_bf16 v[72:87], v[64:67], v[108:111], v[72:87]
    v_exp_f32 v148, v148
    v_exp_f32 v149, v149
    v_exp_f32 v150, v150
    v_exp_f32 v151, v151
    v_cvt_pk_bf16_f32 v118, v148, v149
    v_cvt_pk_bf16_f32 v119, v150, v151
    s_waitcnt vmcnt(0)
    s_barrier
    s_setprio 3
    v_mfma_f32_32x32x8_bf16 v[136:151], v[68:69], v[54:55], 0
    v_exp_f32 v120, v120
    v_exp_f32 v121, v121
    v_exp_f32 v122, v122
    v_exp_f32 v123, v123
    v_cvt_pk_bf16_f32 v104, v120, v121
    v_cvt_pk_bf16_f32 v105, v122, v123
    v_mfma_f32_32x32x16_bf16 v[136:151], v[56:59], v[48:51], v[136:151]
    ds_read_b128 v[56:59], v29 offset:0
    ds_read_b64 v[68:69], v30 offset:0
    v_exp_f32 v124, v124
    v_exp_f32 v125, v125
    v_exp_f32 v126, v126
    v_exp_f32 v127, v127
    v_cvt_pk_bf16_f32 v106, v124, v125
    v_cvt_pk_bf16_f32 v107, v126, v127
    v_mfma_f32_32x32x16_bf16 v[88:103], v[60:63], v[112:115], v[88:103]
    v_exp_f32 v128, v128
    v_exp_f32 v129, v129
    v_exp_f32 v130, v130
    v_exp_f32 v131, v131
    v_cvt_pk_bf16_f32 v108, v128, v129
    v_cvt_pk_bf16_f32 v109, v130, v131
    v_mfma_f32_32x32x16_bf16 v[88:103], v[64:67], v[116:119], v[88:103]
    s_mov_b64 exec, s[44:45]
    ds_read_b128 v[60:63], v31 offset:48640
    ds_read_b128 v[64:67], v31 offset:49280
    s_mov_b64 exec, -1
    v_exp_f32 v132, v132
    v_exp_f32 v133, v133
    v_exp_f32 v134, v134
    v_exp_f32 v135, v135
    v_cvt_pk_bf16_f32 v110, v132, v133
    v_cvt_pk_bf16_f32 v111, v134, v135
    s_waitcnt lgkmcnt(2)
    v_mfma_f32_32x32x8_bf16 v[120:135], v[68:69], v[52:53], 0
    v_exp_f32 v136, v136
    v_exp_f32 v137, v137
    v_exp_f32 v138, v138
    v_exp_f32 v139, v139
    v_cvt_pk_bf16_f32 v112, v136, v137
    v_cvt_pk_bf16_f32 v113, v138, v139
    v_mfma_f32_32x32x16_bf16 v[120:135], v[56:59], v[44:47], v[120:135]
    v_exp_f32 v140, v140
    v_exp_f32 v141, v141
    v_exp_f32 v142, v142
    v_exp_f32 v143, v143
    v_cvt_pk_bf16_f32 v114, v140, v141
    v_cvt_pk_bf16_f32 v115, v142, v143
    s_waitcnt lgkmcnt(0)
    v_mfma_f32_32x32x16_bf16 v[72:87], v[60:63], v[104:107], v[72:87]
    v_exp_f32 v144, v144
    v_exp_f32 v145, v145
    v_exp_f32 v146, v146
    v_exp_f32 v147, v147
    v_cvt_pk_bf16_f32 v116, v144, v145
    v_cvt_pk_bf16_f32 v117, v146, v147
    v_mfma_f32_32x32x16_bf16 v[72:87], v[64:67], v[108:111], v[72:87]
    v_exp_f32 v148, v148
    v_exp_f32 v149, v149
    v_exp_f32 v150, v150
    v_exp_f32 v151, v151
    v_cvt_pk_bf16_f32 v118, v148, v149
    v_cvt_pk_bf16_f32 v119, v150, v151
    s_mov_b32 s25, 25782272
    buffer_load_dwordx4 v[152:155], v2, s[8:11], s25 offen sc1
    s_mul_i32 s30, s98, 20480
    s_add_u32 s98, s98, 1
    s_add_u32 s30, s30, s31
    s_and_b32 s98, s98, 7
    s_add_u32 m0, s32, 20480
    s_setprio 2
    v_mfma_f32_32x32x8_bf16 v[136:151], v[68:69], v[54:55], 0
    v_exp_f32 v120, v120
    v_exp_f32 v121, v121
    v_exp_f32 v122, v122
    v_exp_f32 v123, v123
    v_cvt_pk_bf16_f32 v104, v120, v121
    v_cvt_pk_bf16_f32 v105, v122, v123
    v_mfma_f32_32x32x16_bf16 v[136:151], v[56:59], v[48:51], v[136:151]
    ds_read_b128 v[56:59], v29 offset:2560
    ds_read_b64 v[68:69], v30 offset:2560
    buffer_load_dwordx4 v28, s[8:11], s30 offen offset:0 sc1 lds
    v_exp_f32 v124, v124
    v_exp_f32 v125, v125
    v_exp_f32 v126, v126
    v_exp_f32 v127, v127
    v_cvt_pk_bf16_f32 v106, v124, v125
    v_cvt_pk_bf16_f32 v107, v126, v127
    v_mfma_f32_32x32x16_bf16 v[88:103], v[60:63], v[112:115], v[88:103]
    v_exp_f32 v128, v128
    v_exp_f32 v129, v129
    v_exp_f32 v130, v130
    v_exp_f32 v131, v131
    v_cvt_pk_bf16_f32 v108, v128, v129
    v_cvt_pk_bf16_f32 v109, v130, v131
    v_mfma_f32_32x32x16_bf16 v[88:103], v[64:67], v[116:119], v[88:103]
    s_mov_b64 exec, s[44:45]
    ds_read_b128 v[60:63], v31 offset:0
    ds_read_b128 v[64:67], v31 offset:640
    s_mov_b64 exec, -1
    buffer_load_dwordx4 v28, s[8:11], s30 offen offset:1024 sc1 lds
    v_exp_f32 v132, v132
    v_exp_f32 v133, v133
    v_exp_f32 v134, v134
    v_exp_f32 v135, v135
    v_cvt_pk_bf16_f32 v110, v132, v133
    v_cvt_pk_bf16_f32 v111, v134, v135
    s_waitcnt lgkmcnt(2)
    v_mfma_f32_32x32x8_bf16 v[120:135], v[68:69], v[52:53], 0
    s_mov_b32 exec_hi, 0
    buffer_load_dwordx4 v28, s[8:11], s30 offen offset:2048 sc1 lds
    s_mov_b32 exec_hi, -1
    v_exp_f32 v136, v136
    v_exp_f32 v137, v137
    v_exp_f32 v138, v138
    v_exp_f32 v139, v139
    v_cvt_pk_bf16_f32 v112, v136, v137
    v_cvt_pk_bf16_f32 v113, v138, v139
    v_mfma_f32_32x32x16_bf16 v[120:135], v[56:59], v[44:47], v[120:135]
    v_exp_f32 v140, v140
    v_exp_f32 v141, v141
    v_exp_f32 v142, v142
    v_exp_f32 v143, v143
    v_cvt_pk_bf16_f32 v114, v140, v141
    v_cvt_pk_bf16_f32 v115, v142, v143
    s_waitcnt lgkmcnt(0)
    v_mfma_f32_32x32x16_bf16 v[72:87], v[60:63], v[104:107], v[72:87]
    v_exp_f32 v144, v144
    v_exp_f32 v145, v145
    v_exp_f32 v146, v146
    v_exp_f32 v147, v147
    v_cvt_pk_bf16_f32 v116, v144, v145
    v_cvt_pk_bf16_f32 v117, v146, v147
    v_mfma_f32_32x32x16_bf16 v[72:87], v[64:67], v[108:111], v[72:87]
    v_exp_f32 v148, v148
    v_exp_f32 v149, v149
    v_exp_f32 v150, v150
    v_exp_f32 v151, v151
    v_cvt_pk_bf16_f32 v118, v148, v149
    v_cvt_pk_bf16_f32 v119, v150, v151
    s_setprio 1
    v_mfma_f32_32x32x8_bf16 v[136:151], v[68:69], v[54:55], 0
    s_waitcnt vmcnt(3)
    v_min3_u32 v6, v152, v153, v154
    v_min_u32 v6, v6, v155
    v_cmp_eq_u32 vcc, 0, v6
    s_cbranch_vccnz pc_63
pc_64:
    v_exp_f32 v120, v120
    v_exp_f32 v121, v121
    v_exp_f32 v122, v122
    v_exp_f32 v123, v123
    v_cvt_pk_bf16_f32 v104, v120, v121
    v_cvt_pk_bf16_f32 v105, v122, v123
    v_mfma_f32_32x32x16_bf16 v[136:151], v[56:59], v[48:51], v[136:151]
    ds_read_b128 v[56:59], v29 offset:5120
    ds_read_b64 v[68:69], v30 offset:5120
    v_exp_f32 v124, v124
    v_exp_f32 v125, v125
    v_exp_f32 v126, v126
    v_exp_f32 v127, v127
    v_cvt_pk_bf16_f32 v106, v124, v125
    v_cvt_pk_bf16_f32 v107, v126, v127
    v_mfma_f32_32x32x16_bf16 v[88:103], v[60:63], v[112:115], v[88:103]
    s_add_u32 m0, s34, 0
    s_add_u32 s25, s33, 0
    buffer_load_dwordx4 v41, s[8:11], s25 offen offset:0 sc1 lds
    v_exp_f32 v128, v128
    v_exp_f32 v129, v129
    v_exp_f32 v130, v130
    v_exp_f32 v131, v131
    v_cvt_pk_bf16_f32 v108, v128, v129
    v_cvt_pk_bf16_f32 v109, v130, v131
    v_mfma_f32_32x32x16_bf16 v[88:103], v[64:67], v[116:119], v[88:103]
    s_mov_b64 exec, s[44:45]
    ds_read_b128 v[60:63], v31 offset:2560
    ds_read_b128 v[64:67], v31 offset:3200
    s_mov_b64 exec, -1
    v_exp_f32 v132, v132
    v_exp_f32 v133, v133
    v_exp_f32 v134, v134
    v_exp_f32 v135, v135
    v_cvt_pk_bf16_f32 v110, v132, v133
    v_cvt_pk_bf16_f32 v111, v134, v135
    s_waitcnt lgkmcnt(2)
    v_mfma_f32_32x32x8_bf16 v[120:135], v[68:69], v[52:53], 0
    s_add_u32 m0, s34, 0
    s_add_u32 s25, s33, 0
    buffer_load_dwordx4 v41, s[8:11], s25 offen offset:1024 sc1 lds
    v_exp_f32 v136, v136
    v_exp_f32 v137, v137
    v_exp_f32 v138, v138
    v_exp_f32 v139, v139
    v_cvt_pk_bf16_f32 v112, v136, v137
    v_cvt_pk_bf16_f32 v113, v138, v139
    v_mfma_f32_32x32x16_bf16 v[120:135], v[56:59], v[44:47], v[120:135]
    s_add_u32 m0, s34, 0
    s_add_u32 s25, s33, 0
    buffer_load_dwordx4 v41, s[8:11], s25 offen offset:2048 sc1 lds
    v_exp_f32 v140, v140
    v_exp_f32 v141, v141
    v_exp_f32 v142, v142
    v_exp_f32 v143, v143
    v_cvt_pk_bf16_f32 v114, v140, v141
    v_cvt_pk_bf16_f32 v115, v142, v143
    s_waitcnt lgkmcnt(0)
    v_mfma_f32_32x32x16_bf16 v[72:87], v[60:63], v[104:107], v[72:87]
    v_exp_f32 v144, v144
    v_exp_f32 v145, v145
    v_exp_f32 v146, v146
    v_exp_f32 v147, v147
    v_cvt_pk_bf16_f32 v116, v144, v145
    v_cvt_pk_bf16_f32 v117, v146, v147
    v_mfma_f32_32x32x16_bf16 v[72:87], v[64:67], v[108:111], v[72:87]
    s_add_u32 m0, s34, 0
    s_add_u32 s25, s33, 0
    buffer_load_dwordx4 v41, s[8:11], s25 offen offset:3072 sc1 lds
    v_exp_f32 v148, v148
    v_exp_f32 v149, v149
    v_exp_f32 v150, v150
    v_exp_f32 v151, v151
    v_cvt_pk_bf16_f32 v118, v148, v149
    v_cvt_pk_bf16_f32 v119, v150, v151
    s_setprio 0
    v_mfma_f32_32x32x8_bf16 v[136:151], v[68:69], v[54:55], 0
    v_exp_f32 v120, v120
    v_exp_f32 v121, v121
    v_exp_f32 v122, v122
    v_exp_f32 v123, v123
    v_cvt_pk_bf16_f32 v104, v120, v121
    v_cvt_pk_bf16_f32 v105, v122, v123
    v_mfma_f32_32x32x16_bf16 v[136:151], v[56:59], v[48:51], v[136:151]
    ds_read_b128 v[56:59], v29 offset:7680
    ds_read_b64 v[68:69], v30 offset:7680
    s_add_u32 m0, s34, 4096
    s_add_u32 s25, s33, 4096
    buffer_load_dwordx4 v41, s[8:11], s25 offen offset:0 sc1 lds
    v_exp_f32 v124, v124
    v_exp_f32 v125, v125
    v_exp_f32 v126, v126
    v_exp_f32 v127, v127
    v_cvt_pk_bf16_f32 v106, v124, v125
    v_cvt_pk_bf16_f32 v107, v126, v127
    v_mfma_f32_32x32x16_bf16 v[88:103], v[60:63], v[112:115], v[88:103]
    v_exp_f32 v128, v128
    v_exp_f32 v129, v129
    v_exp_f32 v130, v130
    v_exp_f32 v131, v131
    v_cvt_pk_bf16_f32 v108, v128, v129
    v_cvt_pk_bf16_f32 v109, v130, v131
    v_mfma_f32_32x32x16_bf16 v[88:103], v[64:67], v[116:119], v[88:103]
    s_mov_b64 exec, s[44:45]
    ds_read_b128 v[60:63], v31 offset:5120
    ds_read_b128 v[64:67], v31 offset:5760
    s_mov_b64 exec, -1
    s_add_u32 m0, s34, 40960
    s_add_u32 s25, s33, 40960
    buffer_load_dwordx4 v41, s[8:11], s25 offen offset:0 sc1 lds
    v_exp_f32 v132, v132
    v_exp_f32 v133, v133
    v_exp_f32 v134, v134
    v_exp_f32 v135, v135
    v_cvt_pk_bf16_f32 v110, v132, v133
    v_cvt_pk_bf16_f32 v111, v134, v135
    s_waitcnt lgkmcnt(2)
    v_mfma_f32_32x32x8_bf16 v[120:135], v[68:69], v[52:53], 0
    v_exp_f32 v136, v136
    v_exp_f32 v137, v137
    v_exp_f32 v138, v138
    v_exp_f32 v139, v139
    v_cvt_pk_bf16_f32 v112, v136, v137
    v_cvt_pk_bf16_f32 v113, v138, v139
    v_mfma_f32_32x32x16_bf16 v[120:135], v[56:59], v[44:47], v[120:135]
    s_add_u32 m0, s34, 40960
    s_add_u32 s25, s33, 40960
    buffer_load_dwordx4 v41, s[8:11], s25 offen offset:1024 sc1 lds
    v_exp_f32 v140, v140
    v_exp_f32 v141, v141
    v_exp_f32 v142, v142
    v_exp_f32 v143, v143
    v_cvt_pk_bf16_f32 v114, v140, v141
    v_cvt_pk_bf16_f32 v115, v142, v143
    s_waitcnt lgkmcnt(0)
    v_mfma_f32_32x32x16_bf16 v[72:87], v[60:63], v[104:107], v[72:87]
    s_add_u32 m0, s34, 40960
    s_add_u32 s25, s33, 40960
    buffer_load_dwordx4 v41, s[8:11], s25 offen offset:2048 sc1 lds
    v_exp_f32 v144, v144
    v_exp_f32 v145, v145
    v_exp_f32 v146, v146
    v_exp_f32 v147, v147
    v_cvt_pk_bf16_f32 v116, v144, v145
    v_cvt_pk_bf16_f32 v117, v146, v147
    v_mfma_f32_32x32x16_bf16 v[72:87], v[64:67], v[108:111], v[72:87]
    v_exp_f32 v148, v148
    v_exp_f32 v149, v149
    v_exp_f32 v150, v150
    v_exp_f32 v151, v151
    v_cvt_pk_bf16_f32 v118, v148, v149
    v_cvt_pk_bf16_f32 v119, v150, v151
    s_waitcnt vmcnt(8)
    s_barrier
    s_setprio 3
    v_mfma_f32_32x32x8_bf16 v[136:151], v[68:69], v[54:55], 0
    s_add_u32 m0, s34, 40960
    s_add_u32 s25, s33, 40960
    buffer_load_dwordx4 v41, s[8:11], s25 offen offset:3072 sc1 lds
    v_exp_f32 v120, v120
    v_exp_f32 v121, v121
    v_exp_f32 v122, v122
    v_exp_f32 v123, v123
    v_cvt_pk_bf16_f32 v104, v120, v121
    v_cvt_pk_bf16_f32 v105, v122, v123
    v_mfma_f32_32x32x16_bf16 v[136:151], v[56:59], v[48:51], v[136:151]
    ds_read_b128 v[56:59], v29 offset:20480
    ds_read_b64 v[68:69], v30 offset:20480
    v_exp_f32 v124, v124
    v_exp_f32 v125, v125
    v_exp_f32 v126, v126
    v_exp_f32 v127, v127
    v_cvt_pk_bf16_f32 v106, v124, v125
    v_cvt_pk_bf16_f32 v107, v126, v127
    v_mfma_f32_32x32x16_bf16 v[88:103], v[60:63], v[112:115], v[88:103]
    s_add_u32 m0, s34, 45056
    s_add_u32 s25, s33, 45056
    buffer_load_dwordx4 v41, s[8:11], s25 offen offset:0 sc1 lds
    v_exp_f32 v128, v128
    v_exp_f32 v129, v129
    v_exp_f32 v130, v130
    v_exp_f32 v131, v131
    v_cvt_pk_bf16_f32 v108, v128, v129
    v_cvt_pk_bf16_f32 v109, v130, v131
    v_mfma_f32_32x32x16_bf16 v[88:103], v[64:67], v[116:119], v[88:103]
    s_mov_b64 exec, s[44:45]
    ds_read_b128 v[60:63], v31 offset:7680
    ds_read_b128 v[64:67], v31 offset:8320
    s_mov_b64 exec, -1
    v_exp_f32 v132, v132
    v_exp_f32 v133, v133
    v_exp_f32 v134, v134
    v_exp_f32 v135, v135
    v_cvt_pk_bf16_f32 v110, v132, v133
    v_cvt_pk_bf16_f32 v111, v134, v135
    s_waitcnt lgkmcnt(2)
    v_mfma_f32_32x32x8_bf16 v[120:135], v[68:69], v[52:53], 0
    s_add_u32 s27, s81, 0
    buffer_load_dwordx4 v[156:159], v38, s[8:11], s27 offen offset:0 sc1
    v_exp_f32 v136, v136
    v_exp_f32 v137, v137
    v_exp_f32 v138, v138
    v_exp_f32 v139, v139
    v_cvt_pk_bf16_f32 v112, v136, v137
    v_cvt_pk_bf16_f32 v113, v138, v139
    v_mfma_f32_32x32x16_bf16 v[120:135], v[56:59], v[44:47], v[120:135]
    v_exp_f32 v140, v140
    v_exp_f32 v141, v141
    v_exp_f32 v142, v142
    v_exp_f32 v143, v143
    v_cvt_pk_bf16_f32 v114, v140, v141
    v_cvt_pk_bf16_f32 v115, v142, v143
    s_waitcnt lgkmcnt(0)
    v_mfma_f32_32x32x16_bf16 v[72:87], v[60:63], v[104:107], v[72:87]
    v_exp_f32 v144, v144
    v_exp_f32 v145, v145
    v_exp_f32 v146, v146
    v_exp_f32 v147, v147
    v_cvt_pk_bf16_f32 v116, v144, v145
    v_cvt_pk_bf16_f32 v117, v146, v147
    v_mfma_f32_32x32x16_bf16 v[72:87], v[64:67], v[108:111], v[72:87]
    v_exp_f32 v148, v148
    v_exp_f32 v149, v149
    v_exp_f32 v150, v150
    v_exp_f32 v151, v151
    v_cvt_pk_bf16_f32 v118, v148, v149
    v_cvt_pk_bf16_f32 v119, v150, v151
    s_mul_i32 s30, s98, 20480
    s_add_u32 s98, s98, 1
    s_add_u32 s30, s30, s31
    s_and_b32 s98, s98, 7
    s_add_u32 m0, s32, 40960
    s_setprio 2
    v_mfma_f32_32x32x8_bf16 v[136:151], v[68:69], v[54:55], 0
    v_exp_f32 v120, v120
    v_exp_f32 v121, v121
    v_exp_f32 v122, v122
    v_exp_f32 v123, v123
    v_cvt_pk_bf16_f32 v104, v120, v121
    v_cvt_pk_bf16_f32 v105, v122, v123
    v_mfma_f32_32x32x16_bf16 v[136:151], v[56:59], v[48:51], v[136:151]
    ds_read_b128 v[56:59], v29 offset:23040
    ds_read_b64 v[68:69], v30 offset:23040
    buffer_load_dwordx4 v28, s[8:11], s30 offen offset:0 sc1 lds
    v_exp_f32 v124, v124
    v_exp_f32 v125, v125
    v_exp_f32 v126, v126
    v_exp_f32 v127, v127
    v_cvt_pk_bf16_f32 v106, v124, v125
    v_cvt_pk_bf16_f32 v107, v126, v127
    v_mfma_f32_32x32x16_bf16 v[88:103], v[60:63], v[112:115], v[88:103]
    v_exp_f32 v128, v128
    v_exp_f32 v129, v129
    v_exp_f32 v130, v130
    v_exp_f32 v131, v131
    v_cvt_pk_bf16_f32 v108, v128, v129
    v_cvt_pk_bf16_f32 v109, v130, v131
    v_mfma_f32_32x32x16_bf16 v[88:103], v[64:67], v[116:119], v[88:103]
    s_mov_b64 exec, s[44:45]
    ds_read_b128 v[60:63], v31 offset:20480
    ds_read_b128 v[64:67], v31 offset:21120
    s_mov_b64 exec, -1
    buffer_load_dwordx4 v28, s[8:11], s30 offen offset:1024 sc1 lds
    v_exp_f32 v132, v132
    v_exp_f32 v133, v133
    v_exp_f32 v134, v134
    v_exp_f32 v135, v135
    v_cvt_pk_bf16_f32 v110, v132, v133
    v_cvt_pk_bf16_f32 v111, v134, v135
    s_waitcnt lgkmcnt(2)
    v_mfma_f32_32x32x8_bf16 v[120:135], v[68:69], v[52:53], 0
    s_mov_b32 exec_hi, 0
    buffer_load_dwordx4 v28, s[8:11], s30 offen offset:2048 sc1 lds
    s_mov_b32 exec_hi, -1
    v_exp_f32 v136, v136
    v_exp_f32 v137, v137
    v_exp_f32 v138, v138
    v_exp_f32 v139, v139
    v_cvt_pk_bf16_f32 v112, v136, v137
    v_cvt_pk_bf16_f32 v113, v138, v139
    v_mfma_f32_32x32x16_bf16 v[120:135], v[56:59], v[44:47], v[120:135]
    buffer_load_dwordx4 v[160:163], v38, s[8:11], s27 offen offset:1024 sc1
    v_exp_f32 v140, v140
    v_exp_f32 v141, v141
    v_exp_f32 v142, v142
    v_exp_f32 v143, v143
    v_cvt_pk_bf16_f32 v114, v140, v141
    v_cvt_pk_bf16_f32 v115, v142, v143
    s_waitcnt lgkmcnt(0)
    v_mfma_f32_32x32x16_bf16 v[72:87], v[60:63], v[104:107], v[72:87]
    buffer_load_dwordx4 v[164:167], v38, s[8:11], s27 offen offset:2048 sc1
    v_exp_f32 v144, v144
    v_exp_f32 v145, v145
    v_exp_f32 v146, v146
    v_exp_f32 v147, v147
    v_cvt_pk_bf16_f32 v116, v144, v145
    v_cvt_pk_bf16_f32 v117, v146, v147
    v_mfma_f32_32x32x16_bf16 v[72:87], v[64:67], v[108:111], v[72:87]
    v_exp_f32 v148, v148
    v_exp_f32 v149, v149
    v_exp_f32 v150, v150
    v_exp_f32 v151, v151
    v_cvt_pk_bf16_f32 v118, v148, v149
    v_cvt_pk_bf16_f32 v119, v150, v151
    s_setprio 1
    v_mfma_f32_32x32x8_bf16 v[136:151], v[68:69], v[54:55], 0
    buffer_load_dwordx4 v[168:171], v38, s[8:11], s27 offen offset:3072 sc1
    v_exp_f32 v120, v120
    v_exp_f32 v121, v121
    v_exp_f32 v122, v122
    v_exp_f32 v123, v123
    v_cvt_pk_bf16_f32 v104, v120, v121
    v_cvt_pk_bf16_f32 v105, v122, v123
    v_mfma_f32_32x32x16_bf16 v[136:151], v[56:59], v[48:51], v[136:151]
    ds_read_b128 v[56:59], v29 offset:25600
    ds_read_b64 v[68:69], v30 offset:25600
    v_exp_f32 v124, v124
    v_exp_f32 v125, v125
    v_exp_f32 v126, v126
    v_exp_f32 v127, v127
    v_cvt_pk_bf16_f32 v106, v124, v125
    v_cvt_pk_bf16_f32 v107, v126, v127
    v_mfma_f32_32x32x16_bf16 v[88:103], v[60:63], v[112:115], v[88:103]
    s_add_u32 s27, s27, 4096
    buffer_load_dwordx4 v[172:175], v38, s[8:11], s27 offen offset:0 sc1
    v_exp_f32 v128, v128
    v_exp_f32 v129, v129
    v_exp_f32 v130, v130
    v_exp_f32 v131, v131
    v_cvt_pk_bf16_f32 v108, v128, v129
    v_cvt_pk_bf16_f32 v109, v130, v131
    v_mfma_f32_32x32x16_bf16 v[88:103], v[64:67], v[116:119], v[88:103]
    s_mov_b64 exec, s[44:45]
    ds_read_b128 v[60:63], v31 offset:23040
    ds_read_b128 v[64:67], v31 offset:23680
    s_mov_b64 exec, -1
    v_exp_f32 v132, v132
    v_exp_f32 v133, v133
    v_exp_f32 v134, v134
    v_exp_f32 v135, v135
    v_cvt_pk_bf16_f32 v110, v132, v133
    v_cvt_pk_bf16_f32 v111, v134, v135
    s_waitcnt lgkmcnt(2)
    v_mfma_f32_32x32x8_bf16 v[120:135], v[68:69], v[52:53], 0
    s_add_u32 s27, s81, 20480
    buffer_load_dwordx4 v[176:179], v38, s[8:11], s27 offen offset:0 sc1
    v_exp_f32 v136, v136
    v_exp_f32 v137, v137
    v_exp_f32 v138, v138
    v_exp_f32 v139, v139
    v_cvt_pk_bf16_f32 v112, v136, v137
    v_cvt_pk_bf16_f32 v113, v138, v139
    v_mfma_f32_32x32x16_bf16 v[120:135], v[56:59], v[44:47], v[120:135]
    buffer_load_dwordx4 v[180:183], v38, s[8:11], s27 offen offset:1024 sc1
    v_exp_f32 v140, v140
    v_exp_f32 v141, v141
    v_exp_f32 v142, v142
    v_exp_f32 v143, v143
    v_cvt_pk_bf16_f32 v114, v140, v141
    v_cvt_pk_bf16_f32 v115, v142, v143
    s_waitcnt lgkmcnt(0)
    v_mfma_f32_32x32x16_bf16 v[72:87], v[60:63], v[104:107], v[72:87]
    v_exp_f32 v144, v144
    v_exp_f32 v145, v145
    v_exp_f32 v146, v146
    v_exp_f32 v147, v147
    v_cvt_pk_bf16_f32 v116, v144, v145
    v_cvt_pk_bf16_f32 v117, v146, v147
    v_mfma_f32_32x32x16_bf16 v[72:87], v[64:67], v[108:111], v[72:87]
    buffer_load_dwordx4 v[184:187], v38, s[8:11], s27 offen offset:2048 sc1
    v_exp_f32 v148, v148
    v_exp_f32 v149, v149
    v_exp_f32 v150, v150
    v_exp_f32 v151, v151
    v_cvt_pk_bf16_f32 v118, v148, v149
    v_cvt_pk_bf16_f32 v119, v150, v151
    s_setprio 0
    v_mfma_f32_32x32x8_bf16 v[136:151], v[68:69], v[54:55], 0
    v_exp_f32 v120, v120
    v_exp_f32 v121, v121
    v_exp_f32 v122, v122
    v_exp_f32 v123, v123
    v_cvt_pk_bf16_f32 v104, v120, v121
    v_cvt_pk_bf16_f32 v105, v122, v123
    v_mfma_f32_32x32x16_bf16 v[136:151], v[56:59], v[48:51], v[136:151]
    ds_read_b128 v[56:59], v29 offset:28160
    ds_read_b64 v[68:69], v30 offset:28160
    buffer_load_dwordx4 v[188:191], v38, s[8:11], s27 offen offset:3072 sc1
    v_exp_f32 v124, v124
    v_exp_f32 v125, v125
    v_exp_f32 v126, v126
    v_exp_f32 v127, v127
    v_cvt_pk_bf16_f32 v106, v124, v125
    v_cvt_pk_bf16_f32 v107, v126, v127
    v_mfma_f32_32x32x16_bf16 v[88:103], v[60:63], v[112:115], v[88:103]
    v_exp_f32 v128, v128
    v_exp_f32 v129, v129
    v_exp_f32 v130, v130
    v_exp_f32 v131, v131
    v_cvt_pk_bf16_f32 v108, v128, v129
    v_cvt_pk_bf16_f32 v109, v130, v131
    v_mfma_f32_32x32x16_bf16 v[88:103], v[64:67], v[116:119], v[88:103]
    s_mov_b64 exec, s[44:45]
    ds_read_b128 v[60:63], v31 offset:25600
    ds_read_b128 v[64:67], v31 offset:26240
    s_mov_b64 exec, -1
    s_add_u32 s27, s27, 4096
    buffer_load_dwordx4 v[192:195], v38, s[8:11], s27 offen offset:0 sc1
    v_exp_f32 v132, v132
    v_exp_f32 v133, v133
    v_exp_f32 v134, v134
    v_exp_f32 v135, v135
    v_cvt_pk_bf16_f32 v110, v132, v133
    v_cvt_pk_bf16_f32 v111, v134, v135
    s_waitcnt lgkmcnt(2)
    v_mfma_f32_32x32x8_bf16 v[120:135], v[68:69], v[52:53], 0
    v_exp_f32 v136, v136
    v_exp_f32 v137, v137
    v_exp_f32 v138, v138
    v_exp_f32 v139, v139
    v_cvt_pk_bf16_f32 v112, v136, v137
    v_cvt_pk_bf16_f32 v113, v138, v139
    v_mfma_f32_32x32x16_bf16 v[120:135], v[56:59], v[44:47], v[120:135]
    s_add_u32 s27, s81, 40960
    s_add_u32 s25, s83, 143360
    s_cmp_eq_u32 s24, 0
    s_cselect_b32 s27, s27, s25
    buffer_load_dwordx4 v[196:199], v38, s[8:11], s27 offen offset:0 sc1
    v_exp_f32 v140, v140
    v_exp_f32 v141, v141
    v_exp_f32 v142, v142
    v_exp_f32 v143, v143
    v_cvt_pk_bf16_f32 v114, v140, v141
    v_cvt_pk_bf16_f32 v115, v142, v143
    s_waitcnt lgkmcnt(0)
    v_mfma_f32_32x32x16_bf16 v[72:87], v[60:63], v[104:107], v[72:87]
    buffer_load_dwordx4 v[200:203], v38, s[8:11], s27 offen offset:1024 sc1
    v_exp_f32 v144, v144
    v_exp_f32 v145, v145
    v_exp_f32 v146, v146
    v_exp_f32 v147, v147
    v_cvt_pk_bf16_f32 v116, v144, v145
    v_cvt_pk_bf16_f32 v117, v146, v147
    v_mfma_f32_32x32x16_bf16 v[72:87], v[64:67], v[108:111], v[72:87]
    v_exp_f32 v148, v148
    v_exp_f32 v149, v149
    v_exp_f32 v150, v150
    v_exp_f32 v151, v151
    v_cvt_pk_bf16_f32 v118, v148, v149
    v_cvt_pk_bf16_f32 v119, v150, v151
    s_waitcnt vmcnt(11)
    s_barrier
    s_setprio 3
    v_mfma_f32_32x32x8_bf16 v[136:151], v[68:69], v[54:55], 0
    buffer_load_dwordx4 v[204:207], v38, s[8:11], s27 offen offset:2048 sc1
    v_exp_f32 v120, v120
    v_exp_f32 v121, v121
    v_exp_f32 v122, v122
    v_exp_f32 v123, v123
    v_cvt_pk_bf16_f32 v104, v120, v121
    v_cvt_pk_bf16_f32 v105, v122, v123
    v_mfma_f32_32x32x16_bf16 v[136:151], v[56:59], v[48:51], v[136:151]
    ds_read_b128 v[56:59], v29 offset:40960
    ds_read_b64 v[68:69], v30 offset:40960
    v_exp_f32 v124, v124
    v_exp_f32 v125, v125
    v_exp_f32 v126, v126
    v_exp_f32 v127, v127
    v_cvt_pk_bf16_f32 v106, v124, v125
    v_cvt_pk_bf16_f32 v107, v126, v127
    v_mfma_f32_32x32x16_bf16 v[88:103], v[60:63], v[112:115], v[88:103]
    buffer_load_dwordx4 v[208:211], v38, s[8:11], s27 offen offset:3072 sc1
    v_exp_f32 v128, v128
    v_exp_f32 v129, v129
    v_exp_f32 v130, v130
    v_exp_f32 v131, v131
    v_cvt_pk_bf16_f32 v108, v128, v129
    v_cvt_pk_bf16_f32 v109, v130, v131
    v_mfma_f32_32x32x16_bf16 v[88:103], v[64:67], v[116:119], v[88:103]
    s_mov_b64 exec, s[44:45]
    ds_read_b128 v[60:63], v31 offset:28160
    ds_read_b128 v[64:67], v31 offset:28800
    s_mov_b64 exec, -1
    v_exp_f32 v132, v132
    v_exp_f32 v133, v133
    v_exp_f32 v134, v134
    v_exp_f32 v135, v135
    v_cvt_pk_bf16_f32 v110, v132, v133
    v_cvt_pk_bf16_f32 v111, v134, v135
    s_waitcnt lgkmcnt(2)
    v_mfma_f32_32x32x8_bf16 v[120:135], v[68:69], v[52:53], 0
    s_add_u32 s27, s27, 4096
    buffer_load_dwordx4 v[212:215], v38, s[8:11], s27 offen offset:0 sc1
    v_exp_f32 v136, v136
    v_exp_f32 v137, v137
    v_exp_f32 v138, v138
    v_exp_f32 v139, v139
    v_cvt_pk_bf16_f32 v112, v136, v137
    v_cvt_pk_bf16_f32 v113, v138, v139
    v_mfma_f32_32x32x16_bf16 v[120:135], v[56:59], v[44:47], v[120:135]
    v_exp_f32 v140, v140
    v_exp_f32 v141, v141
    v_exp_f32 v142, v142
    v_exp_f32 v143, v143
    v_cvt_pk_bf16_f32 v114, v140, v141
    v_cvt_pk_bf16_f32 v115, v142, v143
    s_waitcnt lgkmcnt(0)
    v_mfma_f32_32x32x16_bf16 v[72:87], v[60:63], v[104:107], v[72:87]
    v_exp_f32 v144, v144
    v_exp_f32 v145, v145
    v_exp_f32 v146, v146
    v_exp_f32 v147, v147
    v_cvt_pk_bf16_f32 v116, v144, v145
    v_cvt_pk_bf16_f32 v117, v146, v147
    v_mfma_f32_32x32x16_bf16 v[72:87], v[64:67], v[108:111], v[72:87]
    v_exp_f32 v148, v148
    v_exp_f32 v149, v149
    v_exp_f32 v150, v150
    v_exp_f32 v151, v151
    v_cvt_pk_bf16_f32 v118, v148, v149
    v_cvt_pk_bf16_f32 v119, v150, v151
    s_add_u32 s30, s33, 81920
    s_add_u32 m0, s32, 143360
    s_setprio 2
    v_mfma_f32_32x32x8_bf16 v[136:151], v[68:69], v[54:55], 0
    v_exp_f32 v120, v120
    v_exp_f32 v121, v121
    v_exp_f32 v122, v122
    v_exp_f32 v123, v123
    v_cvt_pk_bf16_f32 v104, v120, v121
    v_cvt_pk_bf16_f32 v105, v122, v123
    v_mfma_f32_32x32x16_bf16 v[136:151], v[56:59], v[48:51], v[136:151]
    ds_read_b128 v[56:59], v29 offset:43520
    ds_read_b64 v[68:69], v30 offset:43520
    buffer_load_dwordx4 v28, s[8:11], s30 offen offset:0 sc1 lds
    v_exp_f32 v124, v124
    v_exp_f32 v125, v125
    v_exp_f32 v126, v126
    v_exp_f32 v127, v127
    v_cvt_pk_bf16_f32 v106, v124, v125
    v_cvt_pk_bf16_f32 v107, v126, v127
    v_mfma_f32_32x32x16_bf16 v[88:103], v[60:63], v[112:115], v[88:103]
    v_exp_f32 v128, v128
    v_exp_f32 v129, v129
    v_exp_f32 v130, v130
    v_exp_f32 v131, v131
    v_cvt_pk_bf16_f32 v108, v128, v129
    v_cvt_pk_bf16_f32 v109, v130, v131
    v_mfma_f32_32x32x16_bf16 v[88:103], v[64:67], v[116:119], v[88:103]
    s_mov_b64 exec, s[44:45]
    ds_read_b128 v[60:63], v31 offset:40960
    ds_read_b128 v[64:67], v31 offset:41600
    s_mov_b64 exec, -1
    buffer_load_dwordx4 v28, s[8:11], s30 offen offset:1024 sc1 lds
    v_exp_f32 v132, v132
    v_exp_f32 v133, v133
    v_exp_f32 v134, v134
    v_exp_f32 v135, v135
    v_cvt_pk_bf16_f32 v110, v132, v133
    v_cvt_pk_bf16_f32 v111, v134, v135
    s_waitcnt lgkmcnt(2)
    v_mfma_f32_32x32x8_bf16 v[120:135], v[68:69], v[52:53], 0
    s_mov_b32 exec_hi, 0
    buffer_load_dwordx4 v28, s[8:11], s30 offen offset:2048 sc1 lds
    s_mov_b32 exec_hi, -1
    v_exp_f32 v136, v136
    v_exp_f32 v137, v137
    v_exp_f32 v138, v138
    v_exp_f32 v139, v139
    v_cvt_pk_bf16_f32 v112, v136, v137
    v_cvt_pk_bf16_f32 v113, v138, v139
    v_mfma_f32_32x32x16_bf16 v[120:135], v[56:59], v[44:47], v[120:135]
    s_mov_b32 m0, s32
    s_nop 0
    buffer_load_dwordx4 v28, s[8:11], s28 offen offset:0 sc1 lds
    v_exp_f32 v140, v140
    v_exp_f32 v141, v141
    v_exp_f32 v142, v142
    v_exp_f32 v143, v143
    v_cvt_pk_bf16_f32 v114, v140, v141
    v_cvt_pk_bf16_f32 v115, v142, v143
    s_waitcnt lgkmcnt(0)
    v_mfma_f32_32x32x16_bf16 v[72:87], v[60:63], v[104:107], v[72:87]
    s_mov_b32 m0, s32
    s_nop 0
    buffer_load_dwordx4 v28, s[8:11], s28 offen offset:1024 sc1 lds
    v_exp_f32 v144, v144
    v_exp_f32 v145, v145
    v_exp_f32 v146, v146
    v_exp_f32 v147, v147
    v_cvt_pk_bf16_f32 v116, v144, v145
    v_cvt_pk_bf16_f32 v117, v146, v147
    v_mfma_f32_32x32x16_bf16 v[72:87], v[64:67], v[108:111], v[72:87]
    v_exp_f32 v148, v148
    v_exp_f32 v149, v149
    v_exp_f32 v150, v150
    v_exp_f32 v151, v151
    v_cvt_pk_bf16_f32 v118, v148, v149
    v_cvt_pk_bf16_f32 v119, v150, v151
    s_setprio 1
    v_mfma_f32_32x32x8_bf16 v[136:151], v[68:69], v[54:55], 0
    s_mov_b32 m0, s32
    s_mov_b32 exec_hi, 0
    buffer_load_dwordx4 v28, s[8:11], s28 offen offset:2048 sc1 lds
    s_mov_b32 exec_hi, -1
    v_exp_f32 v120, v120
    v_exp_f32 v121, v121
    v_exp_f32 v122, v122
    v_exp_f32 v123, v123
    v_cvt_pk_bf16_f32 v104, v120, v121
    v_cvt_pk_bf16_f32 v105, v122, v123
    v_mfma_f32_32x32x16_bf16 v[136:151], v[56:59], v[48:51], v[136:151]
    ds_read_b128 v[56:59], v29 offset:46080
    ds_read_b64 v[68:69], v30 offset:46080
    v_exp_f32 v124, v124
    v_exp_f32 v125, v125
    v_exp_f32 v126, v126
    v_exp_f32 v127, v127
    v_cvt_pk_bf16_f32 v106, v124, v125
    v_cvt_pk_bf16_f32 v107, v126, v127
    v_mfma_f32_32x32x16_bf16 v[88:103], v[60:63], v[112:115], v[88:103]
    s_add_u32 s27, s81, 61440
    s_add_u32 s25, s83, 225280
    s_cmp_eq_u32 s24, 0
    s_cselect_b32 s27, s27, s25
    buffer_load_dwordx4 v[216:219], v38, s[8:11], s27 offen offset:0 sc1
    v_exp_f32 v128, v128
    v_exp_f32 v129, v129
    v_exp_f32 v130, v130
    v_exp_f32 v131, v131
    v_cvt_pk_bf16_f32 v108, v128, v129
    v_cvt_pk_bf16_f32 v109, v130, v131
    v_mfma_f32_32x32x16_bf16 v[88:103], v[64:67], v[116:119], v[88:103]
    s_mov_b64 exec, s[44:45]
    ds_read_b128 v[60:63], v31 offset:43520
    ds_read_b128 v[64:67], v31 offset:44160
    s_mov_b64 exec, -1
    v_exp_f32 v132, v132
    v_exp_f32 v133, v133
    v_exp_f32 v134, v134
    v_exp_f32 v135, v135
    v_cvt_pk_bf16_f32 v110, v132, v133
    v_cvt_pk_bf16_f32 v111, v134, v135
    s_waitcnt lgkmcnt(2)
    v_mfma_f32_32x32x8_bf16 v[120:135], v[68:69], v[52:53], 0
    buffer_load_dwordx4 v[220:223], v38, s[8:11], s27 offen offset:1024 sc1
    v_exp_f32 v136, v136
    v_exp_f32 v137, v137
    v_exp_f32 v138, v138
    v_exp_f32 v139, v139
    v_cvt_pk_bf16_f32 v112, v136, v137
    v_cvt_pk_bf16_f32 v113, v138, v139
    v_mfma_f32_32x32x16_bf16 v[120:135], v[56:59], v[44:47], v[120:135]
    v_exp_f32 v140, v140
    v_exp_f32 v141, v141
    v_exp_f32 v142, v142
    v_exp_f32 v143, v143
    v_cvt_pk_bf16_f32 v114, v140, v141
    v_cvt_pk_bf16_f32 v115, v142, v143
    s_waitcnt lgkmcnt(0)
    v_mfma_f32_32x32x16_bf16 v[72:87], v[60:63], v[104:107], v[72:87]
    buffer_load_dwordx4 v[224:227], v38, s[8:11], s27 offen offset:2048 sc1
    v_exp_f32 v144, v144
    v_exp_f32 v145, v145
    v_exp_f32 v146, v146
    v_exp_f32 v147, v147
    v_cvt_pk_bf16_f32 v116, v144, v145
    v_cvt_pk_bf16_f32 v117, v146, v147
    v_mfma_f32_32x32x16_bf16 v[72:87], v[64:67], v[108:111], v[72:87]
    v_exp_f32 v148, v148
    v_exp_f32 v149, v149
    v_exp_f32 v150, v150
    v_exp_f32 v151, v151
    v_cvt_pk_bf16_f32 v118, v148, v149
    v_cvt_pk_bf16_f32 v119, v150, v151
    s_setprio 0
    v_mfma_f32_32x32x8_bf16 v[136:151], v[68:69], v[54:55], 0
    buffer_load_dwordx4 v[228:231], v38, s[8:11], s27 offen offset:3072 sc1
    v_exp_f32 v120, v120
    v_exp_f32 v121, v121
    v_exp_f32 v122, v122
    v_exp_f32 v123, v123
    v_cvt_pk_bf16_f32 v104, v120, v121
    v_cvt_pk_bf16_f32 v105, v122, v123
    v_mfma_f32_32x32x16_bf16 v[136:151], v[56:59], v[48:51], v[136:151]
    ds_read_b128 v[56:59], v29 offset:48640
    ds_read_b64 v[68:69], v30 offset:48640
    v_exp_f32 v124, v124
    v_exp_f32 v125, v125
    v_exp_f32 v126, v126
    v_exp_f32 v127, v127
    v_cvt_pk_bf16_f32 v106, v124, v125
    v_cvt_pk_bf16_f32 v107, v126, v127
    v_mfma_f32_32x32x16_bf16 v[88:103], v[60:63], v[112:115], v[88:103]
    s_add_u32 s27, s27, 4096
    buffer_load_dwordx4 v[232:235], v38, s[8:11], s27 offen offset:0 sc1
    v_exp_f32 v128, v128
    v_exp_f32 v129, v129
    v_exp_f32 v130, v130
    v_exp_f32 v131, v131
    v_cvt_pk_bf16_f32 v108, v128, v129
    v_cvt_pk_bf16_f32 v109, v130, v131
    v_mfma_f32_32x32x16_bf16 v[88:103], v[64:67], v[116:119], v[88:103]
    s_mov_b64 exec, s[44:45]
    ds_read_b128 v[60:63], v31 offset:46080
    ds_read_b128 v[64:67], v31 offset:46720
    s_mov_b64 exec, -1
    v_exp_f32 v132, v132
    v_exp_f32 v133, v133
    v_exp_f32 v134, v134
    v_exp_f32 v135, v135
    v_cvt_pk_bf16_f32 v110, v132, v133
    v_cvt_pk_bf16_f32 v111, v134, v135
    s_waitcnt lgkmcnt(2)
    v_mfma_f32_32x32x8_bf16 v[120:135], v[68:69], v[52:53], 0
    s_add_u32 s27, s81, 81920
    s_add_u32 s25, s83, 245760
    s_cmp_eq_u32 s24, 0
    s_cselect_b32 s27, s27, s25
    buffer_load_dwordx4 v[236:239], v38, s[8:11], s27 offen offset:0 sc1
    v_exp_f32 v136, v136
    v_exp_f32 v137, v137
    v_exp_f32 v138, v138
    v_exp_f32 v139, v139
    v_cvt_pk_bf16_f32 v112, v136, v137
    v_cvt_pk_bf16_f32 v113, v138, v139
    v_mfma_f32_32x32x16_bf16 v[120:135], v[56:59], v[44:47], v[120:135]
    v_exp_f32 v140, v140
    v_exp_f32 v141, v141
    v_exp_f32 v142, v142
    v_exp_f32 v143, v143
    v_cvt_pk_bf16_f32 v114, v140, v141
    v_cvt_pk_bf16_f32 v115, v142, v143
    s_waitcnt lgkmcnt(0)
    v_mfma_f32_32x32x16_bf16 v[72:87], v[60:63], v[104:107], v[72:87]
    buffer_load_dwordx4 v[240:243], v38, s[8:11], s27 offen offset:1024 sc1
    v_exp_f32 v144, v144
    v_exp_f32 v145, v145
    v_exp_f32 v146, v146
    v_exp_f32 v147, v147
    v_cvt_pk_bf16_f32 v116, v144, v145
    v_cvt_pk_bf16_f32 v117, v146, v147
    v_mfma_f32_32x32x16_bf16 v[72:87], v[64:67], v[108:111], v[72:87]
    v_exp_f32 v148, v148
    v_exp_f32 v149, v149
    v_exp_f32 v150, v150
    v_exp_f32 v151, v151
    v_cvt_pk_bf16_f32 v118, v148, v149
    v_cvt_pk_bf16_f32 v119, v150, v151
    s_waitcnt vmcnt(10)
    s_barrier
    s_setprio 3
    v_mfma_f32_32x32x8_bf16 v[136:151], v[68:69], v[54:55], 0
    buffer_load_dwordx4 v[244:247], v38, s[8:11], s27 offen offset:2048 sc1
    v_exp_f32 v120, v120
    v_exp_f32 v121, v121
    v_exp_f32 v122, v122
    v_exp_f32 v123, v123
    v_cvt_pk_bf16_f32 v104, v120, v121
    v_cvt_pk_bf16_f32 v105, v122, v123
    v_mfma_f32_32x32x16_bf16 v[136:151], v[56:59], v[48:51], v[136:151]
    v_exp_f32 v124, v124
    v_exp_f32 v125, v125
    v_exp_f32 v126, v126
    v_exp_f32 v127, v127
    v_cvt_pk_bf16_f32 v106, v124, v125
    v_cvt_pk_bf16_f32 v107, v126, v127
    v_mfma_f32_32x32x16_bf16 v[88:103], v[60:63], v[112:115], v[88:103]
    buffer_load_dwordx4 v[248:251], v38, s[8:11], s27 offen offset:3072 sc1
    v_exp_f32 v128, v128
    v_exp_f32 v129, v129
    v_exp_f32 v130, v130
    v_exp_f32 v131, v131
    v_cvt_pk_bf16_f32 v108, v128, v129
    v_cvt_pk_bf16_f32 v109, v130, v131
    v_mfma_f32_32x32x16_bf16 v[88:103], v[64:67], v[116:119], v[88:103]
    s_mov_b64 exec, s[44:45]
    ds_read_b128 v[60:63], v31 offset:48640
    ds_read_b128 v[64:67], v31 offset:49280
    s_mov_b64 exec, -1
    v_exp_f32 v132, v132
    v_exp_f32 v133, v133
    v_exp_f32 v134, v134
    v_exp_f32 v135, v135
    v_cvt_pk_bf16_f32 v110, v132, v133
    v_cvt_pk_bf16_f32 v111, v134, v135
    s_add_u32 s27, s27, 4096
    buffer_load_dwordx4 v[252:255], v38, s[8:11], s27 offen offset:0 sc1
    v_exp_f32 v136, v136
    v_exp_f32 v137, v137
    v_exp_f32 v138, v138
    v_exp_f32 v139, v139
    v_cvt_pk_bf16_f32 v112, v136, v137
    v_cvt_pk_bf16_f32 v113, v138, v139
    v_exp_f32 v140, v140
    v_exp_f32 v141, v141
    v_exp_f32 v142, v142
    v_exp_f32 v143, v143
    v_cvt_pk_bf16_f32 v114, v140, v141
    v_cvt_pk_bf16_f32 v115, v142, v143
    s_waitcnt lgkmcnt(0)
    v_mfma_f32_32x32x16_bf16 v[72:87], v[60:63], v[104:107], v[72:87]
    v_exp_f32 v144, v144
    v_exp_f32 v145, v145
    v_exp_f32 v146, v146
    v_exp_f32 v147, v147
    v_cvt_pk_bf16_f32 v116, v144, v145
    v_cvt_pk_bf16_f32 v117, v146, v147
    v_mfma_f32_32x32x16_bf16 v[72:87], v[64:67], v[108:111], v[72:87]
    v_exp_f32 v148, v148
    v_exp_f32 v149, v149
    v_exp_f32 v150, v150
    v_exp_f32 v151, v151
    v_cvt_pk_bf16_f32 v118, v148, v149
    v_cvt_pk_bf16_f32 v119, v150, v151
    s_setprio 0
    v_mfma_f32_32x32x16_bf16 v[88:103], v[60:63], v[112:115], v[88:103]
    v_mfma_f32_32x32x16_bf16 v[88:103], v[64:67], v[116:119], v[88:103]
    s_nop 3
    ds_write_b128 v34, v[72:75] offset:0
    ds_write_b128 v34, v[76:79] offset:1024
    ds_write_b128 v34, v[80:83] offset:2048
    s_lshl_b32 s26, s97, 3
    s_and_b32 s27, s96, 7
    s_add_u32 s26, s26, s27
    s_lshr_b32 s27, s96, 3
    s_lshl_b32 s36, s26, 7
    s_lshl_b32 s25, s27, 2
    s_add_u32 s36, s36, s25
    s_add_u32 s36, s36, 25749504
    s_waitcnt lgkmcnt(0)
    s_barrier
    ds_read_b128 v[72:75], v35 offset:0
    ds_read_b128 v[76:79], v35 offset:1024
    ds_read_b128 v[80:83], v35 offset:2048
    s_waitcnt lgkmcnt(0)
    v_pk_add_f32 v[96:97], v[96:97], v[80:81]
    v_pk_add_f32 v[98:99], v[98:99], v[82:83]
    v_pk_add_f32 v[88:89], v[88:89], v[72:73]
    v_pk_add_f32 v[90:91], v[90:91], v[74:75]
    v_pk_add_f32 v[92:93], v[92:93], v[76:77]
    v_pk_add_f32 v[94:95], v[94:95], v[78:79]
fin_66:
    v_mov_b32 v100, v96
    v_mov_b32 v101, v96
    s_nop 1
    v_permlane32_swap_b32 v101, v100
    v_rcp_f32 v102, v100
    s_nop 0
    v_pk_mul_f32 v[88:89], v[88:89], v[102:103] op_sel_hi:[1,0]
    v_pk_mul_f32 v[90:91], v[90:91], v[102:103] op_sel_hi:[1,0]
    v_pk_mul_f32 v[92:93], v[92:93], v[102:103] op_sel_hi:[1,0]
    v_pk_mul_f32 v[94:95], v[94:95], v[102:103] op_sel_hi:[1,0]
    v_pk_mul_f32 v[96:97], v[96:97], v[102:103] op_sel_hi:[1,0]
    v_pk_mul_f32 v[98:99], v[98:99], v[102:103] op_sel_hi:[1,0]
    v_cvt_pk_bf16_f32 v104, v88, v89
    v_cvt_pk_bf16_f32 v105, v90, v91
    v_cvt_pk_bf16_f32 v106, v92, v93
    v_cvt_pk_bf16_f32 v107, v94, v95
    v_cvt_pk_bf16_f32 v108, v96, v97
    v_cvt_pk_bf16_f32 v109, v98, v99
    buffer_store_dwordx4 v[104:107], v36, s[8:11], s58 offen sc1
    s_mov_b32 exec_hi, 0
    buffer_store_dwordx2 v[108:109], v37, s[8:11], s59 offen sc1
    s_mov_b32 exec_hi, -1
    s_cmp_lg_u32 s43, 0
    s_cbranch_scc1 ok_67
    v_mov_b32 v9, v100
    v_fma_f32 v9, v88, 0, v9
    v_fma_f32 v9, v89, 0, v9
    v_fma_f32 v9, v90, 0, v9
    v_fma_f32 v9, v91, 0, v9
    v_fma_f32 v9, v92, 0, v9
    v_fma_f32 v9, v93, 0, v9
    v_fma_f32 v9, v94, 0, v9
    v_fma_f32 v9, v95, 0, v9
    v_fma_f32 v9, v96, 0, v9
    v_fma_f32 v9, v97, 0, v9
    v_fma_f32 v9, v98, 0, v9
    v_fma_f32 v9, v99, 0, v9
    s_mov_b32 s25, 0x1f800000
    v_cmp_nle_f32 s[46:47], s25, v9
    s_mov_b32 s25, 0x5f800000
    v_cmp_nge_f32 vcc, s25, v9
    s_nop 1
    s_or_b64 vcc, vcc, s[46:47]
    s_cbranch_vccnz slow_65
ok_67:
    s_cmp_ge_u32 s20, 4
    s_cbranch_scc1 prod_68
    v_mov_b32 v9, v38
    ds_read_b128 v[48:51], v13 offset:0
    ds_read_b128 v[52:55], v13 offset:1024
    ds_read_b128 v[56:59], v13 offset:2048
    ds_read_b128 v[60:63], v13 offset:3072
    ds_read_b128 v[64:67], v13 offset:4096
    ds_read_b128 v[68:71], v13 offset:5120
    ds_read_b128 v[72:75], v13 offset:6144
    v_min3_u32 v6, v152, v153, v154
    v_min_u32 v6, v6, v155
    v_max3_u32 v7, v152, v153, v154
    v_max_u32 v7, v7, v155
    s_getreg_b32 s26, hwreg(HW_REG_XCC_ID, 0, 4)
    s_add_u32 s26, s26, 1
    v_cmp_ne_u32 vcc, s26, v6
    v_cmp_ne_u32 s[46:47], s26, v7
    s_lshl_b32 s25, s21, 3
    s_nop 1
    s_or_b64 s[46:47], s[46:47], vcc
    s_lshr_b64 s[46:47], s[46:47], s25
    s_and_b32 s25, s46, 0xff
    s_cselect_b32 s42, 0, 1
    s_lshr_b32 s35, s76, 1
    s_lshl_b32 s26, s21, 3
    s_lshl_b32 s37, s26, 7
    s_add_u32 s37, s37, 25749504
    s_mul_i32 s81, s76, 20480
    s_add_u32 s81, s81, 7884800
    v_lshlrev_b32 v80, 16, v18
    v_and_b32 v81, 0xffff0000, v18
    v_lshlrev_b32 v82, 16, v19
    v_and_b32 v83, 0xffff0000, v19
    v_lshlrev_b32 v84, 16, v20
    v_and_b32 v85, 0xffff0000, v20
    v_lshlrev_b32 v86, 16, v21
    v_and_b32 v87, 0xffff0000, v21
    v_lshlrev_b32 v88, 16, v22
    v_and_b32 v89, 0xffff0000, v22
    v_lshlrev_b32 v90, 16, v23
    v_and_b32 v91, 0xffff0000, v23
    v_lshlrev_b32 v92, 16, v24
    v_and_b32 v93, 0xffff0000, v24
    v_lshlrev_b32 v94, 16, v25
    v_and_b32 v95, 0xffff0000, v25
    v_lshlrev_b32 v96, 16, v26
    v_and_b32 v97, 0xffff0000, v26
    v_lshlrev_b32 v98, 16, v27
    v_and_b32 v99, 0xffff0000, v27
    v_and_b32 v7, 7, v1
    v_lshlrev_b32 v7, 7, v7
    v_lshrrev_b32 v6, 3, v1
    v_lshl_add_u32 v7, v6, 2, v7
    s_waitcnt vmcnt(0)
    s_barrier
    v_add_u32 v8, 20480, v9
    ds_write_b128 v8, v[156:159] offset:0
    ds_write_b128 v8, v[160:163] offset:1024
    ds_write_b128 v8, v[164:167] offset:2048
    ds_write_b128 v8, v[168:171] offset:3072
    ds_write_b128 v8, v[172:175] offset:4096
    s_sleep 5
    s_mov_b32 s26, 0
    s_mov_b32 exec_hi, 0
    buffer_load_dword v11, v7, s[8:11], s37 offen sc1
    s_mov_b64 exec, -1
    v_add_u32 v8, 40960, v9
    ds_write_b128 v8, v[176:179] offset:0
    ds_write_b128 v8, v[180:183] offset:1024
    ds_write_b128 v8, v[184:187] offset:2048
    ds_write_b128 v8, v[188:191] offset:3072
    ds_write_b128 v8, v[192:195] offset:4096
    s_mov_b32 exec_hi, 0
    s_branch poll_71
poll_69:
    buffer_load_dword v11, v7, s[8:11], s37 offen sc1
    s_add_u32 s26, s26, 1
    s_cmp_gt_u32 s26, 200000
    s_cbranch_scc1 poll_70
poll_71:
    s_waitcnt vmcnt(0)
    v_cmp_ne_u32 vcc, 1, v11
    s_cbranch_vccz poll_70
    s_sleep 2
    s_branch poll_69
poll_70:
    s_mov_b64 exec, -1
    s_add_u32 s41, s81, 0
    buffer_load_dwordx4 v[112:115], v2, s[8:11], s41 offen offset:0 sc1
    buffer_load_dwordx4 v[116:119], v2, s[8:11], s41 offen offset:1024 sc1
    buffer_load_dwordx4 v[120:123], v2, s[8:11], s41 offen offset:2048 sc1
    buffer_load_dwordx4 v[124:127], v2, s[8:11], s41 offen offset:3072 sc1
    s_add_u32 s41, s81, 4096
    buffer_load_dwordx4 v[128:131], v2, s[8:11], s41 offen offset:0 sc1
    buffer_load_dwordx4 v[132:135], v2, s[8:11], s41 offen offset:1024 sc1
    s_min_u32 s38, s79, 13
    s_lshl_b32 s38, s38, 9
    s_add_u32 s38, s38, 25783296
    v_and_b32 v6, 0x7c, v3
    buffer_load_dword v40, v6, s[8:11], s38 offen offset:0 sc1
    buffer_load_dword v42, v6, s[8:11], s38 offen offset:128 sc1
    buffer_load_dword v44, v6, s[8:11], s38 offen offset:256 sc1
    buffer_load_dword v46, v6, s[8:11], s38 offen offset:384 sc1
    s_mul_i32 s82, s35, 40960
    s_and_b32 s27, s76, 1
    s_lshl_b32 s26, s27, 8
    s_add_u32 s82, s82, s26
    s_add_u32 s82, s82, 10506240
    s_lshl_b32 s26, s77, 10
    s_add_u32 s58, s82, s26
    s_add_u32 s58, s58, 32768
    s_lshl_b32 s26, s77, 12
    s_add_u32 s82, s82, s26
    v_lshlrev_b32 v10, 1, v17
    s_lshl_b32 s26, s77, 1
    s_add_u32 s27, s27, s26
    s_lshl_b32 s36, s35, 7
    s_lshl_b32 s25, s27, 2
    s_add_u32 s36, s36, s25
    s_add_u32 s36, s36, 25757696
    s_lshl_b32 s39, s78, 7
    s_lshl_b32 s25, s79, 2
    s_add_u32 s39, s39, s25
    s_add_u32 s39, s39, 25765888
    s_lshl_b32 s31, s35, 7
    s_add_u32 s31, s31, 25765888
    s_lshl_b32 s59, s77, 14
    s_lshl_b32 s26, s76, 7
    s_add_u32 s59, s59, s26
    s_add_u32 s59, s59, 25532416
    v_lshlrev_b32 v34, 1, v3
    v_lshrrev_b32 v35, 5, v1
    s_mul_i32 s40, s76, 55296
    s_add_u32 s40, s40, 13127680
    s_mov_b32 s16, s4
    s_mov_b32 s17, s5
    s_mov_b32 s18, 25794560
    s_mov_b32 s19, 0x20000
    s_cmp_ge_u32 s79, 14
    s_cselect_b32 s18, 0, s18
    s_mov_b32 s12, s56
    s_mov_b32 s13, s57
    s_mov_b32 s14, 2621440
    s_mov_b32 s15, 0x20000
    s_lshl_b32 s37, s78, 7
    s_add_u32 s37, s37, 25757696
    s_waitcnt vmcnt(9) lgkmcnt(5)
    v_mfma_f32_16x16x32_bf16 v[80:83], v[48:51], v[112:115], v[80:83]
    ds_read_b128 v[76:79], v13 offset:7168
    buffer_load_dwordx4 v[136:139], v2, s[8:11], s41 offen offset:2048 sc1
    v_mfma_f32_16x16x32_bf16 v[84:87], v[52:55], v[112:115], v[84:87]
    ds_read_b128 v[48:51], v13 offset:8192
    buffer_load_dwordx4 v[140:143], v2, s[8:11], s41 offen offset:3072 sc1
    s_waitcnt lgkmcnt(5)
    v_mfma_f32_16x16x32_bf16 v[88:91], v[56:59], v[112:115], v[88:91]
    ds_read_b128 v[52:55], v13 offset:9216
    s_add_u32 s41, s81, 8192
    buffer_load_dwordx4 v[144:147], v2, s[8:11], s41 offen offset:0 sc1
    v_mfma_f32_16x16x32_bf16 v[92:95], v[60:63], v[112:115], v[92:95]
    ds_read_b128 v[56:59], v13 offset:10240
    s_waitcnt lgkmcnt(5)
    v_mfma_f32_16x16x32_bf16 v[96:99], v[64:67], v[112:115], v[96:99]
    ds_read_b128 v[60:63], v13 offset:11264
    s_waitcnt vmcnt(11)
    v_mfma_f32_16x16x32_bf16 v[80:83], v[68:71], v[116:119], v[80:83]
    ds_read_b128 v[64:67], v13 offset:12288
    buffer_load_dwordx4 v[148:151], v2, s[8:11], s41 offen offset:1024 sc1
    s_waitcnt lgkmcnt(5)
    v_mfma_f32_16x16x32_bf16 v[84:87], v[72:75], v[116:119], v[84:87]
    ds_read_b128 v[68:71], v13 offset:13312
    v_mfma_f32_16x16x32_bf16 v[88:91], v[76:79], v[116:119], v[88:91]
    ds_read_b128 v[72:75], v13 offset:14336
    s_waitcnt lgkmcnt(5)
    v_mfma_f32_16x16x32_bf16 v[92:95], v[48:51], v[116:119], v[92:95]
    ds_read_b128 v[76:79], v13 offset:15360
    v_mfma_f32_16x16x32_bf16 v[96:99], v[52:55], v[116:119], v[96:99]
    ds_read_b128 v[48:51], v13 offset:16384
    s_waitcnt vmcnt(11) lgkmcnt(5)
    v_mfma_f32_16x16x32_bf16 v[80:83], v[56:59], v[120:123], v[80:83]
    ds_read_b128 v[52:55], v13 offset:17408
    buffer_load_dwordx4 v[152:155], v2, s[8:11], s41 offen offset:2048 sc1
    v_mfma_f32_16x16x32_bf16 v[84:87], v[60:63], v[120:123], v[84:87]
    ds_read_b128 v[56:59], v13 offset:18432
    s_waitcnt lgkmcnt(5)
    v_mfma_f32_16x16x32_bf16 v[88:91], v[64:67], v[120:123], v[88:91]
    ds_read_b128 v[60:63], v13 offset:19456
    v_mfma_f32_16x16x32_bf16 v[92:95], v[68:71], v[120:123], v[92:95]
    ds_read_b128 v[64:67], v13 offset:20480
    s_waitcnt lgkmcnt(5)
    v_mfma_f32_16x16x32_bf16 v[96:99], v[72:75], v[120:123], v[96:99]
    ds_read_b128 v[68:71], v13 offset:21504
    s_waitcnt vmcnt(11)
    v_mfma_f32_16x16x32_bf16 v[80:83], v[76:79], v[124:127], v[80:83]
    ds_read_b128 v[72:75], v13 offset:22528
    buffer_load_dwordx4 v[112:115], v2, s[8:11], s41 offen offset:3072 sc1
    s_waitcnt lgkmcnt(5)
    v_mfma_f32_16x16x32_bf16 v[84:87], v[48:51], v[124:127], v[84:87]
    ds_read_b128 v[76:79], v13 offset:23552
    v_mfma_f32_16x16x32_bf16 v[88:91], v[52:55], v[124:127], v[88:91]
    ds_read_b128 v[48:51], v13 offset:24576
    s_waitcnt lgkmcnt(5)
    v_mfma_f32_16x16x32_bf16 v[92:95], v[56:59], v[124:127], v[92:95]
    ds_read_b128 v[52:55], v13 offset:25600
    v_mfma_f32_16x16x32_bf16 v[96:99], v[60:63], v[124:127], v[96:99]
    ds_read_b128 v[56:59], v13 offset:26624
    s_waitcnt vmcnt(11) lgkmcnt(5)
    v_mfma_f32_16x16x32_bf16 v[80:83], v[64:67], v[128:131], v[80:83]
    ds_read_b128 v[60:63], v13 offset:27648
    s_add_u32 s41, s81, 12288
    buffer_load_dwordx4 v[116:119], v2, s[8:11], s41 offen offset:0 sc1
    v_mfma_f32_16x16x32_bf16 v[84:87], v[68:71], v[128:131], v[84:87]
    ds_read_b128 v[64:67], v13 offset:28672
    s_waitcnt lgkmcnt(5)
    v_mfma_f32_16x16x32_bf16 v[88:91], v[72:75], v[128:131], v[88:91]
    ds_read_b128 v[68:71], v13 offset:29696
    v_mfma_f32_16x16x32_bf16 v[92:95], v[76:79], v[128:131], v[92:95]
    ds_read_b128 v[72:75], v13 offset:30720
    s_waitcnt lgkmcnt(5)
    v_mfma_f32_16x16x32_bf16 v[96:99], v[48:51], v[128:131], v[96:99]
    ds_read_b128 v[76:79], v13 offset:31744
    s_waitcnt vmcnt(11)
    v_mfma_f32_16x16x32_bf16 v[80:83], v[52:55], v[132:135], v[80:83]
    ds_read_b128 v[48:51], v13 offset:32768
    buffer_load_dwordx4 v[120:123], v2, s[8:11], s41 offen offset:1024 sc1
    s_waitcnt lgkmcnt(5)
    v_mfma_f32_16x16x32_bf16 v[84:87], v[56:59], v[132:135], v[84:87]
    ds_read_b128 v[52:55], v13 offset:33792
    v_mfma_f32_16x16x32_bf16 v[88:91], v[60:63], v[132:135], v[88:91]
    ds_read_b128 v[56:59], v13 offset:34816
    s_waitcnt lgkmcnt(5)
    v_mfma_f32_16x16x32_bf16 v[92:95], v[64:67], v[132:135], v[92:95]
    ds_read_b128 v[60:63], v13 offset:35840
    v_mfma_f32_16x16x32_bf16 v[96:99], v[68:71], v[132:135], v[96:99]
    ds_read_b128 v[64:67], v13 offset:36864
    s_waitcnt vmcnt(7) lgkmcnt(5)
    v_mfma_f32_16x16x32_bf16 v[80:83], v[72:75], v[136:139], v[80:83]
    ds_read_b128 v[68:71], v13 offset:37888
    buffer_load_dwordx4 v[124:127], v2, s[8:11], s41 offen offset:2048 sc1
    v_mfma_f32_16x16x32_bf16 v[84:87], v[76:79], v[136:139], v[84:87]
    ds_read_b128 v[72:75], v13 offset:38912
    s_waitcnt lgkmcnt(5)
    v_mfma_f32_16x16x32_bf16 v[88:91], v[48:51], v[136:139], v[88:91]
    ds_read_b128 v[76:79], v13 offset:39936
    v_mfma_f32_16x16x32_bf16 v[92:95], v[52:55], v[136:139], v[92:95]
    ds_read_b128 v[48:51], v13 offset:40960
    s_waitcnt lgkmcnt(5)
    v_mfma_f32_16x16x32_bf16 v[96:99], v[56:59], v[136:139], v[96:99]
    ds_read_b128 v[52:55], v13 offset:41984
    s_waitcnt vmcnt(7)
    v_mfma_f32_16x16x32_bf16 v[80:83], v[60:63], v[140:143], v[80:83]
    ds_read_b128 v[56:59], v13 offset:43008
    buffer_load_dwordx4 v[128:131], v2, s[8:11], s41 offen offset:3072 sc1
    s_waitcnt lgkmcnt(5)
    v_mfma_f32_16x16x32_bf16 v[84:87], v[64:67], v[140:143], v[84:87]
    ds_read_b128 v[60:63], v13 offset:44032
    v_mfma_f32_16x16x32_bf16 v[88:91], v[68:71], v[140:143], v[88:91]
    ds_read_b128 v[64:67], v13 offset:45056
    s_waitcnt lgkmcnt(5)
    v_mfma_f32_16x16x32_bf16 v[92:95], v[72:75], v[140:143], v[92:95]
    ds_read_b128 v[68:71], v13 offset:46080
    v_mfma_f32_16x16x32_bf16 v[96:99], v[76:79], v[140:143], v[96:99]
    ds_read_b128 v[72:75], v13 offset:47104
    s_waitcnt vmcnt(7) lgkmcnt(5)
    v_mfma_f32_16x16x32_bf16 v[80:83], v[48:51], v[144:147], v[80:83]
    ds_read_b128 v[76:79], v13 offset:48128
    s_add_u32 s41, s81, 16384
    buffer_load_dwordx2 v[132:133], v17, s[8:11], s41 offen offset:0 sc1
    buffer_load_dwordx2 v[134:135], v17, s[8:11], s41 offen offset:128 sc1
    v_mfma_f32_16x16x32_bf16 v[84:87], v[52:55], v[144:147], v[84:87]
    ds_read_b128 v[48:51], v13 offset:49152
    s_waitcnt lgkmcnt(5)
    v_mfma_f32_16x16x32_bf16 v[88:91], v[56:59], v[144:147], v[88:91]
    ds_read_b128 v[52:55], v13 offset:50176
    v_mfma_f32_16x16x32_bf16 v[92:95], v[60:63], v[144:147], v[92:95]
    ds_read_b128 v[56:59], v13 offset:51200
    s_waitcnt lgkmcnt(5)
    v_mfma_f32_16x16x32_bf16 v[96:99], v[64:67], v[144:147], v[96:99]
    ds_read_b128 v[60:63], v13 offset:52224
    s_waitcnt vmcnt(8)
    v_mfma_f32_16x16x32_bf16 v[80:83], v[68:71], v[148:151], v[80:83]
    ds_read_b128 v[64:67], v13 offset:53248
    buffer_load_dwordx2 v[136:137], v17, s[8:11], s41 offen offset:1024 sc1
    buffer_load_dwordx2 v[138:139], v17, s[8:11], s41 offen offset:1152 sc1
    s_waitcnt lgkmcnt(5)
    v_mfma_f32_16x16x32_bf16 v[84:87], v[72:75], v[148:151], v[84:87]
    ds_read_b128 v[68:71], v13 offset:54272
    v_mfma_f32_16x16x32_bf16 v[88:91], v[76:79], v[148:151], v[88:91]
    ds_read_b128 v[72:75], v13 offset:55296
    s_waitcnt lgkmcnt(5)
    v_mfma_f32_16x16x32_bf16 v[92:95], v[48:51], v[148:151], v[92:95]
    ds_read_b128 v[76:79], v13 offset:56320
    v_mfma_f32_16x16x32_bf16 v[96:99], v[52:55], v[148:151], v[96:99]
    ds_read_b128 v[48:51], v13 offset:57344
    s_waitcnt vmcnt(9) lgkmcnt(5)
    v_mfma_f32_16x16x32_bf16 v[80:83], v[56:59], v[152:155], v[80:83]
    ds_read_b128 v[52:55], v13 offset:58368
    buffer_load_dwordx2 v[140:141], v17, s[8:11], s41 offen offset:2048 sc1
    buffer_load_dwordx2 v[142:143], v17, s[8:11], s41 offen offset:2176 sc1
    v_mfma_f32_16x16x32_bf16 v[84:87], v[60:63], v[152:155], v[84:87]
    ds_read_b128 v[56:59], v13 offset:59392
    s_waitcnt lgkmcnt(5)
    v_mfma_f32_16x16x32_bf16 v[88:91], v[64:67], v[152:155], v[88:91]
    ds_read_b128 v[60:63], v13 offset:60416
    v_mfma_f32_16x16x32_bf16 v[92:95], v[68:71], v[152:155], v[92:95]
    ds_read_b128 v[64:67], v14 offset:0
    s_waitcnt lgkmcnt(5)
    v_mfma_f32_16x16x32_bf16 v[96:99], v[72:75], v[152:155], v[96:99]
    ds_read_b128 v[68:71], v14 offset:1024
    s_waitcnt vmcnt(10)
    v_mfma_f32_16x16x32_bf16 v[80:83], v[76:79], v[112:115], v[80:83]
    ds_read_b128 v[72:75], v14 offset:2048
    buffer_load_dwordx2 v[144:145], v17, s[8:11], s41 offen offset:3072 sc1
    buffer_load_dwordx2 v[146:147], v17, s[8:11], s41 offen offset:3200 sc1
    s_waitcnt lgkmcnt(5)
    v_mfma_f32_16x16x32_bf16 v[84:87], v[48:51], v[112:115], v[84:87]
    ds_read_b128 v[76:79], v14 offset:3072
    v_mfma_f32_16x16x32_bf16 v[88:91], v[52:55], v[112:115], v[88:91]
    ds_read_b128 v[48:51], v14 offset:4096
    s_waitcnt lgkmcnt(5)
    v_mfma_f32_16x16x32_bf16 v[92:95], v[56:59], v[112:115], v[92:95]
    ds_read_b128 v[52:55], v14 offset:5120
    v_mfma_f32_16x16x32_bf16 v[96:99], v[60:63], v[112:115], v[96:99]
    ds_read_b128 v[56:59], v14 offset:6144
    s_waitcnt vmcnt(11) lgkmcnt(5)
    v_mfma_f32_16x16x32_bf16 v[80:83], v[64:67], v[116:119], v[80:83]
    ds_read_b128 v[60:63], v14 offset:7168
    v_mfma_f32_16x16x32_bf16 v[84:87], v[68:71], v[116:119], v[84:87]
    ds_read_b128 v[64:67], v14 offset:8192
    s_waitcnt lgkmcnt(5)
    v_mfma_f32_16x16x32_bf16 v[88:91], v[72:75], v[116:119], v[88:91]
    ds_read_b128 v[68:71], v14 offset:9216
    v_mfma_f32_16x16x32_bf16 v[92:95], v[76:79], v[116:119], v[92:95]
    ds_read_b128 v[72:75], v14 offset:10240
    s_waitcnt lgkmcnt(5)
    v_mfma_f32_16x16x32_bf16 v[96:99], v[48:51], v[116:119], v[96:99]
    ds_read_b128 v[76:79], v14 offset:11264
    s_waitcnt vmcnt(10)
    v_mfma_f32_16x16x32_bf16 v[80:83], v[52:55], v[120:123], v[80:83]
    ds_read_b128 v[48:51], v14 offset:12288
    s_waitcnt lgkmcnt(5)
    v_mfma_f32_16x16x32_bf16 v[84:87], v[56:59], v[120:123], v[84:87]
    ds_read_b128 v[52:55], v14 offset:13312
    v_mfma_f32_16x16x32_bf16 v[88:91], v[60:63], v[120:123], v[88:91]
    ds_read_b128 v[56:59], v14 offset:14336
    s_waitcnt lgkmcnt(5)
    v_mfma_f32_16x16x32_bf16 v[92:95], v[64:67], v[120:123], v[92:95]
    ds_read_b128 v[60:63], v14 offset:15360
    v_mfma_f32_16x16x32_bf16 v[96:99], v[68:71], v[120:123], v[96:99]
    ds_read_b128 v[64:67], v14 offset:16384
    s_waitcnt vmcnt(9) lgkmcnt(5)
    v_mfma_f32_16x16x32_bf16 v[80:83], v[72:75], v[124:127], v[80:83]
    ds_read_b128 v[68:71], v14 offset:17408
    v_mfma_f32_16x16x32_bf16 v[84:87], v[76:79], v[124:127], v[84:87]
    ds_read_b128 v[72:75], v14 offset:18432
    s_waitcnt lgkmcnt(5)
    v_mfma_f32_16x16x32_bf16 v[88:91], v[48:51], v[124:127], v[88:91]
    ds_read_b128 v[76:79], v14 offset:19456
    v_mfma_f32_16x16x32_bf16 v[92:95], v[52:55], v[124:127], v[92:95]
    ds_read_b128 v[48:51], v14 offset:20480
    s_waitcnt lgkmcnt(5)
    v_mfma_f32_16x16x32_bf16 v[96:99], v[56:59], v[124:127], v[96:99]
    ds_read_b128 v[52:55], v14 offset:21504
    s_waitcnt vmcnt(8)
    v_mfma_f32_16x16x32_bf16 v[80:83], v[60:63], v[128:131], v[80:83]
    ds_read_b128 v[56:59], v14 offset:22528
    s_waitcnt lgkmcnt(5)
    v_mfma_f32_16x16x32_bf16 v[84:87], v[64:67], v[128:131], v[84:87]
    ds_read_b128 v[60:63], v14 offset:23552
    v_mfma_f32_16x16x32_bf16 v[88:91], v[68:71], v[128:131], v[88:91]
    ds_read_b128 v[64:67], v14 offset:24576
    s_waitcnt lgkmcnt(5)
    v_mfma_f32_16x16x32_bf16 v[92:95], v[72:75], v[128:131], v[92:95]
    ds_read_b128 v[68:71], v14 offset:25600
    v_mfma_f32_16x16x32_bf16 v[96:99], v[76:79], v[128:131], v[96:99]
    ds_read_b128 v[72:75], v14 offset:26624
    s_waitcnt vmcnt(6) lgkmcnt(5)
    v_mfma_f32_16x16x32_bf16 v[80:83], v[48:51], v[132:135], v[80:83]
    ds_read_b128 v[76:79], v14 offset:27648
    v_mfma_f32_16x16x32_bf16 v[84:87], v[52:55], v[132:135], v[84:87]
    ds_read_b128 v[48:51], v14 offset:28672
    s_waitcnt lgkmcnt(5)
    v_mfma_f32_16x16x32_bf16 v[88:91], v[56:59], v[132:135], v[88:91]
    ds_read_b128 v[52:55], v14 offset:29696
    v_mfma_f32_16x16x32_bf16 v[92:95], v[60:63], v[132:135], v[92:95]
    ds_read_b128 v[56:59], v14 offset:30720
    s_waitcnt lgkmcnt(5)
    v_mfma_f32_16x16x32_bf16 v[96:99], v[64:67], v[132:135], v[96:99]
    ds_read_b128 v[60:63], v14 offset:31744
    s_waitcnt vmcnt(4)
    v_mfma_f32_16x16x32_bf16 v[80:83], v[68:71], v[136:139], v[80:83]
    ds_read_b128 v[64:67], v14 offset:32768
    s_waitcnt lgkmcnt(5)
    v_mfma_f32_16x16x32_bf16 v[84:87], v[72:75], v[136:139], v[84:87]
    ds_read_b128 v[68:71], v14 offset:33792
    v_mfma_f32_16x16x32_bf16 v[88:91], v[76:79], v[136:139], v[88:91]
    ds_read_b128 v[72:75], v14 offset:34816
    s_waitcnt lgkmcnt(5)
    v_mfma_f32_16x16x32_bf16 v[92:95], v[48:51], v[136:139], v[92:95]
    ds_read_b128 v[76:79], v14 offset:35840
    v_mfma_f32_16x16x32_bf16 v[96:99], v[52:55], v[136:139], v[96:99]
    ds_read_b128 v[48:51], v14 offset:36864
    s_waitcnt vmcnt(2) lgkmcnt(5)
    v_mfma_f32_16x16x32_bf16 v[80:83], v[56:59], v[140:143], v[80:83]
    ds_read_b128 v[52:55], v14 offset:37888
    v_mfma_f32_16x16x32_bf16 v[84:87], v[60:63], v[140:143], v[84:87]
    ds_read_b128 v[56:59], v14 offset:38912
    s_waitcnt lgkmcnt(5)
    v_mfma_f32_16x16x32_bf16 v[88:91], v[64:67], v[140:143], v[88:91]
    ds_read_b128 v[60:63], v14 offset:39936
    v_mfma_f32_16x16x32_bf16 v[92:95], v[68:71], v[140:143], v[92:95]
    s_waitcnt lgkmcnt(4)
    v_mfma_f32_16x16x32_bf16 v[96:99], v[72:75], v[140:143], v[96:99]
    s_waitcnt vmcnt(0)
    v_mfma_f32_16x16x32_bf16 v[80:83], v[76:79], v[144:147], v[80:83]
    s_waitcnt lgkmcnt(2)
    v_mfma_f32_16x16x32_bf16 v[84:87], v[48:51], v[144:147], v[84:87]
    v_mfma_f32_16x16x32_bf16 v[88:91], v[52:55], v[144:147], v[88:91]
    s_waitcnt lgkmcnt(0)
    v_mfma_f32_16x16x32_bf16 v[92:95], v[56:59], v[144:147], v[92:95]
    v_mfma_f32_16x16x32_bf16 v[96:99], v[60:63], v[144:147], v[96:99]
    s_nop 3
    v_cvt_pk_bf16_f32 v18, v80, v81
    v_cvt_pk_bf16_f32 v19, v82, v83
    v_cvt_pk_bf16_f32 v20, v84, v85
    v_cvt_pk_bf16_f32 v21, v86, v87
    buffer_store_dwordx4 v[18:21], v10, s[8:11], s82 offen offset:0 sc1
    v_cvt_pk_bf16_f32 v22, v88, v89
    v_cvt_pk_bf16_f32 v23, v90, v91
    v_cvt_pk_bf16_f32 v24, v92, v93
    v_cvt_pk_bf16_f32 v25, v94, v95
    buffer_store_dwordx4 v[22:25], v10, s[8:11], s82 offen offset:2048 sc1
    v_cvt_pk_bf16_f32 v26, v96, v97
    v_cvt_pk_bf16_f32 v27, v98, v99
    buffer_store_dwordx2 v[26:27], v16, s[8:11], s58 offen sc1
    v_pk_add_f32 v[28:29], v[80:81], v[82:83]
    v_pk_mul_f32 v[30:31], v[80:81], v[80:81]
    v_pk_fma_f32 v[30:31], v[82:83], v[82:83], v[30:31]
    v_pk_add_f32 v[28:29], v[28:29], v[84:85]
    v_pk_fma_f32 v[30:31], v[84:85], v[84:85], v[30:31]
    v_pk_add_f32 v[28:29], v[28:29], v[86:87]
    v_pk_fma_f32 v[30:31], v[86:87], v[86:87], v[30:31]
    v_pk_add_f32 v[28:29], v[28:29], v[88:89]
    v_pk_fma_f32 v[30:31], v[88:89], v[88:89], v[30:31]
    v_pk_add_f32 v[28:29], v[28:29], v[90:91]
    v_pk_fma_f32 v[30:31], v[90:91], v[90:91], v[30:31]
    v_pk_add_f32 v[28:29], v[28:29], v[92:93]
    v_pk_fma_f32 v[30:31], v[92:93], v[92:93], v[30:31]
    v_pk_add_f32 v[28:29], v[28:29], v[94:95]
    v_pk_fma_f32 v[30:31], v[94:95], v[94:95], v[30:31]
    v_pk_add_f32 v[28:29], v[28:29], v[96:97]
    v_pk_fma_f32 v[30:31], v[96:97], v[96:97], v[30:31]
    v_pk_add_f32 v[28:29], v[28:29], v[98:99]
    v_pk_fma_f32 v[30:31], v[98:99], v[98:99], v[30:31]
    v_add_f32 v28, v28, v29
    v_add_f32 v29, v30, v31
    v_mov_b32 v30, v28
    v_mov_b32 v31, v29
    s_nop 1
    v_permlane32_swap_b32 v28, v30
    v_permlane32_swap_b32 v29, v31
    v_add_f32 v28, v28, v30
    v_add_f32 v29, v29, v31
    v_mov_b32 v30, v28
    v_mov_b32 v31, v29
    s_nop 1
    v_permlane16_swap_b32 v28, v30
    v_permlane16_swap_b32 v29, v31
    v_add_f32 v28, v28, v30
    v_add_f32 v29, v29, v31
    s_mov_b64 exec, 0xffff
    buffer_store_dwordx2 v[28:29], v34, s[8:11], s59 offen sc1
    s_mov_b64 exec, -1
    s_barrier
    v_add_u32 v8, 61440, v9
    ds_write_b128 v8, v[196:199] offset:0
    ds_write_b128 v8, v[200:203] offset:1024
    ds_write_b128 v8, v[204:207] offset:2048
    ds_write_b128 v8, v[208:211] offset:3072
    ds_write_b128 v8, v[212:215] offset:4096
    v_add_u32 v8, 81920, v9
    ds_write_b128 v8, v[216:219] offset:0
    ds_write_b128 v8, v[220:223] offset:1024
    ds_write_b128 v8, v[224:227] offset:2048
    ds_write_b128 v8, v[228:231] offset:3072
    ds_write_b128 v8, v[232:235] offset:4096
    ds_read_b128 v[48:51], v12 offset:0
    ds_read_b128 v[52:55], v12 offset:1024
    ds_read_b128 v[56:59], v12 offset:2048
    ds_read_b128 v[60:63], v12 offset:3072
    ds_read_b128 v[64:67], v12 offset:4096
    ds_read_b128 v[68:71], v12 offset:5120
    ds_read_b128 v[72:75], v12 offset:6144
    s_mul_i32 s81, s78, 40960
    s_add_u32 s81, s81, 10506240
    v_and_b32 v8, 31, v1
    v_lshlrev_b32 v8, 3, v8
    v_lshl_add_u32 v8, v35, 16, v8
    s_lshl_b32 s27, s78, 8
    s_add_u32 s27, s27, 25532416
    v_cvt_pk_bf16_f32 v6, v40, v40
    v_and_b32 v41, 0xffff0000, v6
    v_sub_f32 v41, v40, v41
    v_cvt_pk_bf16_f32 v40, v40, v41
    v_mov_b32 v41, v40
    v_cvt_pk_bf16_f32 v6, v42, v42
    v_and_b32 v43, 0xffff0000, v6
    v_sub_f32 v43, v42, v43
    v_cvt_pk_bf16_f32 v42, v42, v43
    v_mov_b32 v43, v42
    v_cvt_pk_bf16_f32 v6, v44, v44
    v_and_b32 v45, 0xffff0000, v6
    v_sub_f32 v45, v44, v45
    v_cvt_pk_bf16_f32 v44, v44, v45
    v_mov_b32 v45, v44
    v_cvt_pk_bf16_f32 v6, v46, v46
    v_and_b32 v47, 0xffff0000, v6
    v_sub_f32 v47, v46, v47
    v_cvt_pk_bf16_f32 v46, v46, v47
    v_mov_b32 v47, v46
    s_waitcnt vmcnt(0)
    s_cmp_eq_u32 s42, 0
    s_cbranch_scc1 wt_72
    s_mov_b64 exec, 1
    buffer_store_dword v4, v5, s[8:11], s36 offen
    s_mov_b64 exec, -1
wt_73:
    v_mov_b32 v7, v8
    v_add_u32 v8, 102400, v9
    ds_write_b128 v8, v[236:239] offset:0
    ds_write_b128 v8, v[240:243] offset:1024
    ds_write_b128 v8, v[244:247] offset:2048
    ds_write_b128 v8, v[248:251] offset:3072
    ds_write_b128 v8, v[252:255] offset:4096
    v_mov_b32 v8, v7
    v_bfe_u32 v10, v1, 4, 1
    v_mul_u32_u24 v34, 55296, v10
    v_lshl_add_u32 v34, v35, 8, v34
    v_and_b32 v10, 15, v1
    v_lshl_add_u32 v34, v10, 4, v34
    s_mul_i32 s82, s78, 110592
    s_lshl_b32 s25, s79, 11
    s_add_u32 s82, s82, s25
    s_add_u32 s82, s82, 13127680
    s_mov_b32 s26, 0
    s_mov_b64 exec, 0xffff
poll_74:
    buffer_load_dword v11, v3, s[8:11], s37 offen sc1
    s_add_u32 s26, s26, 1
    s_cmp_gt_u32 s26, 200000
    s_cbranch_scc1 poll_75
poll_76:
    s_waitcnt vmcnt(0)
    v_cmp_ne_u32 vcc, 1, v11
    s_cbranch_vccnz poll_74
poll_75:
    s_mov_b64 exec, -1
    s_waitcnt lgkmcnt(0)
    s_add_u32 s41, s81, 0
    buffer_load_dwordx4 v[112:115], v2, s[16:19], s41 offen offset:0 sc1
    buffer_load_dwordx4 v[116:119], v2, s[16:19], s41 offen offset:1024 sc1
    buffer_load_dwordx4 v[120:123], v2, s[16:19], s41 offen offset:2048 sc1
    buffer_load_dwordx4 v[124:127], v2, s[16:19], s41 offen offset:3072 sc1
    s_add_u32 s41, s81, 4096
    buffer_load_dwordx4 v[128:131], v2, s[16:19], s41 offen offset:0 sc1
    buffer_load_dwordx4 v[132:135], v2, s[16:19], s41 offen offset:1024 sc1
    buffer_load_dword v28, v8, s[8:11], s27 offen sc1
    s_add_u32 s27, s27, 16384
    buffer_load_dword v29, v8, s[8:11], s27 offen sc1
    s_add_u32 s27, s27, 16384
    buffer_load_dword v30, v8, s[8:11], s27 offen sc1
    s_add_u32 s27, s27, 16384
    buffer_load_dword v31, v8, s[8:11], s27 offen sc1
    s_waitcnt vmcnt(9)
    v_mfma_f32_32x32x16_bf16 v[80:95], v[48:51], v[112:115], 0
    ds_read_b128 v[76:79], v12 offset:7168
    buffer_load_dwordx4 v[136:139], v2, s[16:19], s41 offen offset:2048 sc1
    v_mfma_f32_32x32x16_bf16 v[96:111], v[52:55], v[112:115], 0
    ds_read_b128 v[48:51], v12 offset:8192
    buffer_load_dwordx4 v[140:143], v2, s[16:19], s41 offen offset:3072 sc1
    s_waitcnt vmcnt(10)
    v_mfma_f32_32x32x16_bf16 v[80:95], v[56:59], v[116:119], v[80:95]
    ds_read_b128 v[52:55], v12 offset:9216
    s_add_u32 s41, s81, 8192
    buffer_load_dwordx4 v[144:147], v2, s[16:19], s41 offen offset:0 sc1
    v_mfma_f32_32x32x16_bf16 v[96:111], v[60:63], v[116:119], v[96:111]
    ds_read_b128 v[56:59], v12 offset:10240
    buffer_load_dwordx4 v[148:151], v2, s[16:19], s41 offen offset:1024 sc1
    s_waitcnt vmcnt(11)
    v_mfma_f32_32x32x16_bf16 v[80:95], v[64:67], v[120:123], v[80:95]
    ds_read_b128 v[60:63], v12 offset:11264
    buffer_load_dwordx4 v[152:155], v2, s[16:19], s41 offen offset:2048 sc1
    v_mfma_f32_32x32x16_bf16 v[96:111], v[68:71], v[120:123], v[96:111]
    ds_read_b128 v[64:67], v12 offset:12288
    buffer_load_dwordx4 v[156:159], v2, s[16:19], s41 offen offset:3072 sc1
    s_waitcnt vmcnt(12)
    v_mfma_f32_32x32x16_bf16 v[80:95], v[72:75], v[124:127], v[80:95]
    ds_read_b128 v[68:71], v12 offset:13312
    s_add_u32 s41, s81, 12288
    buffer_load_dwordx4 v[160:163], v2, s[16:19], s41 offen offset:0 sc1
    s_waitcnt lgkmcnt(6)
    v_mfma_f32_32x32x16_bf16 v[96:111], v[76:79], v[124:127], v[96:111]
    ds_read_b128 v[72:75], v12 offset:14336
    buffer_load_dwordx4 v[164:167], v2, s[16:19], s41 offen offset:1024 sc1
    s_waitcnt vmcnt(13) lgkmcnt(6)
    v_mfma_f32_32x32x16_bf16 v[80:95], v[48:51], v[128:131], v[80:95]
    ds_read_b128 v[76:79], v12 offset:15360
    buffer_load_dwordx4 v[168:171], v2, s[16:19], s41 offen offset:2048 sc1
    s_waitcnt lgkmcnt(6)
    v_mfma_f32_32x32x16_bf16 v[96:111], v[52:55], v[128:131], v[96:111]
    ds_read_b128 v[48:51], v12 offset:16384
    buffer_load_dwordx4 v[172:175], v2, s[16:19], s41 offen offset:3072 sc1
    s_waitcnt vmcnt(14) lgkmcnt(6)
    v_mfma_f32_32x32x16_bf16 v[80:95], v[56:59], v[132:135], v[80:95]
    ds_read_b128 v[52:55], v12 offset:17408
    s_add_u32 s41, s81, 16384
    buffer_load_dwordx4 v[176:179], v2, s[16:19], s41 offen offset:0 sc1
    s_waitcnt lgkmcnt(6)
    v_mfma_f32_32x32x16_bf16 v[96:111], v[60:63], v[132:135], v[96:111]
    ds_read_b128 v[56:59], v12 offset:18432
    buffer_load_dwordx4 v[180:183], v2, s[16:19], s41 offen offset:1024 sc1
    s_waitcnt vmcnt(11) lgkmcnt(6)
    v_mfma_f32_32x32x16_bf16 v[80:95], v[64:67], v[136:139], v[80:95]
    ds_read_b128 v[60:63], v12 offset:19456
    buffer_load_dwordx4 v[184:187], v2, s[16:19], s41 offen offset:2048 sc1
    s_waitcnt lgkmcnt(6)
    v_mfma_f32_32x32x16_bf16 v[96:111], v[68:71], v[136:139], v[96:111]
    ds_read_b128 v[64:67], v12 offset:20480
    buffer_load_dwordx4 v[188:191], v2, s[16:19], s41 offen offset:3072 sc1
    s_waitcnt vmcnt(12) lgkmcnt(6)
    v_mfma_f32_32x32x16_bf16 v[80:95], v[72:75], v[140:143], v[80:95]
    ds_read_b128 v[68:71], v12 offset:21504
    s_add_u32 s41, s81, 20480
    buffer_load_dwordx4 v[192:195], v2, s[16:19], s41 offen offset:0 sc1
    s_waitcnt lgkmcnt(6)
    v_mfma_f32_32x32x16_bf16 v[96:111], v[76:79], v[140:143], v[96:111]
    ds_read_b128 v[72:75], v12 offset:22528
    buffer_load_dwordx4 v[196:199], v2, s[16:19], s41 offen offset:1024 sc1
    s_waitcnt vmcnt(13) lgkmcnt(6)
    v_mfma_f32_32x32x16_bf16 v[80:95], v[48:51], v[144:147], v[80:95]
    ds_read_b128 v[76:79], v12 offset:23552
    buffer_load_dwordx4 v[200:203], v2, s[16:19], s41 offen offset:2048 sc1
    s_waitcnt lgkmcnt(6)
    v_mfma_f32_32x32x16_bf16 v[96:111], v[52:55], v[144:147], v[96:111]
    ds_read_b128 v[48:51], v12 offset:24576
    s_waitcnt vmcnt(13) lgkmcnt(6)
    v_mfma_f32_32x32x16_bf16 v[80:95], v[56:59], v[148:151], v[80:95]
    ds_read_b128 v[52:55], v12 offset:25600
    buffer_load_dwordx4 v[204:207], v2, s[16:19], s41 offen offset:3072 sc1
    s_waitcnt lgkmcnt(6)
    v_mfma_f32_32x32x16_bf16 v[96:111], v[60:63], v[148:151], v[96:111]
    s_barrier
    ds_read_b128 v[56:59], v12 offset:26624
    s_waitcnt vmcnt(13) lgkmcnt(6)
    v_mfma_f32_32x32x16_bf16 v[80:95], v[64:67], v[152:155], v[80:95]
    ds_read_b128 v[60:63], v12 offset:27648
    s_add_u32 s41, s81, 24576
    buffer_load_dwordx4 v[208:211], v2, s[16:19], s41 offen offset:0 sc1
    s_waitcnt lgkmcnt(6)
    v_mfma_f32_32x32x16_bf16 v[96:111], v[68:71], v[152:155], v[96:111]
    ds_read_b128 v[64:67], v12 offset:28672
    s_waitcnt vmcnt(13) lgkmcnt(6)
    v_mfma_f32_32x32x16_bf16 v[80:95], v[72:75], v[156:159], v[80:95]
    ds_read_b128 v[68:71], v12 offset:29696
    buffer_load_dwordx4 v[212:215], v2, s[16:19], s41 offen offset:1024 sc1
    s_waitcnt lgkmcnt(6)
    v_mfma_f32_32x32x16_bf16 v[96:111], v[76:79], v[156:159], v[96:111]
    ds_read_b128 v[72:75], v12 offset:30720
    s_waitcnt vmcnt(13) lgkmcnt(6)
    v_mfma_f32_32x32x16_bf16 v[80:95], v[48:51], v[160:163], v[80:95]
    ds_read_b128 v[76:79], v12 offset:31744
    buffer_load_dwordx4 v[216:219], v2, s[16:19], s41 offen offset:2048 sc1
    s_waitcnt lgkmcnt(6)
    v_mfma_f32_32x32x16_bf16 v[96:111], v[52:55], v[160:163], v[96:111]
    ds_read_b128 v[48:51], v12 offset:32768
    s_waitcnt vmcnt(13) lgkmcnt(6)
    v_mfma_f32_32x32x16_bf16 v[80:95], v[56:59], v[164:167], v[80:95]
    ds_read_b128 v[52:55], v12 offset:33792
    buffer_load_dwordx4 v[220:223], v2, s[16:19], s41 offen offset:3072 sc1
    s_waitcnt lgkmcnt(6)
    v_mfma_f32_32x32x16_bf16 v[96:111], v[60:63], v[164:167], v[96:111]
    ds_read_b128 v[56:59], v12 offset:34816
    s_waitcnt vmcnt(13) lgkmcnt(6)
    v_mfma_f32_32x32x16_bf16 v[80:95], v[64:67], v[168:171], v[80:95]
    ds_read_b128 v[60:63], v12 offset:35840
    s_add_u32 s41, s81, 28672
    buffer_load_dwordx4 v[224:227], v2, s[16:19], s41 offen offset:0 sc1
    s_waitcnt lgkmcnt(6)
    v_mfma_f32_32x32x16_bf16 v[96:111], v[68:71], v[168:171], v[96:111]
    ds_read_b128 v[64:67], v12 offset:36864
    s_waitcnt vmcnt(13) lgkmcnt(6)
    v_mfma_f32_32x32x16_bf16 v[80:95], v[72:75], v[172:175], v[80:95]
    ds_read_b128 v[68:71], v12 offset:37888
    buffer_load_dwordx4 v[228:231], v2, s[16:19], s41 offen offset:1024 sc1
    v_add_f32 v28, v28, v29
    v_add_f32 v30, v30, v31
    v_add_f32 v28, v28, v30
    v_mov_b32 v29, v28
    s_waitcnt lgkmcnt(6)
    v_mfma_f32_32x32x16_bf16 v[96:111], v[76:79], v[172:175], v[96:111]
    ds_read_b128 v[72:75], v12 offset:38912
    s_nop 1
    v_permlane32_swap_b32 v28, v29
    v_add_f32 v28, v28, v29
    v_mul_f32 v38, 0xbacccccd, v28
    v_cvt_pk_bf16_f32 v6, v38, v38
    v_and_b32 v39, 0xffff0000, v6
    s_waitcnt vmcnt(13) lgkmcnt(6)
    v_mfma_f32_32x32x16_bf16 v[80:95], v[48:51], v[176:179], v[80:95]
    ds_read_b128 v[76:79], v12 offset:39936
    buffer_load_dwordx4 v[232:235], v2, s[16:19], s41 offen offset:2048 sc1
    v_sub_f32 v39, v38, v39
    v_cvt_pk_bf16_f32 v39, v39, v39
    v_mov_b32 v38, v6
    s_mov_b32 exec_lo, 0
    v_mov_b32 v38, 0
    v_mov_b32 v39, 0
    s_mov_b32 exec_lo, -1
    s_waitcnt lgkmcnt(6)
    v_mfma_f32_32x32x16_bf16 v[96:111], v[52:55], v[176:179], v[96:111]
    ds_read_b128 v[48:51], v12 offset:40960
    s_waitcnt vmcnt(13) lgkmcnt(6)
    v_mfma_f32_32x32x16_bf16 v[80:95], v[56:59], v[180:183], v[80:95]
    ds_read_b128 v[52:55], v12 offset:41984
    buffer_load_dwordx4 v[236:239], v2, s[16:19], s41 offen offset:3072 sc1
    s_waitcnt lgkmcnt(6)
    v_mfma_f32_32x32x16_bf16 v[96:111], v[60:63], v[180:183], v[96:111]
    ds_read_b128 v[56:59], v12 offset:43008
    s_waitcnt vmcnt(13) lgkmcnt(6)
    v_mfma_f32_32x32x16_bf16 v[80:95], v[64:67], v[184:187], v[80:95]
    ds_read_b128 v[60:63], v12 offset:44032
    s_add_u32 s41, s81, 32768
    buffer_load_dwordx4 v[240:243], v2, s[16:19], s41 offen offset:0 sc1
    s_waitcnt lgkmcnt(6)
    v_mfma_f32_32x32x16_bf16 v[96:111], v[68:71], v[184:187], v[96:111]
    ds_read_b128 v[64:67], v12 offset:45056
    s_waitcnt vmcnt(13) lgkmcnt(6)
    v_mfma_f32_32x32x16_bf16 v[80:95], v[72:75], v[188:191], v[80:95]
    ds_read_b128 v[68:71], v12 offset:46080
    buffer_load_dwordx4 v[244:247], v2, s[16:19], s41 offen offset:1024 sc1
    s_waitcnt lgkmcnt(6)
    v_mfma_f32_32x32x16_bf16 v[96:111], v[76:79], v[188:191], v[96:111]
    s_barrier
    ds_read_b128 v[72:75], v12 offset:47104
    s_waitcnt vmcnt(13) lgkmcnt(6)
    v_mfma_f32_32x32x16_bf16 v[80:95], v[48:51], v[192:195], v[80:95]
    ds_read_b128 v[76:79], v12 offset:48128
    buffer_load_dwordx4 v[248:251], v2, s[16:19], s41 offen offset:2048 sc1
    s_waitcnt lgkmcnt(6)
    v_mfma_f32_32x32x16_bf16 v[96:111], v[52:55], v[192:195], v[96:111]
    ds_read_b128 v[48:51], v12 offset:49152
    s_waitcnt vmcnt(13) lgkmcnt(6)
    v_mfma_f32_32x32x16_bf16 v[80:95], v[56:59], v[196:199], v[80:95]
    ds_read_b128 v[52:55], v12 offset:50176
    buffer_load_dwordx4 v[252:255], v2, s[16:19], s41 offen offset:3072 sc1
    s_waitcnt lgkmcnt(6)
    v_mfma_f32_32x32x16_bf16 v[96:111], v[60:63], v[196:199], v[96:111]
    ds_read_b128 v[56:59], v12 offset:51200
    s_waitcnt vmcnt(13) lgkmcnt(6)
    v_mfma_f32_32x32x16_bf16 v[80:95], v[64:67], v[200:203], v[80:95]
    ds_read_b128 v[60:63], v12 offset:52224
    s_add_u32 s41, s81, 36864
    buffer_load_dwordx4 v[112:115], v2, s[16:19], s41 offen offset:0 sc1
    s_waitcnt lgkmcnt(6)
    v_mfma_f32_32x32x16_bf16 v[96:111], v[68:71], v[200:203], v[96:111]
    ds_read_b128 v[64:67], v12 offset:53248
    s_waitcnt vmcnt(13) lgkmcnt(6)
    v_mfma_f32_32x32x16_bf16 v[80:95], v[72:75], v[204:207], v[80:95]
    ds_read_b128 v[68:71], v12 offset:54272
    buffer_load_dwordx4 v[116:119], v2, s[16:19], s41 offen offset:1024 sc1
    s_waitcnt lgkmcnt(6)
    v_mfma_f32_32x32x16_bf16 v[96:111], v[76:79], v[204:207], v[96:111]
    ds_read_b128 v[72:75], v12 offset:55296
    s_waitcnt vmcnt(13) lgkmcnt(6)
    v_mfma_f32_32x32x16_bf16 v[80:95], v[48:51], v[208:211], v[80:95]
    ds_read_b128 v[76:79], v12 offset:56320
    buffer_load_dwordx4 v[120:123], v2, s[16:19], s41 offen offset:2048 sc1
    s_waitcnt lgkmcnt(6)
    v_mfma_f32_32x32x16_bf16 v[96:111], v[52:55], v[208:211], v[96:111]
    ds_read_b128 v[48:51], v12 offset:57344
    s_waitcnt vmcnt(13) lgkmcnt(6)
    v_mfma_f32_32x32x16_bf16 v[80:95], v[56:59], v[212:215], v[80:95]
    ds_read_b128 v[52:55], v12 offset:58368
    buffer_load_dwordx4 v[124:127], v2, s[16:19], s41 offen offset:3072 sc1
    s_waitcnt lgkmcnt(6)
    v_mfma_f32_32x32x16_bf16 v[96:111], v[60:63], v[212:215], v[96:111]
    ds_read_b128 v[56:59], v12 offset:59392
    s_waitcnt vmcnt(13) lgkmcnt(6)
    v_mfma_f32_32x32x16_bf16 v[80:95], v[64:67], v[216:219], v[80:95]
    ds_read_b128 v[60:63], v12 offset:60416
    s_add_u32 s41, s81, 4096
    buffer_load_dwordx4 v[128:131], v2, s[16:19], s41 offen offset:0 sc1
    s_waitcnt lgkmcnt(6)
    v_mfma_f32_32x32x16_bf16 v[96:111], v[68:71], v[216:219], v[96:111]
    ds_read_b128 v[64:67], v13 offset:0
    s_waitcnt vmcnt(13) lgkmcnt(6)
    v_mfma_f32_32x32x16_bf16 v[80:95], v[72:75], v[220:223], v[80:95]
    ds_read_b128 v[68:71], v13 offset:1024
    s_waitcnt lgkmcnt(6)
    v_mfma_f32_32x32x16_bf16 v[96:111], v[76:79], v[220:223], v[96:111]
    ds_read_b128 v[72:75], v13 offset:2048
    s_waitcnt vmcnt(12) lgkmcnt(6)
    v_mfma_f32_32x32x16_bf16 v[80:95], v[48:51], v[224:227], v[80:95]
    ds_read_b128 v[76:79], v13 offset:3072
    s_waitcnt lgkmcnt(6)
    v_mfma_f32_32x32x16_bf16 v[96:111], v[52:55], v[224:227], v[96:111]
    ds_read_b128 v[48:51], v13 offset:4096
    s_waitcnt vmcnt(11) lgkmcnt(6)
    v_mfma_f32_32x32x16_bf16 v[80:95], v[56:59], v[228:231], v[80:95]
    ds_read_b128 v[52:55], v13 offset:5120
    s_waitcnt lgkmcnt(6)
    v_mfma_f32_32x32x16_bf16 v[96:111], v[60:63], v[228:231], v[96:111]
    s_barrier
    ds_read_b128 v[56:59], v13 offset:6144
    s_waitcnt vmcnt(10) lgkmcnt(6)
    v_mfma_f32_32x32x16_bf16 v[80:95], v[64:67], v[232:235], v[80:95]
    ds_read_b128 v[60:63], v13 offset:7168
    s_waitcnt lgkmcnt(6)
    v_mfma_f32_32x32x16_bf16 v[96:111], v[68:71], v[232:235], v[96:111]
    ds_read_b128 v[64:67], v13 offset:8192
    s_waitcnt vmcnt(9) lgkmcnt(6)
    v_mfma_f32_32x32x16_bf16 v[80:95], v[72:75], v[236:239], v[80:95]
    ds_read_b128 v[68:71], v13 offset:9216
    s_waitcnt lgkmcnt(6)
    v_mfma_f32_32x32x16_bf16 v[96:111], v[76:79], v[236:239], v[96:111]
    ds_read_b128 v[72:75], v13 offset:10240
    s_waitcnt vmcnt(8) lgkmcnt(6)
    v_mfma_f32_32x32x16_bf16 v[80:95], v[48:51], v[240:243], v[80:95]
    ds_read_b128 v[76:79], v13 offset:11264
    s_waitcnt lgkmcnt(6)
    v_mfma_f32_32x32x16_bf16 v[96:111], v[52:55], v[240:243], v[96:111]
    ds_read_b128 v[48:51], v13 offset:12288
    s_waitcnt vmcnt(7) lgkmcnt(6)
    v_mfma_f32_32x32x16_bf16 v[80:95], v[56:59], v[244:247], v[80:95]
    ds_read_b128 v[52:55], v13 offset:13312
    s_waitcnt lgkmcnt(6)
    v_mfma_f32_32x32x16_bf16 v[96:111], v[60:63], v[244:247], v[96:111]
    ds_read_b128 v[56:59], v13 offset:14336
    s_waitcnt vmcnt(6) lgkmcnt(6)
    v_mfma_f32_32x32x16_bf16 v[80:95], v[64:67], v[248:251], v[80:95]
    ds_read_b128 v[60:63], v13 offset:15360
    s_waitcnt lgkmcnt(6)
    v_mfma_f32_32x32x16_bf16 v[96:111], v[68:71], v[248:251], v[96:111]
    ds_read_b128 v[64:67], v13 offset:16384
    s_waitcnt vmcnt(5) lgkmcnt(6)
    v_mfma_f32_32x32x16_bf16 v[80:95], v[72:75], v[252:255], v[80:95]
    ds_read_b128 v[68:71], v13 offset:17408
    s_waitcnt lgkmcnt(6)
    v_mfma_f32_32x32x16_bf16 v[96:111], v[76:79], v[252:255], v[96:111]
    ds_read_b128 v[72:75], v13 offset:18432
    s_waitcnt vmcnt(4) lgkmcnt(6)
    v_mfma_f32_32x32x16_bf16 v[80:95], v[48:51], v[112:115], v[80:95]
    ds_read_b128 v[76:79], v13 offset:19456
    s_waitcnt lgkmcnt(6)
    v_mfma_f32_32x32x16_bf16 v[96:111], v[52:55], v[112:115], v[96:111]
    s_waitcnt vmcnt(3) lgkmcnt(5)
    v_mfma_f32_32x32x16_bf16 v[80:95], v[56:59], v[116:119], v[80:95]
    s_waitcnt lgkmcnt(4)
    v_mfma_f32_32x32x16_bf16 v[96:111], v[60:63], v[116:119], v[96:111]
    s_waitcnt vmcnt(2) lgkmcnt(3)
    v_mfma_f32_32x32x16_bf16 v[80:95], v[64:67], v[120:123], v[80:95]
    s_waitcnt lgkmcnt(2)
    v_mfma_f32_32x32x16_bf16 v[96:111], v[68:71], v[120:123], v[96:111]
    ds_read_b128 v[64:67], v13 offset:20480
    s_waitcnt vmcnt(1) lgkmcnt(2)
    v_mfma_f32_32x32x16_bf16 v[80:95], v[72:75], v[124:127], v[80:95]
    ds_read_b128 v[68:71], v13 offset:21504
    s_waitcnt lgkmcnt(2)
    v_mfma_f32_32x32x16_bf16 v[96:111], v[76:79], v[124:127], v[96:111]
    s_barrier
    ds_read_b128 v[72:75], v13 offset:22528
    v_mfma_f32_32x32x8_bf16 v[80:95], v[40:41], v[38:39], v[80:95]
    ds_read_b128 v[76:79], v13 offset:23552
    v_mfma_f32_32x32x8_bf16 v[96:111], v[42:43], v[38:39], v[96:111]
    ds_read_b128 v[48:51], v13 offset:24576
    s_nop 7
    s_nop 2
    v_cvt_pk_bf16_f32 v80, v80, v81
    v_cvt_pk_bf16_f32 v81, v82, v83
    v_cvt_pk_bf16_f32 v82, v84, v85
    v_cvt_pk_bf16_f32 v83, v86, v87
    v_pk_max_i16 v80, v80, 0
    v_pk_max_i16 v81, v81, 0
    v_pk_max_i16 v82, v82, 0
    v_pk_max_i16 v83, v83, 0
    v_cvt_pk_bf16_f32 v84, v88, v89
    v_cvt_pk_bf16_f32 v85, v90, v91
    v_cvt_pk_bf16_f32 v86, v92, v93
    v_cvt_pk_bf16_f32 v87, v94, v95
    v_pk_max_i16 v84, v84, 0
    v_pk_max_i16 v85, v85, 0
    v_pk_max_i16 v86, v86, 0
    v_pk_max_i16 v87, v87, 0
    buffer_store_dwordx4 v[80:83], v34, s[16:19], s82 offen offset:0 sc1
    buffer_store_dwordx4 v[84:87], v34, s[16:19], s82 offen offset:512 sc1
    v_cvt_pk_bf16_f32 v96, v96, v97
    v_cvt_pk_bf16_f32 v97, v98, v99
    v_cvt_pk_bf16_f32 v98, v100, v101
    v_cvt_pk_bf16_f32 v99, v102, v103
    v_pk_max_i16 v96, v96, 0
    v_pk_max_i16 v97, v97, 0
    v_pk_max_i16 v98, v98, 0
    v_pk_max_i16 v99, v99, 0
    v_cvt_pk_bf16_f32 v100, v104, v105
    v_cvt_pk_bf16_f32 v101, v106, v107
    v_cvt_pk_bf16_f32 v102, v108, v109
    v_cvt_pk_bf16_f32 v103, v110, v111
    v_pk_max_i16 v100, v100, 0
    v_pk_max_i16 v101, v101, 0
    v_pk_max_i16 v102, v102, 0
    v_pk_max_i16 v103, v103, 0
    buffer_store_dwordx4 v[96:99], v34, s[16:19], s82 offen offset:1024 sc1
    buffer_store_dwordx4 v[100:103], v34, s[16:19], s82 offen offset:1536 sc1
    s_nop 1
    v_mfma_f32_32x32x8_bf16 v[80:95], v[44:45], v[38:39], 0
    ds_read_b128 v[52:55], v13 offset:25600
    v_mfma_f32_32x32x8_bf16 v[96:111], v[46:47], v[38:39], 0
    ds_read_b128 v[56:59], v13 offset:26624
    s_waitcnt lgkmcnt(6)
    v_mfma_f32_32x32x16_bf16 v[80:95], v[64:67], v[124:127], v[80:95]
    ds_read_b128 v[60:63], v13 offset:27648
    s_waitcnt lgkmcnt(6)
    v_mfma_f32_32x32x16_bf16 v[96:111], v[68:71], v[124:127], v[96:111]
    ds_read_b128 v[64:67], v13 offset:28672
    s_waitcnt lgkmcnt(6)
    v_mfma_f32_32x32x16_bf16 v[80:95], v[72:75], v[120:123], v[80:95]
    ds_read_b128 v[68:71], v13 offset:29696
    s_add_u32 s41, s81, 0
    buffer_load_dwordx4 v[124:127], v2, s[16:19], s41 offen offset:3072 sc1
    s_waitcnt lgkmcnt(6)
    v_mfma_f32_32x32x16_bf16 v[96:111], v[76:79], v[120:123], v[96:111]
    ds_read_b128 v[72:75], v13 offset:30720
    s_waitcnt lgkmcnt(6)
    v_mfma_f32_32x32x16_bf16 v[80:95], v[48:51], v[116:119], v[80:95]
    ds_read_b128 v[76:79], v13 offset:31744
    buffer_load_dwordx4 v[120:123], v2, s[16:19], s41 offen offset:2048 sc1
    s_waitcnt lgkmcnt(6)
    v_mfma_f32_32x32x16_bf16 v[96:111], v[52:55], v[116:119], v[96:111]
    ds_read_b128 v[48:51], v13 offset:32768
    s_waitcnt lgkmcnt(6)
    v_mfma_f32_32x32x16_bf16 v[80:95], v[56:59], v[112:115], v[80:95]
    ds_read_b128 v[52:55], v13 offset:33792
    buffer_load_dwordx4 v[116:119], v2, s[16:19], s41 offen offset:1024 sc1
    s_waitcnt lgkmcnt(6)
    v_mfma_f32_32x32x16_bf16 v[96:111], v[60:63], v[112:115], v[96:111]
    ds_read_b128 v[56:59], v13 offset:34816
    s_waitcnt lgkmcnt(6)
    v_mfma_f32_32x32x16_bf16 v[80:95], v[64:67], v[252:255], v[80:95]
    ds_read_b128 v[60:63], v13 offset:35840
    buffer_load_dwordx4 v[112:115], v2, s[16:19], s41 offen offset:0 sc1
    s_waitcnt lgkmcnt(6)
    v_mfma_f32_32x32x16_bf16 v[96:111], v[68:71], v[252:255], v[96:111]
    ds_read_b128 v[64:67], v13 offset:36864
    s_waitcnt lgkmcnt(6)
    v_mfma_f32_32x32x16_bf16 v[80:95], v[72:75], v[248:251], v[80:95]
    ds_read_b128 v[68:71], v13 offset:37888
    s_waitcnt lgkmcnt(6)
    v_mfma_f32_32x32x16_bf16 v[96:111], v[76:79], v[248:251], v[96:111]
    ds_read_b128 v[72:75], v13 offset:38912
    s_waitcnt lgkmcnt(6)
    v_mfma_f32_32x32x16_bf16 v[80:95], v[48:51], v[244:247], v[80:95]
    ds_read_b128 v[76:79], v13 offset:39936
    s_waitcnt lgkmcnt(6)
    v_mfma_f32_32x32x16_bf16 v[96:111], v[52:55], v[244:247], v[96:111]
    ds_read_b128 v[48:51], v13 offset:40960
    s_waitcnt lgkmcnt(6)
    v_mfma_f32_32x32x16_bf16 v[80:95], v[56:59], v[240:243], v[80:95]
    ds_read_b128 v[52:55], v13 offset:41984
    s_waitcnt lgkmcnt(6)
    v_mfma_f32_32x32x16_bf16 v[96:111], v[60:63], v[240:243], v[96:111]
    ds_read_b128 v[56:59], v13 offset:43008
    s_waitcnt lgkmcnt(6)
    v_mfma_f32_32x32x16_bf16 v[80:95], v[64:67], v[236:239], v[80:95]
    ds_read_b128 v[60:63], v13 offset:44032
    s_waitcnt lgkmcnt(6)
    v_mfma_f32_32x32x16_bf16 v[96:111], v[68:71], v[236:239], v[96:111]
    ds_read_b128 v[64:67], v13 offset:45056
    s_waitcnt lgkmcnt(6)
    v_mfma_f32_32x32x16_bf16 v[80:95], v[72:75], v[232:235], v[80:95]
    ds_read_b128 v[68:71], v13 offset:46080
    s_waitcnt lgkmcnt(6)
    v_mfma_f32_32x32x16_bf16 v[96:111], v[76:79], v[232:235], v[96:111]
    s_barrier
    ds_read_b128 v[72:75], v13 offset:47104
    s_waitcnt lgkmcnt(6)
    v_mfma_f32_32x32x16_bf16 v[80:95], v[48:51], v[228:231], v[80:95]
    ds_read_b128 v[76:79], v13 offset:48128
    s_waitcnt lgkmcnt(6)
    v_mfma_f32_32x32x16_bf16 v[96:111], v[52:55], v[228:231], v[96:111]
    ds_read_b128 v[48:51], v13 offset:49152
    s_waitcnt lgkmcnt(6)
    v_mfma_f32_32x32x16_bf16 v[80:95], v[56:59], v[224:227], v[80:95]
    ds_read_b128 v[52:55], v13 offset:50176
    s_waitcnt lgkmcnt(6)
    v_mfma_f32_32x32x16_bf16 v[96:111], v[60:63], v[224:227], v[96:111]
    ds_read_b128 v[56:59], v13 offset:51200
    s_waitcnt lgkmcnt(6)
    v_mfma_f32_32x32x16_bf16 v[80:95], v[64:67], v[220:223], v[80:95]
    ds_read_b128 v[60:63], v13 offset:52224
    s_waitcnt lgkmcnt(6)
    v_mfma_f32_32x32x16_bf16 v[96:111], v[68:71], v[220:223], v[96:111]
    ds_read_b128 v[64:67], v13 offset:53248
    s_waitcnt lgkmcnt(6)
    v_mfma_f32_32x32x16_bf16 v[80:95], v[72:75], v[216:219], v[80:95]
    ds_read_b128 v[68:71], v13 offset:54272
    s_waitcnt lgkmcnt(6)
    v_mfma_f32_32x32x16_bf16 v[96:111], v[76:79], v[216:219], v[96:111]
    ds_read_b128 v[72:75], v13 offset:55296
    s_waitcnt lgkmcnt(6)
    v_mfma_f32_32x32x16_bf16 v[80:95], v[48:51], v[212:215], v[80:95]
    ds_read_b128 v[76:79], v13 offset:56320
    s_waitcnt lgkmcnt(6)
    v_mfma_f32_32x32x16_bf16 v[96:111], v[52:55], v[212:215], v[96:111]
    ds_read_b128 v[48:51], v13 offset:57344
    s_waitcnt lgkmcnt(6)
    v_mfma_f32_32x32x16_bf16 v[80:95], v[56:59], v[208:211], v[80:95]
    ds_read_b128 v[52:55], v13 offset:58368
    s_waitcnt lgkmcnt(6)
    v_mfma_f32_32x32x16_bf16 v[96:111], v[60:63], v[208:211], v[96:111]
    ds_read_b128 v[56:59], v13 offset:59392
    s_waitcnt lgkmcnt(6)
    v_mfma_f32_32x32x16_bf16 v[80:95], v[64:67], v[204:207], v[80:95]
    ds_read_b128 v[60:63], v13 offset:60416
    s_waitcnt lgkmcnt(6)
    v_mfma_f32_32x32x16_bf16 v[96:111], v[68:71], v[204:207], v[96:111]
    ds_read_b128 v[64:67], v14 offset:0
    s_waitcnt lgkmcnt(6)
    v_mfma_f32_32x32x16_bf16 v[80:95], v[72:75], v[200:203], v[80:95]
    ds_read_b128 v[68:71], v14 offset:1024
    s_waitcnt lgkmcnt(6)
    v_mfma_f32_32x32x16_bf16 v[96:111], v[76:79], v[200:203], v[96:111]
    ds_read_b128 v[72:75], v14 offset:2048
    s_waitcnt lgkmcnt(6)
    v_mfma_f32_32x32x16_bf16 v[80:95], v[48:51], v[196:199], v[80:95]
    ds_read_b128 v[76:79], v14 offset:3072
    s_waitcnt lgkmcnt(6)
    v_mfma_f32_32x32x16_bf16 v[96:111], v[52:55], v[196:199], v[96:111]
    ds_read_b128 v[48:51], v14 offset:4096
    s_waitcnt lgkmcnt(6)
    v_mfma_f32_32x32x16_bf16 v[80:95], v[56:59], v[192:195], v[80:95]
    ds_read_b128 v[52:55], v14 offset:5120
    s_waitcnt vmcnt(4)
    s_cmp_eq_u32 s42, 0
    s_cbranch_scc1 wt_77
    s_mov_b64 exec, 1
    buffer_store_dword v4, v5, s[16:19], s39 offen
    s_mov_b64 exec, -1
wt_78:
    s_add_u32 s39, s39, 8192
    s_add_u32 s82, s82, 28672
    s_cmp_ge_u32 s79, 13
    s_cselect_b32 s18, 0, s18
    s_waitcnt lgkmcnt(6)
    v_mfma_f32_32x32x16_bf16 v[96:111], v[60:63], v[192:195], v[96:111]
    s_barrier
    ds_read_b128 v[56:59], v14 offset:6144
    s_waitcnt lgkmcnt(6)
    v_mfma_f32_32x32x16_bf16 v[80:95], v[64:67], v[188:191], v[80:95]
    ds_read_b128 v[60:63], v14 offset:7168
    s_waitcnt lgkmcnt(6)
    v_mfma_f32_32x32x16_bf16 v[96:111], v[68:71], v[188:191], v[96:111]
    ds_read_b128 v[64:67], v14 offset:8192
    s_waitcnt lgkmcnt(6)
    v_mfma_f32_32x32x16_bf16 v[80:95], v[72:75], v[184:187], v[80:95]
    ds_read_b128 v[68:71], v14 offset:9216
    s_waitcnt lgkmcnt(6)
    v_mfma_f32_32x32x16_bf16 v[96:111], v[76:79], v[184:187], v[96:111]
    ds_read_b128 v[72:75], v14 offset:10240
    s_waitcnt lgkmcnt(6)
    v_mfma_f32_32x32x16_bf16 v[80:95], v[48:51], v[180:183], v[80:95]
    ds_read_b128 v[76:79], v14 offset:11264
    s_waitcnt lgkmcnt(6)
    v_mfma_f32_32x32x16_bf16 v[96:111], v[52:55], v[180:183], v[96:111]
    ds_read_b128 v[48:51], v14 offset:12288
    s_waitcnt lgkmcnt(6)
    v_mfma_f32_32x32x16_bf16 v[80:95], v[56:59], v[176:179], v[80:95]
    ds_read_b128 v[52:55], v14 offset:13312
    s_waitcnt lgkmcnt(6)
    v_mfma_f32_32x32x16_bf16 v[96:111], v[60:63], v[176:179], v[96:111]
    ds_read_b128 v[56:59], v14 offset:14336
    s_waitcnt lgkmcnt(6)
    v_mfma_f32_32x32x16_bf16 v[80:95], v[64:67], v[172:175], v[80:95]
    ds_read_b128 v[60:63], v14 offset:15360
    s_waitcnt lgkmcnt(6)
    v_mfma_f32_32x32x16_bf16 v[96:111], v[68:71], v[172:175], v[96:111]
    ds_read_b128 v[64:67], v14 offset:16384
    s_waitcnt lgkmcnt(6)
    v_mfma_f32_32x32x16_bf16 v[80:95], v[72:75], v[168:171], v[80:95]
    ds_read_b128 v[68:71], v14 offset:17408
    s_waitcnt lgkmcnt(6)
    v_mfma_f32_32x32x16_bf16 v[96:111], v[76:79], v[168:171], v[96:111]
    ds_read_b128 v[72:75], v14 offset:18432
    s_waitcnt lgkmcnt(6)
    v_mfma_f32_32x32x16_bf16 v[80:95], v[48:51], v[164:167], v[80:95]
    ds_read_b128 v[76:79], v14 offset:19456
    s_waitcnt lgkmcnt(6)
    v_mfma_f32_32x32x16_bf16 v[96:111], v[52:55], v[164:167], v[96:111]
    ds_read_b128 v[48:51], v14 offset:20480
    s_waitcnt lgkmcnt(6)
    v_mfma_f32_32x32x16_bf16 v[80:95], v[56:59], v[160:163], v[80:95]
    ds_read_b128 v[52:55], v14 offset:21504
    s_waitcnt lgkmcnt(6)
    v_mfma_f32_32x32x16_bf16 v[96:111], v[60:63], v[160:163], v[96:111]
    ds_read_b128 v[56:59], v14 offset:22528
    s_waitcnt lgkmcnt(6)
    v_mfma_f32_32x32x16_bf16 v[80:95], v[64:67], v[156:159], v[80:95]
    ds_read_b128 v[60:63], v14 offset:23552
    v_min_u32 v10, 52, v3
    buffer_load_dword v36, v10, s[8:11], s31 offen sc1
    s_waitcnt lgkmcnt(6)
    v_mfma_f32_32x32x16_bf16 v[96:111], v[68:71], v[156:159], v[96:111]
    ds_read_b128 v[64:67], v14 offset:24576
    s_waitcnt lgkmcnt(6)
    v_mfma_f32_32x32x16_bf16 v[80:95], v[72:75], v[152:155], v[80:95]
    ds_read_b128 v[68:71], v14 offset:25600
    s_waitcnt lgkmcnt(6)
    v_mfma_f32_32x32x16_bf16 v[96:111], v[76:79], v[152:155], v[96:111]
    s_barrier
    ds_read_b128 v[72:75], v14 offset:26624
    s_waitcnt lgkmcnt(6)
    v_mfma_f32_32x32x16_bf16 v[80:95], v[48:51], v[148:151], v[80:95]
    ds_read_b128 v[76:79], v14 offset:27648
    s_waitcnt lgkmcnt(6)
    v_mfma_f32_32x32x16_bf16 v[96:111], v[52:55], v[148:151], v[96:111]
    ds_read_b128 v[48:51], v14 offset:28672
    s_waitcnt lgkmcnt(6)
    v_mfma_f32_32x32x16_bf16 v[80:95], v[56:59], v[144:147], v[80:95]
    ds_read_b128 v[52:55], v14 offset:29696
    s_waitcnt lgkmcnt(6)
    v_mfma_f32_32x32x16_bf16 v[96:111], v[60:63], v[144:147], v[96:111]
    ds_read_b128 v[56:59], v14 offset:30720
    s_waitcnt lgkmcnt(6)
    v_mfma_f32_32x32x16_bf16 v[80:95], v[64:67], v[140:143], v[80:95]
    ds_read_b128 v[60:63], v14 offset:31744
    s_waitcnt lgkmcnt(6)
    v_mfma_f32_32x32x16_bf16 v[96:111], v[68:71], v[140:143], v[96:111]
    ds_read_b128 v[64:67], v14 offset:32768
    s_waitcnt lgkmcnt(6)
    v_mfma_f32_32x32x16_bf16 v[80:95], v[72:75], v[136:139], v[80:95]
    ds_read_b128 v[68:71], v14 offset:33792
    s_waitcnt lgkmcnt(6)
    v_mfma_f32_32x32x16_bf16 v[96:111], v[76:79], v[136:139], v[96:111]
    ds_read_b128 v[72:75], v14 offset:34816
    s_waitcnt lgkmcnt(6)
    v_mfma_f32_32x32x16_bf16 v[80:95], v[48:51], v[132:135], v[80:95]
    ds_read_b128 v[76:79], v14 offset:35840
    s_waitcnt lgkmcnt(6)
    v_mfma_f32_32x32x16_bf16 v[96:111], v[52:55], v[132:135], v[96:111]
    ds_read_b128 v[48:51], v14 offset:36864
    s_waitcnt lgkmcnt(6)
    v_mfma_f32_32x32x16_bf16 v[80:95], v[56:59], v[128:131], v[80:95]
    ds_read_b128 v[52:55], v14 offset:37888
    s_waitcnt vmcnt(0)
    v_cmp_ne_u32 vcc, 1, v36
    s_cbranch_vccnz spin_79
spin_80:
    s_add_u32 s31, s31, 8192
    s_add_u32 s41, s40, 0
    buffer_load_dwordx4 v[252:255], v2, s[8:11], s41 offen offset:0 sc1
    buffer_load_dwordx4 v[248:251], v2, s[8:11], s41 offen offset:1024 sc1
    buffer_load_dwordx4 v[244:247], v2, s[8:11], s41 offen offset:2048 sc1
    buffer_load_dwordx4 v[240:243], v2, s[8:11], s41 offen offset:3072 sc1
    s_waitcnt lgkmcnt(6)
    v_mfma_f32_32x32x16_bf16 v[96:111], v[60:63], v[128:131], v[96:111]
    ds_read_b128 v[56:59], v14 offset:38912
    s_add_u32 s41, s40, 4096
    buffer_load_dwordx4 v[236:239], v2, s[8:11], s41 offen offset:0 sc1
    buffer_load_dwordx4 v[232:235], v2, s[8:11], s41 offen offset:1024 sc1
    buffer_load_dwordx4 v[228:231], v2, s[8:11], s41 offen offset:2048 sc1
    buffer_load_dwordx4 v[224:227], v2, s[8:11], s41 offen offset:3072 sc1
    s_waitcnt lgkmcnt(6)
    v_mfma_f32_32x32x16_bf16 v[80:95], v[64:67], v[124:127], v[80:95]
    ds_read_b128 v[60:63], v14 offset:39936
    s_add_u32 s41, s40, 8192
    buffer_load_dwordx4 v[220:223], v2, s[8:11], s41 offen offset:0 sc1
    s_waitcnt lgkmcnt(6)
    v_mfma_f32_32x32x16_bf16 v[96:111], v[68:71], v[124:127], v[96:111]
    ds_read_b128 v[64:67], v12 offset:0
    s_waitcnt lgkmcnt(6)
    v_mfma_f32_32x32x16_bf16 v[80:95], v[72:75], v[120:123], v[80:95]
    ds_read_b128 v[68:71], v12 offset:1024
    buffer_load_dwordx4 v[216:219], v2, s[8:11], s41 offen offset:1024 sc1
    s_waitcnt lgkmcnt(6)
    v_mfma_f32_32x32x16_bf16 v[96:111], v[76:79], v[120:123], v[96:111]
    ds_read_b128 v[72:75], v12 offset:2048
    s_waitcnt lgkmcnt(6)
    v_mfma_f32_32x32x16_bf16 v[80:95], v[48:51], v[116:119], v[80:95]
    ds_read_b128 v[76:79], v12 offset:3072
    buffer_load_dwordx4 v[212:215], v2, s[8:11], s41 offen offset:2048 sc1
    s_waitcnt lgkmcnt(6)
    v_mfma_f32_32x32x16_bf16 v[96:111], v[52:55], v[116:119], v[96:111]
    ds_read_b128 v[48:51], v12 offset:4096
    s_waitcnt lgkmcnt(6)
    v_mfma_f32_32x32x16_bf16 v[80:95], v[56:59], v[112:115], v[80:95]
    ds_read_b128 v[52:55], v12 offset:5120
    buffer_load_dwordx4 v[208:211], v2, s[8:11], s41 offen offset:3072 sc1
    s_waitcnt lgkmcnt(6)
    v_mfma_f32_32x32x16_bf16 v[96:111], v[60:63], v[112:115], v[96:111]
    s_barrier
    ds_read_b128 v[56:59], v12 offset:6144
    s_nop 7
    s_nop 2
    v_cvt_pk_bf16_f32 v80, v80, v81
    v_cvt_pk_bf16_f32 v81, v82, v83
    v_cvt_pk_bf16_f32 v82, v84, v85
    v_cvt_pk_bf16_f32 v83, v86, v87
    v_pk_max_i16 v80, v80, 0
    v_pk_max_i16 v81, v81, 0
    v_pk_max_i16 v82, v82, 0
    v_pk_max_i16 v83, v83, 0
    v_cvt_pk_bf16_f32 v84, v88, v89
    v_cvt_pk_bf16_f32 v85, v90, v91
    v_cvt_pk_bf16_f32 v86, v92, v93
    v_cvt_pk_bf16_f32 v87, v94, v95
    v_pk_max_i16 v84, v84, 0
    v_pk_max_i16 v85, v85, 0
    v_pk_max_i16 v86, v86, 0
    v_pk_max_i16 v87, v87, 0
    buffer_store_dwordx4 v[80:83], v34, s[16:19], s82 offen offset:0 sc1
    buffer_store_dwordx4 v[84:87], v34, s[16:19], s82 offen offset:512 sc1
    v_cvt_pk_bf16_f32 v96, v96, v97
    v_cvt_pk_bf16_f32 v97, v98, v99
    v_cvt_pk_bf16_f32 v98, v100, v101
    v_cvt_pk_bf16_f32 v99, v102, v103
    v_pk_max_i16 v96, v96, 0
    v_pk_max_i16 v97, v97, 0
    v_pk_max_i16 v98, v98, 0
    v_pk_max_i16 v99, v99, 0
    v_cvt_pk_bf16_f32 v100, v104, v105
    v_cvt_pk_bf16_f32 v101, v106, v107
    v_cvt_pk_bf16_f32 v102, v108, v109
    v_cvt_pk_bf16_f32 v103, v110, v111
    v_pk_max_i16 v100, v100, 0
    v_pk_max_i16 v101, v101, 0
    v_pk_max_i16 v102, v102, 0
    v_pk_max_i16 v103, v103, 0
    buffer_store_dwordx4 v[96:99], v34, s[16:19], s82 offen offset:1024 sc1
    buffer_store_dwordx4 v[100:103], v34, s[16:19], s82 offen offset:1536 sc1
    s_nop 1
    s_waitcnt vmcnt(15) lgkmcnt(5)
    v_mfma_f32_16x16x32_bf16 v[80:83], v[64:67], v[252:255], 0
    ds_read_b128 v[60:63], v12 offset:7168
    s_add_u32 s41, s40, 12288
    buffer_load_dwordx4 v[204:207], v2, s[8:11], s41 offen offset:0 sc1
    v_mfma_f32_16x16x32_bf16 v[84:87], v[68:71], v[252:255], 0
    ds_read_b128 v[64:67], v12 offset:8192
    s_waitcnt lgkmcnt(5)
    v_mfma_f32_16x16x32_bf16 v[88:91], v[72:75], v[252:255], 0
    ds_read_b128 v[68:71], v12 offset:9216
    v_mfma_f32_16x16x32_bf16 v[92:95], v[76:79], v[252:255], 0
    ds_read_b128 v[72:75], v12 offset:10240
    s_waitcnt lgkmcnt(5)
    v_mfma_f32_16x16x32_bf16 v[96:99], v[48:51], v[252:255], 0
    ds_read_b128 v[76:79], v12 offset:11264
    s_waitcnt vmcnt(15)
    v_mfma_f32_16x16x32_bf16 v[80:83], v[52:55], v[248:251], v[80:83]
    ds_read_b128 v[48:51], v12 offset:12288
    buffer_load_dwordx4 v[200:203], v2, s[8:11], s41 offen offset:1024 sc1
    s_waitcnt lgkmcnt(5)
    v_mfma_f32_16x16x32_bf16 v[84:87], v[56:59], v[248:251], v[84:87]
    ds_read_b128 v[52:55], v12 offset:13312
    v_mfma_f32_16x16x32_bf16 v[88:91], v[60:63], v[248:251], v[88:91]
    ds_read_b128 v[56:59], v12 offset:14336
    s_waitcnt lgkmcnt(5)
    v_mfma_f32_16x16x32_bf16 v[92:95], v[64:67], v[248:251], v[92:95]
    ds_read_b128 v[60:63], v12 offset:15360
    v_mfma_f32_16x16x32_bf16 v[96:99], v[68:71], v[248:251], v[96:99]
    ds_read_b128 v[64:67], v12 offset:16384
    s_waitcnt vmcnt(15) lgkmcnt(5)
    v_mfma_f32_16x16x32_bf16 v[80:83], v[72:75], v[244:247], v[80:83]
    ds_read_b128 v[68:71], v12 offset:17408
    buffer_load_dwordx4 v[196:199], v2, s[8:11], s41 offen offset:2048 sc1
    v_mfma_f32_16x16x32_bf16 v[84:87], v[76:79], v[244:247], v[84:87]
    ds_read_b128 v[72:75], v12 offset:18432
    s_waitcnt lgkmcnt(5)
    v_mfma_f32_16x16x32_bf16 v[88:91], v[48:51], v[244:247], v[88:91]
    ds_read_b128 v[76:79], v12 offset:19456
    v_mfma_f32_16x16x32_bf16 v[92:95], v[52:55], v[244:247], v[92:95]
    ds_read_b128 v[48:51], v12 offset:20480
    s_waitcnt lgkmcnt(5)
    v_mfma_f32_16x16x32_bf16 v[96:99], v[56:59], v[244:247], v[96:99]
    ds_read_b128 v[52:55], v12 offset:21504
    s_waitcnt vmcnt(15)
    v_mfma_f32_16x16x32_bf16 v[80:83], v[60:63], v[240:243], v[80:83]
    ds_read_b128 v[56:59], v12 offset:22528
    buffer_load_dwordx4 v[192:195], v2, s[8:11], s41 offen offset:3072 sc1
    s_waitcnt lgkmcnt(5)
    v_mfma_f32_16x16x32_bf16 v[84:87], v[64:67], v[240:243], v[84:87]
    ds_read_b128 v[60:63], v12 offset:23552
    v_mfma_f32_16x16x32_bf16 v[88:91], v[68:71], v[240:243], v[88:91]
    ds_read_b128 v[64:67], v12 offset:24576
    s_waitcnt lgkmcnt(5)
    v_mfma_f32_16x16x32_bf16 v[92:95], v[72:75], v[240:243], v[92:95]
    ds_read_b128 v[68:71], v12 offset:25600
    v_mfma_f32_16x16x32_bf16 v[96:99], v[76:79], v[240:243], v[96:99]
    ds_read_b128 v[72:75], v12 offset:26624
    s_waitcnt vmcnt(15) lgkmcnt(5)
    v_mfma_f32_16x16x32_bf16 v[80:83], v[48:51], v[236:239], v[80:83]
    ds_read_b128 v[76:79], v12 offset:27648
    s_add_u32 s41, s40, 16384
    buffer_load_dwordx4 v[188:191], v2, s[8:11], s41 offen offset:0 sc1
    v_mfma_f32_16x16x32_bf16 v[84:87], v[52:55], v[236:239], v[84:87]
    ds_read_b128 v[48:51], v12 offset:28672
    s_waitcnt lgkmcnt(5)
    v_mfma_f32_16x16x32_bf16 v[88:91], v[56:59], v[236:239], v[88:91]
    ds_read_b128 v[52:55], v12 offset:29696
    v_mfma_f32_16x16x32_bf16 v[92:95], v[60:63], v[236:239], v[92:95]
    ds_read_b128 v[56:59], v12 offset:30720
    s_waitcnt lgkmcnt(5)
    v_mfma_f32_16x16x32_bf16 v[96:99], v[64:67], v[236:239], v[96:99]
    ds_read_b128 v[60:63], v12 offset:31744
    s_waitcnt vmcnt(15)
    v_mfma_f32_16x16x32_bf16 v[80:83], v[68:71], v[232:235], v[80:83]
    ds_read_b128 v[64:67], v12 offset:32768
    buffer_load_dwordx4 v[184:187], v2, s[8:11], s41 offen offset:1024 sc1
    s_waitcnt lgkmcnt(5)
    v_mfma_f32_16x16x32_bf16 v[84:87], v[72:75], v[232:235], v[84:87]
    ds_read_b128 v[68:71], v12 offset:33792
    v_mfma_f32_16x16x32_bf16 v[88:91], v[76:79], v[232:235], v[88:91]
    ds_read_b128 v[72:75], v12 offset:34816
    s_waitcnt lgkmcnt(5)
    v_mfma_f32_16x16x32_bf16 v[92:95], v[48:51], v[232:235], v[92:95]
    ds_read_b128 v[76:79], v12 offset:35840
    v_mfma_f32_16x16x32_bf16 v[96:99], v[52:55], v[232:235], v[96:99]
    ds_read_b128 v[48:51], v12 offset:36864
    s_waitcnt vmcnt(15) lgkmcnt(5)
    v_mfma_f32_16x16x32_bf16 v[80:83], v[56:59], v[228:231], v[80:83]
    ds_read_b128 v[52:55], v12 offset:37888
    buffer_load_dwordx4 v[180:183], v2, s[8:11], s41 offen offset:2048 sc1
    v_mfma_f32_16x16x32_bf16 v[84:87], v[60:63], v[228:231], v[84:87]
    ds_read_b128 v[56:59], v12 offset:38912
    s_waitcnt lgkmcnt(5)
    v_mfma_f32_16x16x32_bf16 v[88:91], v[64:67], v[228:231], v[88:91]
    ds_read_b128 v[60:63], v12 offset:39936
    v_mfma_f32_16x16x32_bf16 v[92:95], v[68:71], v[228:231], v[92:95]
    ds_read_b128 v[64:67], v12 offset:40960
    s_waitcnt lgkmcnt(5)
    v_mfma_f32_16x16x32_bf16 v[96:99], v[72:75], v[228:231], v[96:99]
    ds_read_b128 v[68:71], v12 offset:41984
    s_waitcnt vmcnt(15)
    v_mfma_f32_16x16x32_bf16 v[80:83], v[76:79], v[224:227], v[80:83]
    ds_read_b128 v[72:75], v12 offset:43008
    buffer_load_dwordx4 v[176:179], v2, s[8:11], s41 offen offset:3072 sc1
    s_waitcnt lgkmcnt(5)
    v_mfma_f32_16x16x32_bf16 v[84:87], v[48:51], v[224:227], v[84:87]
    ds_read_b128 v[76:79], v12 offset:44032
    v_mfma_f32_16x16x32_bf16 v[88:91], v[52:55], v[224:227], v[88:91]
    ds_read_b128 v[48:51], v12 offset:45056
    s_waitcnt lgkmcnt(5)
    v_mfma_f32_16x16x32_bf16 v[92:95], v[56:59], v[224:227], v[92:95]
    ds_read_b128 v[52:55], v12 offset:46080
    v_mfma_f32_16x16x32_bf16 v[96:99], v[60:63], v[224:227], v[96:99]
    s_barrier
    ds_read_b128 v[56:59], v12 offset:47104
    s_waitcnt vmcnt(15) lgkmcnt(5)
    v_mfma_f32_16x16x32_bf16 v[80:83], v[64:67], v[220:223], v[80:83]
    ds_read_b128 v[60:63], v12 offset:48128
    s_waitcnt vmcnt(8)
    s_cmp_eq_u32 s42, 0
    s_cbranch_scc1 wt_81
    s_mov_b64 exec, 1
    buffer_store_dword v4, v5, s[16:19], s39 offen
    s_mov_b64 exec, -1
wt_82:
    s_add_u32 s41, s40, 20480
    buffer_load_dwordx4 v[172:175], v2, s[8:11], s41 offen offset:0 sc1
    v_mfma_f32_16x16x32_bf16 v[84:87], v[68:71], v[220:223], v[84:87]
    ds_read_b128 v[64:67], v12 offset:49152
    s_waitcnt lgkmcnt(5)
    v_mfma_f32_16x16x32_bf16 v[88:91], v[72:75], v[220:223], v[88:91]
    ds_read_b128 v[68:71], v12 offset:50176
    v_mfma_f32_16x16x32_bf16 v[92:95], v[76:79], v[220:223], v[92:95]
    ds_read_b128 v[72:75], v12 offset:51200
    s_waitcnt lgkmcnt(5)
    v_mfma_f32_16x16x32_bf16 v[96:99], v[48:51], v[220:223], v[96:99]
    ds_read_b128 v[76:79], v12 offset:52224
    v_mfma_f32_16x16x32_bf16 v[80:83], v[52:55], v[216:219], v[80:83]
    ds_read_b128 v[48:51], v12 offset:53248
    buffer_load_dwordx4 v[168:171], v2, s[8:11], s41 offen offset:1024 sc1
    s_waitcnt lgkmcnt(5)
    v_mfma_f32_16x16x32_bf16 v[84:87], v[56:59], v[216:219], v[84:87]
    ds_read_b128 v[52:55], v12 offset:54272
    v_mfma_f32_16x16x32_bf16 v[88:91], v[60:63], v[216:219], v[88:91]
    ds_read_b128 v[56:59], v12 offset:55296
    s_waitcnt lgkmcnt(5)
    v_mfma_f32_16x16x32_bf16 v[92:95], v[64:67], v[216:219], v[92:95]
    ds_read_b128 v[60:63], v12 offset:56320
    v_mfma_f32_16x16x32_bf16 v[96:99], v[68:71], v[216:219], v[96:99]
    ds_read_b128 v[64:67], v12 offset:57344
    s_waitcnt lgkmcnt(5)
    v_mfma_f32_16x16x32_bf16 v[80:83], v[72:75], v[212:215], v[80:83]
    ds_read_b128 v[68:71], v12 offset:58368
    buffer_load_dwordx4 v[164:167], v2, s[8:11], s41 offen offset:2048 sc1
    v_mfma_f32_16x16x32_bf16 v[84:87], v[76:79], v[212:215], v[84:87]
    ds_read_b128 v[72:75], v12 offset:59392
    s_waitcnt lgkmcnt(5)
    v_mfma_f32_16x16x32_bf16 v[88:91], v[48:51], v[212:215], v[88:91]
    ds_read_b128 v[76:79], v12 offset:60416
    v_mfma_f32_16x16x32_bf16 v[92:95], v[52:55], v[212:215], v[92:95]
    ds_read_b128 v[48:51], v13 offset:0
    s_waitcnt lgkmcnt(5)
    v_mfma_f32_16x16x32_bf16 v[96:99], v[56:59], v[212:215], v[96:99]
    ds_read_b128 v[52:55], v13 offset:1024
    v_mfma_f32_16x16x32_bf16 v[80:83], v[60:63], v[208:211], v[80:83]
    ds_read_b128 v[56:59], v13 offset:2048
    buffer_load_dwordx4 v[160:163], v2, s[8:11], s41 offen offset:3072 sc1
    s_waitcnt lgkmcnt(5)
    v_mfma_f32_16x16x32_bf16 v[84:87], v[64:67], v[208:211], v[84:87]
    ds_read_b128 v[60:63], v13 offset:3072
    v_mfma_f32_16x16x32_bf16 v[88:91], v[68:71], v[208:211], v[88:91]
    ds_read_b128 v[64:67], v13 offset:4096
    s_waitcnt lgkmcnt(5)
    v_mfma_f32_16x16x32_bf16 v[92:95], v[72:75], v[208:211], v[92:95]
    ds_read_b128 v[68:71], v13 offset:5120
    v_mfma_f32_16x16x32_bf16 v[96:99], v[76:79], v[208:211], v[96:99]
    ds_read_b128 v[72:75], v13 offset:6144
    s_waitcnt vmcnt(12) lgkmcnt(5)
    v_mfma_f32_16x16x32_bf16 v[80:83], v[48:51], v[204:207], v[80:83]
    ds_read_b128 v[76:79], v13 offset:7168
    s_add_u32 s41, s40, 24576
    buffer_load_dwordx4 v[156:159], v2, s[8:11], s41 offen offset:0 sc1
    v_mfma_f32_16x16x32_bf16 v[84:87], v[52:55], v[204:207], v[84:87]
    ds_read_b128 v[48:51], v13 offset:8192
    s_waitcnt lgkmcnt(5)
    v_mfma_f32_16x16x32_bf16 v[88:91], v[56:59], v[204:207], v[88:91]
    ds_read_b128 v[52:55], v13 offset:9216
    v_mfma_f32_16x16x32_bf16 v[92:95], v[60:63], v[204:207], v[92:95]
    ds_read_b128 v[56:59], v13 offset:10240
    s_waitcnt lgkmcnt(5)
    v_mfma_f32_16x16x32_bf16 v[96:99], v[64:67], v[204:207], v[96:99]
    ds_read_b128 v[60:63], v13 offset:11264
    s_waitcnt vmcnt(12)
    v_mfma_f32_16x16x32_bf16 v[80:83], v[68:71], v[200:203], v[80:83]
    ds_read_b128 v[64:67], v13 offset:12288
    buffer_load_dwordx4 v[152:155], v2, s[8:11], s41 offen offset:1024 sc1
    s_waitcnt lgkmcnt(5)
    v_mfma_f32_16x16x32_bf16 v[84:87], v[72:75], v[200:203], v[84:87]
    ds_read_b128 v[68:71], v13 offset:13312
    v_mfma_f32_16x16x32_bf16 v[88:91], v[76:79], v[200:203], v[88:91]
    ds_read_b128 v[72:75], v13 offset:14336
    s_waitcnt lgkmcnt(5)
    v_mfma_f32_16x16x32_bf16 v[92:95], v[48:51], v[200:203], v[92:95]
    ds_read_b128 v[76:79], v13 offset:15360
    v_mfma_f32_16x16x32_bf16 v[96:99], v[52:55], v[200:203], v[96:99]
    ds_read_b128 v[48:51], v13 offset:16384
    s_waitcnt vmcnt(12) lgkmcnt(5)
    v_mfma_f32_16x16x32_bf16 v[80:83], v[56:59], v[196:199], v[80:83]
    ds_read_b128 v[52:55], v13 offset:17408
    v_min_u32 v10, 48, v3
    buffer_load_dword v36, v10, s[8:11], s31 offen sc1
    buffer_load_dwordx4 v[148:151], v2, s[8:11], s41 offen offset:2048 sc1
    v_mfma_f32_16x16x32_bf16 v[84:87], v[60:63], v[196:199], v[84:87]
    ds_read_b128 v[56:59], v13 offset:18432
    s_waitcnt lgkmcnt(5)
    v_mfma_f32_16x16x32_bf16 v[88:91], v[64:67], v[196:199], v[88:91]
    ds_read_b128 v[60:63], v13 offset:19456
    v_mfma_f32_16x16x32_bf16 v[92:95], v[68:71], v[196:199], v[92:95]
    ds_read_b128 v[64:67], v13 offset:20480
    s_waitcnt lgkmcnt(5)
    v_mfma_f32_16x16x32_bf16 v[96:99], v[72:75], v[196:199], v[96:99]
    ds_read_b128 v[68:71], v13 offset:21504
    s_waitcnt vmcnt(13)
    v_mfma_f32_16x16x32_bf16 v[80:83], v[76:79], v[192:195], v[80:83]
    ds_read_b128 v[72:75], v13 offset:22528
    buffer_load_dwordx4 v[144:147], v2, s[8:11], s41 offen offset:3072 sc1
    s_waitcnt lgkmcnt(5)
    v_mfma_f32_16x16x32_bf16 v[84:87], v[48:51], v[192:195], v[84:87]
    ds_read_b128 v[76:79], v13 offset:23552
    v_mfma_f32_16x16x32_bf16 v[88:91], v[52:55], v[192:195], v[88:91]
    ds_read_b128 v[48:51], v13 offset:24576
    s_waitcnt lgkmcnt(5)
    v_mfma_f32_16x16x32_bf16 v[92:95], v[56:59], v[192:195], v[92:95]
    ds_read_b128 v[52:55], v13 offset:25600
    v_mfma_f32_16x16x32_bf16 v[96:99], v[60:63], v[192:195], v[96:99]
    s_barrier
    ds_read_b128 v[56:59], v13 offset:26624
    s_waitcnt vmcnt(13) lgkmcnt(5)
    v_mfma_f32_16x16x32_bf16 v[80:83], v[64:67], v[188:191], v[80:83]
    ds_read_b128 v[60:63], v13 offset:27648
    v_mfma_f32_16x16x32_bf16 v[84:87], v[68:71], v[188:191], v[84:87]
    ds_read_b128 v[64:67], v13 offset:28672
    s_waitcnt lgkmcnt(5)
    v_mfma_f32_16x16x32_bf16 v[88:91], v[72:75], v[188:191], v[88:91]
    ds_read_b128 v[68:71], v13 offset:29696
    v_mfma_f32_16x16x32_bf16 v[92:95], v[76:79], v[188:191], v[92:95]
    ds_read_b128 v[72:75], v13 offset:30720
    s_waitcnt lgkmcnt(5)
    v_mfma_f32_16x16x32_bf16 v[96:99], v[48:51], v[188:191], v[96:99]
    ds_read_b128 v[76:79], v13 offset:31744
    s_waitcnt vmcnt(12)
    v_mfma_f32_16x16x32_bf16 v[80:83], v[52:55], v[184:187], v[80:83]
    ds_read_b128 v[48:51], v13 offset:32768
    s_waitcnt lgkmcnt(5)
    v_mfma_f32_16x16x32_bf16 v[84:87], v[56:59], v[184:187], v[84:87]
    ds_read_b128 v[52:55], v13 offset:33792
    v_mfma_f32_16x16x32_bf16 v[88:91], v[60:63], v[184:187], v[88:91]
    ds_read_b128 v[56:59], v13 offset:34816
    s_waitcnt lgkmcnt(5)
    v_mfma_f32_16x16x32_bf16 v[92:95], v[64:67], v[184:187], v[92:95]
    ds_read_b128 v[60:63], v13 offset:35840
    v_mfma_f32_16x16x32_bf16 v[96:99], v[68:71], v[184:187], v[96:99]
    ds_read_b128 v[64:67], v13 offset:36864
    s_waitcnt vmcnt(11) lgkmcnt(5)
    v_mfma_f32_16x16x32_bf16 v[80:83], v[72:75], v[180:183], v[80:83]
    ds_read_b128 v[68:71], v13 offset:37888
    v_mfma_f32_16x16x32_bf16 v[84:87], v[76:79], v[180:183], v[84:87]
    ds_read_b128 v[72:75], v13 offset:38912
    s_waitcnt lgkmcnt(5)
    v_mfma_f32_16x16x32_bf16 v[88:91], v[48:51], v[180:183], v[88:91]
    ds_read_b128 v[76:79], v13 offset:39936
    v_mfma_f32_16x16x32_bf16 v[92:95], v[52:55], v[180:183], v[92:95]
    ds_read_b128 v[48:51], v13 offset:40960
    s_waitcnt lgkmcnt(5)
    v_mfma_f32_16x16x32_bf16 v[96:99], v[56:59], v[180:183], v[96:99]
    ds_read_b128 v[52:55], v13 offset:41984
    s_waitcnt vmcnt(10)
    v_mfma_f32_16x16x32_bf16 v[80:83], v[60:63], v[176:179], v[80:83]
    ds_read_b128 v[56:59], v13 offset:43008
    s_waitcnt lgkmcnt(5)
    v_mfma_f32_16x16x32_bf16 v[84:87], v[64:67], v[176:179], v[84:87]
    ds_read_b128 v[60:63], v13 offset:44032
    v_mfma_f32_16x16x32_bf16 v[88:91], v[68:71], v[176:179], v[88:91]
    ds_read_b128 v[64:67], v13 offset:45056
    s_waitcnt lgkmcnt(5)
    v_mfma_f32_16x16x32_bf16 v[92:95], v[72:75], v[176:179], v[92:95]
    ds_read_b128 v[68:71], v13 offset:46080
    v_mfma_f32_16x16x32_bf16 v[96:99], v[76:79], v[176:179], v[96:99]
    ds_read_b128 v[72:75], v13 offset:47104
    s_waitcnt vmcnt(8) lgkmcnt(5)
    v_mfma_f32_16x16x32_bf16 v[80:83], v[48:51], v[172:175], v[80:83]
    ds_read_b128 v[76:79], v13 offset:48128
    s_waitcnt vmcnt(2)
    v_cmp_ne_u32 vcc, 1, v36
    s_cbranch_vccnz spin_83
spin_84:
    s_add_u32 s41, s40, 28672
    buffer_load_dwordx4 v[140:143], v2, s[8:11], s41 offen offset:0 sc1
    v_mfma_f32_16x16x32_bf16 v[84:87], v[52:55], v[172:175], v[84:87]
    ds_read_b128 v[48:51], v13 offset:49152
    buffer_load_dwordx4 v[136:139], v2, s[8:11], s41 offen offset:1024 sc1
    s_waitcnt lgkmcnt(5)
    v_mfma_f32_16x16x32_bf16 v[88:91], v[56:59], v[172:175], v[88:91]
    ds_read_b128 v[52:55], v13 offset:50176
    buffer_load_dwordx4 v[132:135], v2, s[8:11], s41 offen offset:2048 sc1
    v_mfma_f32_16x16x32_bf16 v[92:95], v[60:63], v[172:175], v[92:95]
    ds_read_b128 v[56:59], v13 offset:51200
    buffer_load_dwordx4 v[128:131], v2, s[8:11], s41 offen offset:3072 sc1
    s_waitcnt lgkmcnt(5)
    v_mfma_f32_16x16x32_bf16 v[96:99], v[64:67], v[172:175], v[96:99]
    ds_read_b128 v[60:63], v13 offset:52224
    s_add_u32 s41, s40, 32768
    buffer_load_dwordx4 v[248:251], v2, s[8:11], s41 offen offset:0 sc1
    v_mfma_f32_16x16x32_bf16 v[80:83], v[68:71], v[168:171], v[80:83]
    ds_read_b128 v[64:67], v13 offset:53248
    buffer_load_dwordx4 v[244:247], v2, s[8:11], s41 offen offset:1024 sc1
    s_waitcnt lgkmcnt(5)
    v_mfma_f32_16x16x32_bf16 v[84:87], v[72:75], v[168:171], v[84:87]
    ds_read_b128 v[68:71], v13 offset:54272
    v_mfma_f32_16x16x32_bf16 v[88:91], v[76:79], v[168:171], v[88:91]
    ds_read_b128 v[72:75], v13 offset:55296
    s_waitcnt lgkmcnt(5)
    v_mfma_f32_16x16x32_bf16 v[92:95], v[48:51], v[168:171], v[92:95]
    ds_read_b128 v[76:79], v13 offset:56320
    v_mfma_f32_16x16x32_bf16 v[96:99], v[52:55], v[168:171], v[96:99]
    ds_read_b128 v[48:51], v13 offset:57344
    s_waitcnt lgkmcnt(5)
    v_mfma_f32_16x16x32_bf16 v[80:83], v[56:59], v[164:167], v[80:83]
    ds_read_b128 v[52:55], v13 offset:58368
    buffer_load_dwordx4 v[240:243], v2, s[8:11], s41 offen offset:2048 sc1
    v_mfma_f32_16x16x32_bf16 v[84:87], v[60:63], v[164:167], v[84:87]
    ds_read_b128 v[56:59], v13 offset:59392
    s_waitcnt lgkmcnt(5)
    v_mfma_f32_16x16x32_bf16 v[88:91], v[64:67], v[164:167], v[88:91]
    ds_read_b128 v[60:63], v13 offset:60416
    v_mfma_f32_16x16x32_bf16 v[92:95], v[68:71], v[164:167], v[92:95]
    ds_read_b128 v[64:67], v14 offset:0
    s_waitcnt lgkmcnt(5)
    v_mfma_f32_16x16x32_bf16 v[96:99], v[72:75], v[164:167], v[96:99]
    ds_read_b128 v[68:71], v14 offset:1024
    v_mfma_f32_16x16x32_bf16 v[80:83], v[76:79], v[160:163], v[80:83]
    ds_read_b128 v[72:75], v14 offset:2048
    buffer_load_dwordx4 v[236:239], v2, s[8:11], s41 offen offset:3072 sc1
    s_waitcnt lgkmcnt(5)
    v_mfma_f32_16x16x32_bf16 v[84:87], v[48:51], v[160:163], v[84:87]
    ds_read_b128 v[76:79], v14 offset:3072
    v_mfma_f32_16x16x32_bf16 v[88:91], v[52:55], v[160:163], v[88:91]
    ds_read_b128 v[48:51], v14 offset:4096
    s_waitcnt lgkmcnt(5)
    v_mfma_f32_16x16x32_bf16 v[92:95], v[56:59], v[160:163], v[92:95]
    ds_read_b128 v[52:55], v14 offset:5120
    v_mfma_f32_16x16x32_bf16 v[96:99], v[60:63], v[160:163], v[96:99]
    s_barrier
    ds_read_b128 v[56:59], v14 offset:6144
    s_waitcnt lgkmcnt(5)
    v_mfma_f32_16x16x32_bf16 v[80:83], v[64:67], v[156:159], v[80:83]
    ds_read_b128 v[60:63], v14 offset:7168
    s_add_u32 s41, s40, 36864
    buffer_load_dwordx4 v[232:235], v2, s[8:11], s41 offen offset:0 sc1
    v_mfma_f32_16x16x32_bf16 v[84:87], v[68:71], v[156:159], v[84:87]
    ds_read_b128 v[64:67], v14 offset:8192
    s_waitcnt lgkmcnt(5)
    v_mfma_f32_16x16x32_bf16 v[88:91], v[72:75], v[156:159], v[88:91]
    ds_read_b128 v[68:71], v14 offset:9216
    v_mfma_f32_16x16x32_bf16 v[92:95], v[76:79], v[156:159], v[92:95]
    ds_read_b128 v[72:75], v14 offset:10240
    s_waitcnt lgkmcnt(5)
    v_mfma_f32_16x16x32_bf16 v[96:99], v[48:51], v[156:159], v[96:99]
    ds_read_b128 v[76:79], v14 offset:11264
    v_mfma_f32_16x16x32_bf16 v[80:83], v[52:55], v[152:155], v[80:83]
    ds_read_b128 v[48:51], v14 offset:12288
    buffer_load_dwordx4 v[228:231], v2, s[8:11], s41 offen offset:1024 sc1
    s_waitcnt lgkmcnt(5)
    v_mfma_f32_16x16x32_bf16 v[84:87], v[56:59], v[152:155], v[84:87]
    ds_read_b128 v[52:55], v14 offset:13312
    v_mfma_f32_16x16x32_bf16 v[88:91], v[60:63], v[152:155], v[88:91]
    ds_read_b128 v[56:59], v14 offset:14336
    s_waitcnt lgkmcnt(5)
    v_mfma_f32_16x16x32_bf16 v[92:95], v[64:67], v[152:155], v[92:95]
    ds_read_b128 v[60:63], v14 offset:15360
    v_mfma_f32_16x16x32_bf16 v[96:99], v[68:71], v[152:155], v[96:99]
    ds_read_b128 v[64:67], v14 offset:16384
    s_waitcnt vmcnt(11) lgkmcnt(5)
    v_mfma_f32_16x16x32_bf16 v[80:83], v[72:75], v[148:151], v[80:83]
    ds_read_b128 v[68:71], v14 offset:17408
    buffer_load_dwordx4 v[224:227], v2, s[8:11], s41 offen offset:2048 sc1
    v_mfma_f32_16x16x32_bf16 v[84:87], v[76:79], v[148:151], v[84:87]
    ds_read_b128 v[72:75], v14 offset:18432
    s_waitcnt lgkmcnt(5)
    v_mfma_f32_16x16x32_bf16 v[88:91], v[48:51], v[148:151], v[88:91]
    ds_read_b128 v[76:79], v14 offset:19456
    v_mfma_f32_16x16x32_bf16 v[92:95], v[52:55], v[148:151], v[92:95]
    ds_read_b128 v[48:51], v14 offset:20480
    s_waitcnt lgkmcnt(5)
    v_mfma_f32_16x16x32_bf16 v[96:99], v[56:59], v[148:151], v[96:99]
    ds_read_b128 v[52:55], v14 offset:21504
    s_waitcnt vmcnt(11)
    v_mfma_f32_16x16x32_bf16 v[80:83], v[60:63], v[144:147], v[80:83]
    ds_read_b128 v[56:59], v14 offset:22528
    buffer_load_dwordx4 v[220:223], v2, s[8:11], s41 offen offset:3072 sc1
    s_waitcnt lgkmcnt(5)
    v_mfma_f32_16x16x32_bf16 v[84:87], v[64:67], v[144:147], v[84:87]
    ds_read_b128 v[60:63], v14 offset:23552
    v_mfma_f32_16x16x32_bf16 v[88:91], v[68:71], v[144:147], v[88:91]
    ds_read_b128 v[64:67], v14 offset:24576
    s_waitcnt lgkmcnt(5)
    v_mfma_f32_16x16x32_bf16 v[92:95], v[72:75], v[144:147], v[92:95]
    ds_read_b128 v[68:71], v14 offset:25600
    v_mfma_f32_16x16x32_bf16 v[96:99], v[76:79], v[144:147], v[96:99]
    ds_read_b128 v[72:75], v14 offset:26624
    s_waitcnt vmcnt(11) lgkmcnt(5)
    v_mfma_f32_16x16x32_bf16 v[80:83], v[48:51], v[140:143], v[80:83]
    ds_read_b128 v[76:79], v14 offset:27648
    s_add_u32 s41, s40, 40960
    buffer_load_dwordx4 v[216:219], v2, s[8:11], s41 offen offset:0 sc1
    v_mfma_f32_16x16x32_bf16 v[84:87], v[52:55], v[140:143], v[84:87]
    ds_read_b128 v[48:51], v14 offset:28672
    s_waitcnt lgkmcnt(5)
    v_mfma_f32_16x16x32_bf16 v[88:91], v[56:59], v[140:143], v[88:91]
    ds_read_b128 v[52:55], v14 offset:29696
    v_mfma_f32_16x16x32_bf16 v[92:95], v[60:63], v[140:143], v[92:95]
    ds_read_b128 v[56:59], v14 offset:30720
    s_waitcnt lgkmcnt(5)
    v_mfma_f32_16x16x32_bf16 v[96:99], v[64:67], v[140:143], v[96:99]
    ds_read_b128 v[60:63], v14 offset:31744
    s_waitcnt vmcnt(11)
    v_mfma_f32_16x16x32_bf16 v[80:83], v[68:71], v[136:139], v[80:83]
    ds_read_b128 v[64:67], v14 offset:32768
    buffer_load_dwordx4 v[212:215], v2, s[8:11], s41 offen offset:1024 sc1
    s_waitcnt lgkmcnt(5)
    v_mfma_f32_16x16x32_bf16 v[84:87], v[72:75], v[136:139], v[84:87]
    ds_read_b128 v[68:71], v14 offset:33792
    v_mfma_f32_16x16x32_bf16 v[88:91], v[76:79], v[136:139], v[88:91]
    ds_read_b128 v[72:75], v14 offset:34816
    s_waitcnt lgkmcnt(5)
    v_mfma_f32_16x16x32_bf16 v[92:95], v[48:51], v[136:139], v[92:95]
    ds_read_b128 v[76:79], v14 offset:35840
    v_mfma_f32_16x16x32_bf16 v[96:99], v[52:55], v[136:139], v[96:99]
    ds_read_b128 v[48:51], v14 offset:36864
    s_waitcnt vmcnt(11) lgkmcnt(5)
    v_mfma_f32_16x16x32_bf16 v[80:83], v[56:59], v[132:135], v[80:83]
    ds_read_b128 v[52:55], v14 offset:37888
    v_and_b32 v6, 15, v1
    v_lshlrev_b32 v8, 3, v6
    v_lshrrev_b32 v6, 4, v1
    v_lshl_add_u32 v8, v6, 15, v8
    s_lshl_b32 s27, s76, 7
    s_add_u32 s27, s27, 25532416
    buffer_load_dwordx2 v[28:29], v8, s[8:11], s27 offen sc1
    s_add_u32 s27, s27, 16384
    buffer_load_dwordx2 v[32:33], v8, s[8:11], s27 offen sc1
    buffer_load_dwordx4 v[208:211], v2, s[8:11], s41 offen offset:2048 sc1
    v_mfma_f32_16x16x32_bf16 v[84:87], v[60:63], v[132:135], v[84:87]
    ds_read_b128 v[56:59], v14 offset:38912
    s_waitcnt lgkmcnt(5)
    v_mfma_f32_16x16x32_bf16 v[88:91], v[64:67], v[132:135], v[88:91]
    ds_read_b128 v[60:63], v14 offset:39936
    v_mfma_f32_16x16x32_bf16 v[92:95], v[68:71], v[132:135], v[92:95]
    ds_read_b128 v[64:67], v12 offset:0
    s_waitcnt lgkmcnt(5)
    v_mfma_f32_16x16x32_bf16 v[96:99], v[72:75], v[132:135], v[96:99]
    ds_read_b128 v[68:71], v12 offset:1024
    s_waitcnt vmcnt(13)
    v_mfma_f32_16x16x32_bf16 v[80:83], v[76:79], v[128:131], v[80:83]
    ds_read_b128 v[72:75], v12 offset:2048
    v_lshrrev_b32 v7, 4, v1
    v_lshlrev_b32 v7, 3, v7
    v_sub_u32 v7, v15, v7
    buffer_load_dwordx4 v[204:207], v2, s[8:11], s41 offen offset:3072 sc1
    s_waitcnt lgkmcnt(5)
    v_mfma_f32_16x16x32_bf16 v[84:87], v[48:51], v[128:131], v[84:87]
    ds_read_b128 v[76:79], v12 offset:3072
    v_mfma_f32_16x16x32_bf16 v[88:91], v[52:55], v[128:131], v[88:91]
    ds_read_b128 v[48:51], v12 offset:4096
    s_waitcnt lgkmcnt(5)
    v_mfma_f32_16x16x32_bf16 v[92:95], v[56:59], v[128:131], v[92:95]
    ds_read_b128 v[52:55], v12 offset:5120
    v_mfma_f32_16x16x32_bf16 v[96:99], v[60:63], v[128:131], v[96:99]
    ds_read_b128 v[56:59], v12 offset:6144
    s_waitcnt vmcnt(13) lgkmcnt(5)
    v_mfma_f32_16x16x32_bf16 v[80:83], v[64:67], v[248:251], v[80:83]
    ds_read_b128 v[60:63], v12 offset:7168
    s_add_u32 s41, s40, 45056
    buffer_load_dwordx4 v[200:203], v2, s[8:11], s41 offen offset:0 sc1
    v_mfma_f32_16x16x32_bf16 v[84:87], v[68:71], v[248:251], v[84:87]
    ds_read_b128 v[64:67], v12 offset:8192
    s_waitcnt lgkmcnt(5)
    v_mfma_f32_16x16x32_bf16 v[88:91], v[72:75], v[248:251], v[88:91]
    ds_read_b128 v[68:71], v12 offset:9216
    v_mfma_f32_16x16x32_bf16 v[92:95], v[76:79], v[248:251], v[92:95]
    ds_read_b128 v[72:75], v12 offset:10240
    s_waitcnt lgkmcnt(5)
    v_mfma_f32_16x16x32_bf16 v[96:99], v[48:51], v[248:251], v[96:99]
    ds_read_b128 v[76:79], v12 offset:11264
    s_waitcnt vmcnt(13)
    v_mfma_f32_16x16x32_bf16 v[80:83], v[52:55], v[244:247], v[80:83]
    ds_read_b128 v[48:51], v12 offset:12288
    buffer_load_dwordx4 v[196:199], v2, s[8:11], s41 offen offset:1024 sc1
    s_waitcnt lgkmcnt(5)
    v_mfma_f32_16x16x32_bf16 v[84:87], v[56:59], v[244:247], v[84:87]
    ds_read_b128 v[52:55], v12 offset:13312
    v_mfma_f32_16x16x32_bf16 v[88:91], v[60:63], v[244:247], v[88:91]
    ds_read_b128 v[56:59], v12 offset:14336
    s_waitcnt lgkmcnt(5)
    v_mfma_f32_16x16x32_bf16 v[92:95], v[64:67], v[244:247], v[92:95]
    ds_read_b128 v[60:63], v12 offset:15360
    v_mfma_f32_16x16x32_bf16 v[96:99], v[68:71], v[244:247], v[96:99]
    ds_read_b128 v[64:67], v12 offset:16384
    s_waitcnt vmcnt(13) lgkmcnt(5)
    v_mfma_f32_16x16x32_bf16 v[80:83], v[72:75], v[240:243], v[80:83]
    ds_read_b128 v[68:71], v12 offset:17408
    buffer_load_dwordx4 v[192:195], v2, s[8:11], s41 offen offset:2048 sc1
    v_mfma_f32_16x16x32_bf16 v[84:87], v[76:79], v[240:243], v[84:87]
    ds_read_b128 v[72:75], v12 offset:18432
    s_waitcnt lgkmcnt(5)
    v_mfma_f32_16x16x32_bf16 v[88:91], v[48:51], v[240:243], v[88:91]
    ds_read_b128 v[76:79], v12 offset:19456
    v_mfma_f32_16x16x32_bf16 v[92:95], v[52:55], v[240:243], v[92:95]
    ds_read_b128 v[48:51], v12 offset:20480
    s_waitcnt lgkmcnt(5)
    v_mfma_f32_16x16x32_bf16 v[96:99], v[56:59], v[240:243], v[96:99]
    ds_read_b128 v[52:55], v12 offset:21504
    s_waitcnt vmcnt(13)
    v_mfma_f32_16x16x32_bf16 v[80:83], v[60:63], v[236:239], v[80:83]
    ds_read_b128 v[56:59], v12 offset:22528
    buffer_load_dwordx4 v[188:191], v2, s[8:11], s41 offen offset:3072 sc1
    s_waitcnt lgkmcnt(5)
    v_mfma_f32_16x16x32_bf16 v[84:87], v[64:67], v[236:239], v[84:87]
    ds_read_b128 v[60:63], v12 offset:23552
    v_mfma_f32_16x16x32_bf16 v[88:91], v[68:71], v[236:239], v[88:91]
    ds_read_b128 v[64:67], v12 offset:24576
    s_waitcnt lgkmcnt(5)
    v_mfma_f32_16x16x32_bf16 v[92:95], v[72:75], v[236:239], v[92:95]
    ds_read_b128 v[68:71], v12 offset:25600
    v_mfma_f32_16x16x32_bf16 v[96:99], v[76:79], v[236:239], v[96:99]
    s_barrier
    ds_read_b128 v[72:75], v12 offset:26624
    s_waitcnt vmcnt(13) lgkmcnt(5)
    v_mfma_f32_16x16x32_bf16 v[80:83], v[48:51], v[232:235], v[80:83]
    ds_read_b128 v[76:79], v12 offset:27648
    s_add_u32 s41, s40, 49152
    buffer_load_dwordx4 v[184:187], v2, s[8:11], s41 offen offset:0 sc1
    v_mfma_f32_16x16x32_bf16 v[84:87], v[52:55], v[232:235], v[84:87]
    ds_read_b128 v[48:51], v12 offset:28672
    s_waitcnt lgkmcnt(5)
    v_mfma_f32_16x16x32_bf16 v[88:91], v[56:59], v[232:235], v[88:91]
    ds_read_b128 v[52:55], v12 offset:29696
    v_mfma_f32_16x16x32_bf16 v[92:95], v[60:63], v[232:235], v[92:95]
    ds_read_b128 v[56:59], v12 offset:30720
    s_waitcnt lgkmcnt(5)
    v_mfma_f32_16x16x32_bf16 v[96:99], v[64:67], v[232:235], v[96:99]
    ds_read_b128 v[60:63], v12 offset:31744
    s_waitcnt vmcnt(13)
    v_mfma_f32_16x16x32_bf16 v[80:83], v[68:71], v[228:231], v[80:83]
    ds_read_b128 v[64:67], v12 offset:32768
    buffer_load_dwordx4 v[180:183], v2, s[8:11], s41 offen offset:1024 sc1
    s_waitcnt lgkmcnt(5)
    v_mfma_f32_16x16x32_bf16 v[84:87], v[72:75], v[228:231], v[84:87]
    ds_read_b128 v[68:71], v12 offset:33792
    v_mfma_f32_16x16x32_bf16 v[88:91], v[76:79], v[228:231], v[88:91]
    ds_read_b128 v[72:75], v12 offset:34816
    s_waitcnt lgkmcnt(5)
    v_mfma_f32_16x16x32_bf16 v[92:95], v[48:51], v[228:231], v[92:95]
    ds_read_b128 v[76:79], v12 offset:35840
    v_mfma_f32_16x16x32_bf16 v[96:99], v[52:55], v[228:231], v[96:99]
    ds_read_b128 v[48:51], v12 offset:36864
    s_waitcnt vmcnt(13) lgkmcnt(5)
    v_mfma_f32_16x16x32_bf16 v[80:83], v[56:59], v[224:227], v[80:83]
    ds_read_b128 v[52:55], v12 offset:37888
    buffer_load_dwordx4 v[176:179], v2, s[8:11], s41 offen offset:2048 sc1
    v_mfma_f32_16x16x32_bf16 v[84:87], v[60:63], v[224:227], v[84:87]
    ds_read_b128 v[56:59], v12 offset:38912
    s_waitcnt lgkmcnt(5)
    v_mfma_f32_16x16x32_bf16 v[88:91], v[64:67], v[224:227], v[88:91]
    ds_read_b128 v[60:63], v12 offset:39936
    v_mfma_f32_16x16x32_bf16 v[92:95], v[68:71], v[224:227], v[92:95]
    ds_read_b128 v[64:67], v12 offset:40960
    s_waitcnt lgkmcnt(5)
    v_mfma_f32_16x16x32_bf16 v[96:99], v[72:75], v[224:227], v[96:99]
    ds_read_b128 v[68:71], v12 offset:41984
    s_waitcnt vmcnt(13)
    v_mfma_f32_16x16x32_bf16 v[80:83], v[76:79], v[220:223], v[80:83]
    ds_read_b128 v[72:75], v12 offset:43008
    buffer_load_dwordx4 v[172:175], v2, s[8:11], s41 offen offset:3072 sc1
    s_waitcnt lgkmcnt(5)
    v_mfma_f32_16x16x32_bf16 v[84:87], v[48:51], v[220:223], v[84:87]
    ds_read_b128 v[76:79], v12 offset:44032
    v_mfma_f32_16x16x32_bf16 v[88:91], v[52:55], v[220:223], v[88:91]
    ds_read_b128 v[48:51], v12 offset:45056
    s_waitcnt lgkmcnt(5)
    v_mfma_f32_16x16x32_bf16 v[92:95], v[56:59], v[220:223], v[92:95]
    ds_read_b128 v[52:55], v12 offset:46080
    v_mfma_f32_16x16x32_bf16 v[96:99], v[60:63], v[220:223], v[96:99]
    ds_read_b128 v[56:59], v12 offset:47104
    s_waitcnt vmcnt(13) lgkmcnt(5)
    v_mfma_f32_16x16x32_bf16 v[80:83], v[64:67], v[216:219], v[80:83]
    ds_read_b128 v[60:63], v12 offset:48128
    s_add_u32 s41, s40, 53248
    buffer_load_dwordx4 v[168:171], v2, s[8:11], s41 offen offset:0 sc1
    v_mfma_f32_16x16x32_bf16 v[84:87], v[68:71], v[216:219], v[84:87]
    ds_read_b128 v[64:67], v12 offset:49152
    s_waitcnt lgkmcnt(5)
    v_mfma_f32_16x16x32_bf16 v[88:91], v[72:75], v[216:219], v[88:91]
    ds_read_b128 v[68:71], v12 offset:50176
    v_mfma_f32_16x16x32_bf16 v[92:95], v[76:79], v[216:219], v[92:95]
    ds_read_b128 v[72:75], v12 offset:51200
    s_waitcnt lgkmcnt(5)
    v_mfma_f32_16x16x32_bf16 v[96:99], v[48:51], v[216:219], v[96:99]
    ds_read_b128 v[76:79], v12 offset:52224
    s_waitcnt vmcnt(13)
    v_mfma_f32_16x16x32_bf16 v[80:83], v[52:55], v[212:215], v[80:83]
    ds_read_b128 v[48:51], v12 offset:53248
    buffer_load_dwordx4 v[164:167], v2, s[8:11], s41 offen offset:1024 sc1
    s_waitcnt lgkmcnt(5)
    v_mfma_f32_16x16x32_bf16 v[84:87], v[56:59], v[212:215], v[84:87]
    ds_read_b128 v[52:55], v12 offset:54272
    v_mfma_f32_16x16x32_bf16 v[88:91], v[60:63], v[212:215], v[88:91]
    ds_read_b128 v[56:59], v12 offset:55296
    s_waitcnt lgkmcnt(5)
    v_mfma_f32_16x16x32_bf16 v[92:95], v[64:67], v[212:215], v[92:95]
    ds_read_b128 v[60:63], v12 offset:56320
    v_mfma_f32_16x16x32_bf16 v[96:99], v[68:71], v[212:215], v[96:99]
    ds_read_b128 v[64:67], v12 offset:57344
    s_waitcnt vmcnt(11) lgkmcnt(5)
    v_mfma_f32_16x16x32_bf16 v[80:83], v[72:75], v[208:211], v[80:83]
    ds_read_b128 v[68:71], v12 offset:58368
    v_add_f32 v28, v28, v32
    v_mfma_f32_16x16x32_bf16 v[84:87], v[76:79], v[208:211], v[84:87]
    ds_read_b128 v[72:75], v12 offset:59392
    v_add_f32 v29, v29, v33
    v_mov_b32 v30, v28
    s_waitcnt lgkmcnt(5)
    v_mfma_f32_16x16x32_bf16 v[88:91], v[48:51], v[208:211], v[88:91]
    ds_read_b128 v[76:79], v12 offset:60416
    v_mov_b32 v31, v29
    s_nop 1
    v_permlane32_swap_b32 v28, v30
    v_mfma_f32_16x16x32_bf16 v[92:95], v[52:55], v[208:211], v[92:95]
    ds_read_b128 v[48:51], v13 offset:0
    v_permlane32_swap_b32 v29, v31
    v_add_f32 v28, v28, v30
    s_waitcnt lgkmcnt(5)
    v_mfma_f32_16x16x32_bf16 v[96:99], v[56:59], v[208:211], v[96:99]
    ds_read_b128 v[52:55], v13 offset:1024
    v_add_f32 v29, v29, v31
    v_mov_b32 v30, v28
    s_waitcnt vmcnt(10)
    v_mfma_f32_16x16x32_bf16 v[80:83], v[60:63], v[204:207], v[80:83]
    ds_read_b128 v[56:59], v13 offset:2048
    v_mov_b32 v31, v29
    s_nop 1
    v_permlane16_swap_b32 v28, v30
    s_waitcnt lgkmcnt(5)
    v_mfma_f32_16x16x32_bf16 v[84:87], v[64:67], v[204:207], v[84:87]
    ds_read_b128 v[60:63], v13 offset:3072
    v_permlane16_swap_b32 v29, v31
    v_add_f32 v28, v28, v30
    v_mfma_f32_16x16x32_bf16 v[88:91], v[68:71], v[204:207], v[88:91]
    ds_read_b128 v[64:67], v13 offset:4096
    v_add_f32 v29, v29, v31
    v_mul_f32 v28, 0x3acccccd, v28
    s_waitcnt lgkmcnt(5)
    v_mfma_f32_16x16x32_bf16 v[92:95], v[72:75], v[204:207], v[92:95]
    ds_read_b128 v[68:71], v13 offset:5120
    v_mul_f32 v29, 0x3acccccd, v29
    v_fma_f32 v29, -v28, v28, v29
    v_mfma_f32_16x16x32_bf16 v[96:99], v[76:79], v[204:207], v[96:99]
    ds_read_b128 v[72:75], v13 offset:6144
    v_max_f32 v29, 0, v29
    v_add_f32 v29, 0x3727c5ac, v29
    s_waitcnt vmcnt(9) lgkmcnt(5)
    v_mfma_f32_16x16x32_bf16 v[80:83], v[48:51], v[200:203], v[80:83]
    ds_read_b128 v[76:79], v13 offset:7168
    v_rsq_f32 v28, v29
    v_lshlrev_b32 v252, 16, v18
    v_mfma_f32_16x16x32_bf16 v[84:87], v[52:55], v[200:203], v[84:87]
    ds_read_b128 v[48:51], v13 offset:8192
    v_and_b32 v253, 0xffff0000, v18
    v_lshlrev_b32 v254, 16, v19
    s_waitcnt lgkmcnt(5)
    v_mfma_f32_16x16x32_bf16 v[88:91], v[56:59], v[200:203], v[88:91]
    ds_read_b128 v[52:55], v13 offset:9216
    v_and_b32 v255, 0xffff0000, v19
    v_lshlrev_b32 v112, 16, v20
    v_mfma_f32_16x16x32_bf16 v[92:95], v[60:63], v[200:203], v[92:95]
    ds_read_b128 v[56:59], v13 offset:10240
    v_and_b32 v113, 0xffff0000, v20
    v_lshlrev_b32 v114, 16, v21
    s_waitcnt lgkmcnt(5)
    v_mfma_f32_16x16x32_bf16 v[96:99], v[64:67], v[200:203], v[96:99]
    ds_read_b128 v[60:63], v13 offset:11264
    v_and_b32 v115, 0xffff0000, v21
    v_lshlrev_b32 v116, 16, v22
    s_waitcnt vmcnt(8)
    v_mfma_f32_16x16x32_bf16 v[80:83], v[68:71], v[196:199], v[80:83]
    ds_read_b128 v[64:67], v13 offset:12288
    v_and_b32 v117, 0xffff0000, v22
    v_lshlrev_b32 v118, 16, v23
    s_waitcnt lgkmcnt(5)
    v_mfma_f32_16x16x32_bf16 v[84:87], v[72:75], v[196:199], v[84:87]
    ds_read_b128 v[68:71], v13 offset:13312
    v_and_b32 v119, 0xffff0000, v23
    v_lshlrev_b32 v120, 16, v24
    v_mfma_f32_16x16x32_bf16 v[88:91], v[76:79], v[196:199], v[88:91]
    ds_read_b128 v[72:75], v13 offset:14336
    v_and_b32 v121, 0xffff0000, v24
    v_lshlrev_b32 v122, 16, v25
    s_waitcnt lgkmcnt(5)
    v_mfma_f32_16x16x32_bf16 v[92:95], v[48:51], v[196:199], v[92:95]
    ds_read_b128 v[76:79], v13 offset:15360
    v_and_b32 v123, 0xffff0000, v25
    v_lshlrev_b32 v124, 16, v26
    v_mfma_f32_16x16x32_bf16 v[96:99], v[52:55], v[196:199], v[96:99]
    ds_read_b128 v[48:51], v13 offset:16384
    v_and_b32 v125, 0xffff0000, v26
    v_lshlrev_b32 v126, 16, v27
    s_waitcnt vmcnt(7) lgkmcnt(5)
    v_mfma_f32_16x16x32_bf16 v[80:83], v[56:59], v[192:195], v[80:83]
    ds_read_b128 v[52:55], v13 offset:17408
    v_and_b32 v127, 0xffff0000, v27
    v_mfma_f32_16x16x32_bf16 v[84:87], v[60:63], v[192:195], v[84:87]
    ds_read_b128 v[56:59], v13 offset:18432
    s_waitcnt lgkmcnt(5)
    v_mfma_f32_16x16x32_bf16 v[88:91], v[64:67], v[192:195], v[88:91]
    ds_read_b128 v[60:63], v13 offset:19456
    v_mfma_f32_16x16x32_bf16 v[92:95], v[68:71], v[192:195], v[92:95]
    ds_read_b128 v[64:67], v13 offset:20480
    s_waitcnt lgkmcnt(5)
    v_mfma_f32_16x16x32_bf16 v[96:99], v[72:75], v[192:195], v[96:99]
    ds_read_b128 v[68:71], v13 offset:21504
    s_waitcnt vmcnt(6)
    v_mfma_f32_16x16x32_bf16 v[80:83], v[76:79], v[188:191], v[80:83]
    ds_read_b128 v[72:75], v13 offset:22528
    s_waitcnt lgkmcnt(5)
    v_mfma_f32_16x16x32_bf16 v[84:87], v[48:51], v[188:191], v[84:87]
    ds_read_b128 v[76:79], v13 offset:23552
    v_mfma_f32_16x16x32_bf16 v[88:91], v[52:55], v[188:191], v[88:91]
    ds_read_b128 v[48:51], v13 offset:24576
    s_waitcnt lgkmcnt(5)
    v_mfma_f32_16x16x32_bf16 v[92:95], v[56:59], v[188:191], v[92:95]
    ds_read_b128 v[52:55], v13 offset:25600
    v_mfma_f32_16x16x32_bf16 v[96:99], v[60:63], v[188:191], v[96:99]
    s_barrier
    ds_read_b128 v[56:59], v13 offset:26624
    s_waitcnt vmcnt(5) lgkmcnt(5)
    v_mfma_f32_16x16x32_bf16 v[80:83], v[64:67], v[184:187], v[80:83]
    ds_read_b128 v[60:63], v13 offset:27648
    v_mfma_f32_16x16x32_bf16 v[84:87], v[68:71], v[184:187], v[84:87]
    ds_read_b128 v[64:67], v13 offset:28672
    s_waitcnt lgkmcnt(5)
    v_mfma_f32_16x16x32_bf16 v[88:91], v[72:75], v[184:187], v[88:91]
    ds_read_b128 v[68:71], v13 offset:29696
    v_mfma_f32_16x16x32_bf16 v[92:95], v[76:79], v[184:187], v[92:95]
    ds_read_b128 v[72:75], v13 offset:30720
    s_waitcnt lgkmcnt(5)
    v_mfma_f32_16x16x32_bf16 v[96:99], v[48:51], v[184:187], v[96:99]
    ds_read_b128 v[76:79], v13 offset:31744
    s_waitcnt vmcnt(4)
    v_mfma_f32_16x16x32_bf16 v[80:83], v[52:55], v[180:183], v[80:83]
    ds_read_b128 v[48:51], v13 offset:32768
    s_waitcnt lgkmcnt(5)
    v_mfma_f32_16x16x32_bf16 v[84:87], v[56:59], v[180:183], v[84:87]
    ds_read_b128 v[52:55], v13 offset:33792
    v_mfma_f32_16x16x32_bf16 v[88:91], v[60:63], v[180:183], v[88:91]
    ds_read_b128 v[56:59], v13 offset:34816
    s_waitcnt lgkmcnt(5)
    v_mfma_f32_16x16x32_bf16 v[92:95], v[64:67], v[180:183], v[92:95]
    ds_read_b128 v[60:63], v13 offset:35840
    v_mfma_f32_16x16x32_bf16 v[96:99], v[68:71], v[180:183], v[96:99]
    ds_read_b128 v[64:67], v13 offset:36864
    s_waitcnt vmcnt(3) lgkmcnt(5)
    v_mfma_f32_16x16x32_bf16 v[80:83], v[72:75], v[176:179], v[80:83]
    ds_read_b128 v[68:71], v13 offset:37888
    v_mfma_f32_16x16x32_bf16 v[84:87], v[76:79], v[176:179], v[84:87]
    ds_read_b128 v[72:75], v13 offset:38912
    s_waitcnt lgkmcnt(5)
    v_mfma_f32_16x16x32_bf16 v[88:91], v[48:51], v[176:179], v[88:91]
    ds_read_b128 v[76:79], v13 offset:39936
    v_mfma_f32_16x16x32_bf16 v[92:95], v[52:55], v[176:179], v[92:95]
    ds_read_b128 v[48:51], v13 offset:40960
    s_waitcnt lgkmcnt(5)
    v_mfma_f32_16x16x32_bf16 v[96:99], v[56:59], v[176:179], v[96:99]
    ds_read_b128 v[52:55], v13 offset:41984
    s_waitcnt vmcnt(2)
    v_mfma_f32_16x16x32_bf16 v[80:83], v[60:63], v[172:175], v[80:83]
    ds_read_b128 v[56:59], v13 offset:43008
    s_waitcnt lgkmcnt(5)
    v_mfma_f32_16x16x32_bf16 v[84:87], v[64:67], v[172:175], v[84:87]
    ds_read_b128 v[60:63], v13 offset:44032
    v_mfma_f32_16x16x32_bf16 v[88:91], v[68:71], v[172:175], v[88:91]
    ds_read_b128 v[64:67], v13 offset:45056
    s_waitcnt lgkmcnt(5)
    v_mfma_f32_16x16x32_bf16 v[92:95], v[72:75], v[172:175], v[92:95]
    ds_read_b128 v[68:71], v13 offset:46080
    v_mfma_f32_16x16x32_bf16 v[96:99], v[76:79], v[172:175], v[96:99]
    ds_read_b128 v[72:75], v13 offset:47104
    s_waitcnt vmcnt(1) lgkmcnt(5)
    v_mfma_f32_16x16x32_bf16 v[80:83], v[48:51], v[168:171], v[80:83]
    ds_read_b128 v[76:79], v13 offset:48128
    v_mfma_f32_16x16x32_bf16 v[84:87], v[52:55], v[168:171], v[84:87]
    ds_read_b128 v[48:51], v13 offset:49152
    s_waitcnt lgkmcnt(5)
    v_mfma_f32_16x16x32_bf16 v[88:91], v[56:59], v[168:171], v[88:91]
    ds_read_b128 v[52:55], v13 offset:50176
    v_mfma_f32_16x16x32_bf16 v[92:95], v[60:63], v[168:171], v[92:95]
    s_waitcnt lgkmcnt(4)
    v_mfma_f32_16x16x32_bf16 v[96:99], v[64:67], v[168:171], v[96:99]
    s_waitcnt vmcnt(0)
    v_mfma_f32_16x16x32_bf16 v[80:83], v[68:71], v[164:167], v[80:83]
    s_waitcnt lgkmcnt(2)
    v_mfma_f32_16x16x32_bf16 v[84:87], v[72:75], v[164:167], v[84:87]
    v_mfma_f32_16x16x32_bf16 v[88:91], v[76:79], v[164:167], v[88:91]
    s_waitcnt lgkmcnt(0)
    v_mfma_f32_16x16x32_bf16 v[92:95], v[48:51], v[164:167], v[92:95]
    v_mfma_f32_16x16x32_bf16 v[96:99], v[52:55], v[164:167], v[96:99]
    s_nop 3
    v_pk_fma_f32 v[80:81], v[80:81], v[28:29], v[252:253] op_sel_hi:[1,0,1]
    v_pk_fma_f32 v[82:83], v[82:83], v[28:29], v[254:255] op_sel_hi:[1,0,1]
    v_cvt_pk_bf16_f32 v18, v80, v81
    v_cvt_pk_bf16_f32 v19, v82, v83
    v_pk_fma_f32 v[84:85], v[84:85], v[28:29], v[112:113] op_sel_hi:[1,0,1]
    v_pk_fma_f32 v[86:87], v[86:87], v[28:29], v[114:115] op_sel_hi:[1,0,1]
    v_cvt_pk_bf16_f32 v20, v84, v85
    v_cvt_pk_bf16_f32 v21, v86, v87
    buffer_store_dwordx4 v[18:21], v15, s[12:15], s80 offen offset:0
    v_pk_fma_f32 v[88:89], v[88:89], v[28:29], v[116:117] op_sel_hi:[1,0,1]
    v_pk_fma_f32 v[90:91], v[90:91], v[28:29], v[118:119] op_sel_hi:[1,0,1]
    v_cvt_pk_bf16_f32 v22, v88, v89
    v_cvt_pk_bf16_f32 v23, v90, v91
    v_pk_fma_f32 v[92:93], v[92:93], v[28:29], v[120:121] op_sel_hi:[1,0,1]
    v_pk_fma_f32 v[94:95], v[94:95], v[28:29], v[122:123] op_sel_hi:[1,0,1]
    v_cvt_pk_bf16_f32 v24, v92, v93
    v_cvt_pk_bf16_f32 v25, v94, v95
    buffer_store_dwordx4 v[22:25], v15, s[12:15], s80 offen offset:64
    v_pk_fma_f32 v[96:97], v[96:97], v[28:29], v[124:125] op_sel_hi:[1,0,1]
    v_pk_fma_f32 v[98:99], v[98:99], v[28:29], v[126:127] op_sel_hi:[1,0,1]
    v_cvt_pk_bf16_f32 v26, v96, v97
    v_cvt_pk_bf16_f32 v27, v98, v99
    buffer_store_dwordx2 v[26:27], v7, s[12:15], s99 offen offset:1024
p2_end:
    s_endpgm
prod_68:
    s_waitcnt vmcnt(0)
    s_barrier
    s_cmp_lg_u32 s20, 4
    s_cbranch_scc1 fl_85
    s_waitcnt vmcnt(0)
    s_mov_b64 exec, 1
    buffer_store_dword v4, v5, s[8:11], s36 offen sc1
    s_mov_b64 exec, -1
fl_85:
    s_sub_u32 s25, s20, 4
    s_mul_i32 s32, s25, 5120
    v_add_u32 v6, s32, v2
    s_mul_i32 s38, s25, 2560
    v_add_u32 v7, s38, v2
    s_mul_i32 s33, s77, 276480
    s_add_u32 s33, s33, 23319552
    s_mov_b32 s34, 0
    buffer_load_dwordx4 v[32:35], v6, s[8:11], s33 offen offset:0 sc1
    buffer_load_dwordx4 v[36:39], v6, s[8:11], s33 offen offset:1024 sc1
    buffer_load_dwordx4 v[40:43], v6, s[8:11], s33 offen offset:2048 sc1
    buffer_load_dwordx4 v[44:47], v6, s[8:11], s33 offen offset:3072 sc1
    s_add_u32 s33, s33, 4096
    buffer_load_dwordx4 v[48:51], v6, s[8:11], s33 offen offset:0 sc1
    s_mul_i32 s33, s77, 276480
    s_add_u32 s33, s33, 23340032
    s_mov_b32 s34, 20480
    buffer_load_dwordx4 v[52:55], v6, s[8:11], s33 offen offset:0 sc1
    buffer_load_dwordx4 v[56:59], v6, s[8:11], s33 offen offset:1024 sc1
    buffer_load_dwordx4 v[60:63], v6, s[8:11], s33 offen offset:2048 sc1
    buffer_load_dwordx4 v[64:67], v6, s[8:11], s33 offen offset:3072 sc1
    s_add_u32 s33, s33, 4096
    buffer_load_dwordx4 v[68:71], v6, s[8:11], s33 offen offset:0 sc1
    s_waitcnt lgkmcnt(0)
    s_barrier
    v_add_u32 v8, 122880, v6
    ds_write_b128 v8, v[156:159] offset:0
    ds_write_b128 v8, v[160:163] offset:1024
    ds_write_b128 v8, v[164:167] offset:2048
    ds_write_b128 v8, v[168:171] offset:3072
    ds_write_b128 v8, v[172:175] offset:4096
    v_add_u32 v8, 143360, v6
    ds_write_b128 v8, v[176:179] offset:0
    ds_write_b128 v8, v[180:183] offset:1024
    ds_write_b128 v8, v[184:187] offset:2048
    ds_write_b128 v8, v[188:191] offset:3072
    ds_write_b128 v8, v[192:195] offset:4096
    s_waitcnt lgkmcnt(0)
    s_barrier
    s_waitcnt vmcnt(5)
    v_mov_b32 v8, v6
    ds_write_b128 v8, v[32:35] offset:0
    ds_write_b128 v8, v[36:39] offset:1024
    ds_write_b128 v8, v[40:43] offset:2048
    ds_write_b128 v8, v[44:47] offset:3072
    ds_write_b128 v8, v[48:51] offset:4096
    s_waitcnt lgkmcnt(0)
    s_barrier
    s_waitcnt vmcnt(0)
    v_add_u32 v8, 20480, v6
    ds_write_b128 v8, v[52:55] offset:0
    ds_write_b128 v8, v[56:59] offset:1024
    ds_write_b128 v8, v[60:63] offset:2048
    ds_write_b128 v8, v[64:67] offset:3072
    ds_write_b128 v8, v[68:71] offset:4096
    s_waitcnt lgkmcnt(0)
    s_barrier
    s_mul_i32 s33, s77, 276480
    s_add_u32 s33, s33, 23360512
    s_mov_b32 s34, 40960
    s_add_u32 m0, s34, s32
    s_add_u32 s25, s33, 4096
    buffer_load_dwordx4 v6, s[8:11], s33 offen offset:0 sc1 lds
    buffer_load_dwordx4 v6, s[8:11], s33 offen offset:1024 sc1 lds
    buffer_load_dwordx4 v6, s[8:11], s33 offen offset:2048 sc1 lds
    buffer_load_dwordx4 v6, s[8:11], s33 offen offset:3072 sc1 lds
    s_add_u32 m0, m0, 4096
    s_add_u32 s33, s33, 20480
    buffer_load_dwordx4 v6, s[8:11], s25 offen sc1 lds
    s_add_u32 s34, s34, 20480
    s_cmp_ge_u32 s34, 163840
    s_cselect_b32 s34, 0, s34
    s_waitcnt lgkmcnt(0)
    s_barrier
    s_add_u32 m0, s34, s32
    s_add_u32 s25, s33, 4096
    buffer_load_dwordx4 v6, s[8:11], s33 offen offset:0 sc1 lds
    buffer_load_dwordx4 v6, s[8:11], s33 offen offset:1024 sc1 lds
    buffer_load_dwordx4 v6, s[8:11], s33 offen offset:2048 sc1 lds
    buffer_load_dwordx4 v6, s[8:11], s33 offen offset:3072 sc1 lds
    s_add_u32 m0, m0, 4096
    s_add_u32 s33, s33, 20480
    buffer_load_dwordx4 v6, s[8:11], s25 offen sc1 lds
    s_add_u32 s34, s34, 20480
    s_cmp_ge_u32 s34, 163840
    s_cselect_b32 s34, 0, s34
    s_waitcnt lgkmcnt(0)
    s_barrier
    s_add_u32 m0, s34, s32
    s_add_u32 s25, s33, 4096
    buffer_load_dwordx4 v6, s[8:11], s33 offen offset:0 sc1 lds
    buffer_load_dwordx4 v6, s[8:11], s33 offen offset:1024 sc1 lds
    buffer_load_dwordx4 v6, s[8:11], s33 offen offset:2048 sc1 lds
    buffer_load_dwordx4 v6, s[8:11], s33 offen offset:3072 sc1 lds
    s_add_u32 m0, m0, 4096
    s_add_u32 s33, s33, 20480
    buffer_load_dwordx4 v6, s[8:11], s25 offen sc1 lds
    s_add_u32 s34, s34, 20480
    s_cmp_ge_u32 s34, 163840
    s_cselect_b32 s34, 0, s34
    s_waitcnt lgkmcnt(0)
    s_barrier
    s_add_u32 m0, s34, s32
    s_add_u32 s25, s33, 4096
    buffer_load_dwordx4 v6, s[8:11], s33 offen offset:0 sc1 lds
    buffer_load_dwordx4 v6, s[8:11], s33 offen offset:1024 sc1 lds
    buffer_load_dwordx4 v6, s[8:11], s33 offen offset:2048 sc1 lds
    buffer_load_dwordx4 v6, s[8:11], s33 offen offset:3072 sc1 lds
    s_add_u32 m0, m0, 4096
    s_add_u32 s33, s33, 20480
    buffer_load_dwordx4 v6, s[8:11], s25 offen sc1 lds
    s_add_u32 s34, s34, 20480
    s_cmp_ge_u32 s34, 163840
    s_cselect_b32 s34, 0, s34
    s_waitcnt lgkmcnt(0)
    s_barrier
    s_add_u32 m0, s34, s32
    s_add_u32 s25, s33, 4096
    buffer_load_dwordx4 v6, s[8:11], s33 offen offset:0 sc1 lds
    buffer_load_dwordx4 v6, s[8:11], s33 offen offset:1024 sc1 lds
    buffer_load_dwordx4 v6, s[8:11], s33 offen offset:2048 sc1 lds
    buffer_load_dwordx4 v6, s[8:11], s33 offen offset:3072 sc1 lds
    s_add_u32 m0, m0, 4096
    s_add_u32 s33, s33, 20480
    buffer_load_dwordx4 v6, s[8:11], s25 offen sc1 lds
    s_add_u32 s34, s34, 20480
    s_cmp_ge_u32 s34, 163840
    s_cselect_b32 s34, 0, s34
    s_waitcnt vmcnt(20)
    s_waitcnt lgkmcnt(0)
    s_barrier
    v_add_u32 v8, 143360, v6
    ds_write_b128 v8, v[196:199] offset:0
    ds_write_b128 v8, v[200:203] offset:1024
    ds_write_b128 v8, v[204:207] offset:2048
    ds_write_b128 v8, v[208:211] offset:3072
    ds_write_b128 v8, v[212:215] offset:4096
    s_waitcnt vmcnt(10)
    s_waitcnt lgkmcnt(0)
    s_barrier
    s_mul_i32 s33, s77, 276480
    s_add_u32 s33, s33, 23483392
    s_mov_b32 s34, 0
    s_mov_b32 s28, 2
pl_86:
    s_add_u32 m0, s34, s32
    s_add_u32 s25, s33, 4096
    buffer_load_dwordx4 v6, s[8:11], s33 offen offset:0 sc1 lds
    buffer_load_dwordx4 v6, s[8:11], s33 offen offset:1024 sc1 lds
    buffer_load_dwordx4 v6, s[8:11], s33 offen offset:2048 sc1 lds
    buffer_load_dwordx4 v6, s[8:11], s33 offen offset:3072 sc1 lds
    s_add_u32 m0, m0, 4096
    s_add_u32 s33, s33, 20480
    buffer_load_dwordx4 v6, s[8:11], s25 offen sc1 lds
    s_add_u32 s34, s34, 20480
    s_cmp_ge_u32 s34, 163840
    s_cselect_b32 s34, 0, s34
    s_sub_u32 s28, s28, 1
    s_cmp_lg_u32 s28, 0
    s_cbranch_scc1 pl_86
    s_waitcnt vmcnt(10)
    s_waitcnt lgkmcnt(0)
    s_barrier
    s_add_u32 m0, s34, s32
    s_add_u32 s25, s33, 4096
    buffer_load_dwordx4 v6, s[8:11], s33 offen offset:0 sc1 lds
    buffer_load_dwordx4 v6, s[8:11], s33 offen offset:1024 sc1 lds
    buffer_load_dwordx4 v6, s[8:11], s33 offen offset:2048 sc1 lds
    buffer_load_dwordx4 v6, s[8:11], s33 offen offset:3072 sc1 lds
    s_add_u32 m0, m0, 4096
    s_add_u32 s33, s33, 20480
    buffer_load_dwordx4 v6, s[8:11], s25 offen sc1 lds
    s_add_u32 s34, s34, 20480
    s_cmp_ge_u32 s34, 163840
    s_cselect_b32 s34, 0, s34
    v_add_u32 v8, 61440, v6
    ds_write_b128 v8, v[216:219] offset:0
    ds_write_b128 v8, v[220:223] offset:1024
    ds_write_b128 v8, v[224:227] offset:2048
    ds_write_b128 v8, v[228:231] offset:3072
    ds_write_b128 v8, v[232:235] offset:4096
    s_waitcnt vmcnt(5)
    s_waitcnt lgkmcnt(0)
    s_barrier
    v_add_u32 v8, 81920, v6
    ds_write_b128 v8, v[236:239] offset:0
    ds_write_b128 v8, v[240:243] offset:1024
    ds_write_b128 v8, v[244:247] offset:2048
    ds_write_b128 v8, v[248:251] offset:3072
    ds_write_b128 v8, v[252:255] offset:4096
    s_mul_i32 s33, s77, 276480
    s_add_u32 s33, s33, 23585792
    s_mov_b32 s34, 102400
    s_add_u32 m0, s34, s38
    s_nop 0
    buffer_load_dwordx4 v7, s[8:11], s33 offen offset:0 sc1 lds
    buffer_load_dwordx4 v7, s[8:11], s33 offen offset:1024 sc1 lds
    s_mov_b32 exec_hi, 0
    buffer_load_dwordx4 v7, s[8:11], s33 offen offset:2048 sc1 lds
    s_waitcnt vmcnt(3)
    s_waitcnt lgkmcnt(0)
    s_barrier
    s_waitcnt vmcnt(0)
    s_waitcnt lgkmcnt(0)
    s_barrier
    s_endpgm
su_53:
    s_mov_b32 s3, 1
    s_mul_i32 s32, s20, 2560
    v_add_u32 v28, s32, v2
    s_mov_b32 s42, 0
    v_lshlrev_b32 v3, 2, v1
    v_mov_b32 v5, 0
    v_mov_b32 v12, v2
    v_add_u32 v13, 61440, v2
    v_add_u32 v14, 122880, v2
    s_mul_i32 s25, s20, 3072
    s_add_u32 s25, s25, 20480
    v_add_u32 v34, s25, v2
    s_xor_b32 s25, s20, 4
    s_mul_i32 s25, s25, 3072
    s_add_u32 s25, s25, 20480
    v_add_u32 v35, s25, v2
    s_mul_i32 s58, s23, 40960
    s_add_u32 s58, s58, 7884800
    s_lshl_b32 s25, s96, 7
    s_add_u32 s59, s58, s25
    s_add_u32 s59, s59, 16384
    s_lshl_b32 s25, s96, 9
    s_add_u32 s58, s58, s25
    v_mul_u32_u24 v8, 20480, v206
    v_lshl_add_u32 v37, v207, 3, v8
    v_lshl_add_u32 v36, v207, 4, v8
    v_lshl_add_u32 v36, v204, 8, v36
    s_and_b32 s26, s20, 3
    s_and_b32 s76, s22, 3
    s_lshl_b32 s76, s76, 2
    s_lshl_b32 s25, s21, 4
    s_add_u32 s76, s76, s25
    s_add_u32 s76, s76, s26
    s_lshr_b32 s77, s22, 2
    s_and_b32 s78, s22, 1
    s_lshl_b32 s78, s78, 2
    s_lshl_b32 s25, s21, 3
    s_add_u32 s78, s78, s25
    s_add_u32 s78, s78, s26
    s_lshr_b32 s79, s22, 1
    v_mul_u32_u24 v15, 1280, v207
    v_lshl_add_u32 v15, v205, 4, v15
    s_mul_i32 s25, s76, 20480
    s_lshl_b32 s26, s77, 7
    s_add_u32 s80, s25, s26
    s_lshl_b32 s26, s77, 5
    s_add_u32 s99, s25, s26
    v_lshlrev_b32 v16, 4, v207
    v_lshl_add_u32 v16, v204, 9, v16
    v_lshl_add_u32 v16, v206, 3, v16
    v_lshlrev_b32 v17, 3, v207
    v_lshl_add_u32 v17, v205, 8, v17
    s_mul_i32 s33, s77, 102400
    s_add_u32 s33, s33, 20206592
    s_mul_i32 s25, s20, 5120
    v_add_u32 v41, s25, v2
    s_add_u32 s34, s25, 61440
    s_min_u32 s28, s79, 13
    s_mul_i32 s28, s28, 163840
    s_add_u32 s28, s28, 21025792
    s_mul_i32 s25, s24, 102400
    s_add_u32 s81, s28, s25
    s_add_u32 s81, s81, 20480
    s_mul_i32 s83, s77, 276480
    s_add_u32 s83, s83, 23319552
    s_and_b32 s25, s20, 3
    s_mul_i32 s25, s25, 5120
    v_add_u32 v38, s25, v2
    v_lshrrev_b32 v6, 2, v1
    v_xor_b32 v8, v6, v205
    v_and_b32 v8, 1, v8
    v_and_b32 v6, 2, v6
    v_or_b32 v8, v8, v6
    v_mov_b32 v6, 0x3f803f80
    v_cmp_eq_u32 vcc, 0, v8
    s_nop 1
    v_cndmask_b32 v176, 0, v6, vcc
    v_cndmask_b32 v177, 0, v6, vcc
    v_cndmask_b32 v178, 0, v6, vcc
    v_cndmask_b32 v179, 0, v6, vcc
    v_cmp_eq_u32 vcc, 2, v8
    s_nop 1
    v_cndmask_b32 v180, 0, v6, vcc
    v_cndmask_b32 v181, 0, v6, vcc
    v_cndmask_b32 v182, 0, v6, vcc
    v_cndmask_b32 v183, 0, v6, vcc
    s_lshl_b32 s29, s20, 12
    s_add_u32 s29, s29, 61440
    s_cmp_lt_u32 s20, 3
    s_cbranch_scc1 prep_87
    s_mul_i32 s35, s2, 5
    s_add_u32 s35, s35, s20
    s_sub_u32 s35, s35, 3
    s_call_b64 s[46:47], prep_47
    s_branch prep_51
prep_87:
    s_mov_b32 s36, 0
    s_mov_b32 s37, 0
    s_mov_b32 s43, 0
    s_mov_b32 s39, 0
    s_mov_b32 s40, 0
    s_mov_b32 s41, 0
    s_mov_b32 s38, 0
    s_mov_b32 s35, 0
    v_mov_b32 v211, v2
    v_mov_b32 v212, v2
    v_mov_b32 v213, v2
    v_mov_b32 v214, v2
    v_mov_b32 v215, v2
    v_mov_b32 v216, v2
    v_mov_b32 v217, v2
    v_mov_b32 v218, v2
    v_mov_b32 v209, v2
prep_51:
    s_setpc_b64 s[100:101]
prep_47:
    s_mov_b32 s16, s48
    s_mov_b32 s17, s49
    s_mov_b32 s18, 819200
    s_mov_b32 s19, 0x20000
    v_bfe_u32 v6, v1, 2, 2
    v_and_b32 v8, 3, v1
    v_lshlrev_b32 v8, 3, v8
    v_lshl_add_u32 v8, v6, 7, v8
    v_add_u32 v8, s29, v8
    v_lshl_add_u32 v32, v204, 11, v8
    v_lshl_add_u32 v32, v206, 9, v32
    v_add_u32 v33, 1024, v32
    v_lshrrev_b32 v209, 3, v1
    s_mov_b32 s27, s35
    s_mov_b32 s36, 20206592
    s_mov_b32 s37, 102400
    s_mov_b32 s40, 8
    s_mov_b32 s41, 12
    s_mov_b32 s39, 40
    s_cmp_lt_u32 s35, 200
    s_cbranch_scc1 prep_91
    s_mov_b32 s41, 8
    s_mov_b32 s39, 32
    s_mov_b32 s18, 2211840
    s_cmp_lt_u32 s35, 740
    s_cbranch_scc0 prep_89
    s_mov_b32 s16, s54
    s_mov_b32 s17, s55
    s_sub_u32 s27, s35, 200
    s_mov_b32 s36, 23319552
    s_mov_b32 s37, 276480
prep_91:
    s_mul_i32 s25, s27, 6554
    s_lshr_b32 s25, s25, 16
    s_mul_i32 s26, s25, 10
    s_sub_u32 s38, s27, s26
    s_bfe_u32 s26, s25, 0x10001
    s_mul_i32 s26, s26, 27
    s_lshr_b32 s27, s25, 1
    s_add_u32 s26, s26, s27
    s_and_b32 s27, s25, 1
    s_add_u32 s26, s26, s27
    s_cmp_lt_u32 s35, 200
    s_cselect_b32 s26, s25, s26
    s_mul_i32 s26, s26, 5120
    s_add_u32 s36, s36, s26
    s_mul_i32 s39, s39, s25
    s_mov_b32 s27, 1280
    s_sub_u32 s26, s35, 160
    s_cmp_lt_u32 s26, 40
    s_cbranch_scc0 prep_90
    s_mul_i32 s39, s25, 160
    s_sub_u32 s39, s39, 2544
    s_mov_b32 s40, 40
    s_mov_b32 s41, 40
    v_lshl_add_u32 v209, v204, 4, v209
    v_lshl_add_u32 v32, v205, 10, v8
    v_add_u32 v33, 512, v32
    s_branch prep_90
prep_89:
    s_mov_b32 s16, s52
    s_mov_b32 s17, s53
    s_sub_u32 s27, s35, 740
    s_mul_i32 s25, s27, 2428
    s_lshr_b32 s25, s25, 16
    s_mul_i32 s26, s25, 27
    s_sub_u32 s38, s27, s26
    s_lshr_b32 s26, s38, 1
    s_mul_i32 s36, s26, 163840
    s_lshl_b32 s26, s25, 12
    s_sub_u32 s27, 161792, s26
    s_bitcmp1_b32 s38, 0
    s_cselect_b32 s26, s27, s26
    s_mov_b32 s37, 2048
    s_cselect_b32 s37, 0xfffff800, s37
    s_add_u32 s36, s36, s26
    s_add_u32 s36, s36, 21025792
    v_lshl_add_u32 v32, v204, 10, v8
    v_lshl_add_u32 v32, v206, 5, v32
    s_lshl_b32 s39, s25, 5
    s_mov_b32 s27, 3456
prep_90:
    s_mul_i32 s39, s39, s27
    s_lshl_b32 s26, s38, 7
    s_add_u32 s39, s39, s26
    s_mul_i32 s40, s40, s27
    s_mul_i32 s41, s41, s27
    v_mul_lo_u32 v209, v209, s27
    v_and_b32 v9, 7, v1
    v_lshl_add_u32 v209, v9, 4, v209
    s_cmp_ge_u32 s35, 740
    s_cbranch_scc1 prep_92
    s_mov_b32 s27, 64
    s_cmp_ge_u32 s38, 8
    s_cbranch_scc1 prep_93
    v_and_b32 v6, 3, v1
    v_lshl_add_u32 v32, v6, 3, v32
    v_lshl_add_u32 v33, v6, 3, v33
    s_mov_b32 s26, 8
    s_mul_i32 s25, s38, s37
    s_add_u32 s36, s36, s25
    s_mov_b32 s37, 1024
    s_mov_b32 s43, 2048
    s_branch prep_94
prep_93:
    s_mov_b32 s26, 32
    s_sub_u32 s25, s38, 8
    s_lshl_b32 s25, s25, 2
    s_mul_i32 s25, s25, s37
    s_add_u32 s25, s25, 4096
    s_add_u32 s36, s36, s25
    s_lshl_b32 s43, s37, 1
    s_branch prep_94
prep_92:
    v_add_u32 v33, 512, v32
    s_mov_b32 s26, 64
    s_mov_b32 s27, 2048
    s_mov_b32 s43, s37
    s_mov_b32 s37, 1024
prep_94:
    v_mov_b32 v211, v32
    v_add_u32 v213, s26, v32
    v_add_u32 v215, s27, v32
    v_add_u32 v217, s27, v213
    v_mov_b32 v212, v33
    v_add_u32 v214, s26, v33
    v_add_u32 v216, s27, v33
    v_add_u32 v218, s27, v214
    s_lshl_b32 s38, s38, 8
    s_add_u32 s38, s38, 25783296
    s_setpc_b64 s[46:47]
pc_63:
    s_mov_b32 s26, 0
    s_mov_b32 s25, 25782272
pc_95:
    buffer_load_dwordx4 v[152:155], v2, s[8:11], s25 offen sc1
    s_add_u32 s26, s26, 1
    s_cmp_gt_u32 s26, 200000
    s_waitcnt vmcnt(0)
    s_cbranch_scc1 pc_64
    v_min3_u32 v6, v152, v153, v154
    v_min_u32 v6, v6, v155
    v_cmp_eq_u32 vcc, 0, v6
    s_cbranch_vccnz pc_95
    s_branch pc_64
wt_72:
    s_mov_b64 exec, 1
    buffer_store_dword v4, v5, s[8:11], s36 offen sc1
    s_mov_b64 exec, -1
    s_branch wt_73
wt_77:
    s_mov_b64 exec, 1
    buffer_store_dword v4, v5, s[16:19], s39 offen sc1
    s_mov_b64 exec, -1
    s_branch wt_78
spin_79:
    s_mov_b32 s26, 0
spin_96:
    buffer_load_dword v36, v10, s[8:11], s31 offen sc1
    s_add_u32 s26, s26, 1
    s_cmp_gt_u32 s26, 200000
    s_waitcnt vmcnt(0)
    s_cbranch_scc1 spin_80
    v_cmp_ne_u32 vcc, 1, v36
    s_cbranch_vccnz spin_96
    s_branch spin_80
wt_81:
    s_mov_b64 exec, 1
    buffer_store_dword v4, v5, s[16:19], s39 offen sc1
    s_mov_b64 exec, -1
    s_branch wt_82
spin_83:
    s_mov_b32 s26, 0
spin_97:
    buffer_load_dword v36, v10, s[8:11], s31 offen sc1
    s_add_u32 s26, s26, 1
    s_cmp_gt_u32 s26, 200000
    s_waitcnt vmcnt(0)
    s_cbranch_scc1 spin_84
    v_cmp_ne_u32 vcc, 1, v36
    s_cbranch_vccnz spin_97
    s_branch spin_84
slow_65:
    s_mov_b32 s43, 1
    s_mul_i32 s25, s24, 1280
    v_subrev_u32 v32, s25, v29
    v_subrev_u32 v33, s25, v30
    v_subrev_u32 v34, s25, v31
    v_mov_b32 v6, 0xff61b1e6
    v_mov_b32 v88, 0
    v_mov_b32 v89, 0
    v_mov_b32 v90, 0
    v_mov_b32 v91, 0
    v_mov_b32 v92, 0
    v_mov_b32 v93, 0
    v_mov_b32 v94, 0
    v_mov_b32 v95, 0
    v_mov_b32 v96, 0
    v_mov_b32 v97, 0
    v_mov_b32 v98, 0
    v_mov_b32 v99, 0
    v_mov_b32 v100, 0
    v_mov_b32 v101, 0
    v_mov_b32 v102, 0
    v_mov_b32 v103, 0
    s_mov_b32 s28, 0
sl_98:
    s_mul_i32 s25, s28, 1280
    s_lshr_b32 s26, s28, 3
    s_mul_i32 s26, s26, 10240
    s_add_u32 s25, s25, s26
    s_add_u32 s25, s25, s31
    buffer_load_dwordx4 v[56:59], v32, s[8:11], s25 offen sc1
    buffer_load_dwordx2 v[68:69], v33, s[8:11], s25 offen sc1
    s_mov_b64 exec, s[44:45]
    buffer_load_dwordx4 v[60:63], v34, s[8:11], s25 offen sc1
    buffer_load_dwordx4 v[64:67], v34, s[8:11], s25 offen offset:640 sc1
    s_mov_b64 exec, -1
    s_waitcnt vmcnt(0)
    v_mfma_f32_32x32x8_bf16 v[136:151], v[68:69], v[54:55], 0
    v_mfma_f32_32x32x16_bf16 v[136:151], v[56:59], v[48:51], v[136:151]
    s_nop 7
    s_nop 4
    v_max3_f32 v7, v136, v137, v6
    v_max3_f32 v7, v138, v139, v7
    v_max3_f32 v7, v140, v141, v7
    v_max3_f32 v7, v142, v143, v7
    v_max3_f32 v7, v144, v145, v7
    v_max3_f32 v7, v146, v147, v7
    v_max3_f32 v7, v148, v149, v7
    v_max3_f32 v7, v150, v151, v7
    v_mov_b32 v10, v7
    s_nop 1
    v_permlane32_swap_b32 v7, v10
    v_max_f32 v7, v7, v10
    v_sub_f32 v10, v6, v7
    v_exp_f32 v10, v10
    v_mov_b32 v6, v7
    v_sub_f32 v136, v136, v7
    v_mul_f32 v88, v88, v10
    v_sub_f32 v137, v137, v7
    v_mul_f32 v89, v89, v10
    v_sub_f32 v138, v138, v7
    v_mul_f32 v90, v90, v10
    v_sub_f32 v139, v139, v7
    v_mul_f32 v91, v91, v10
    v_sub_f32 v140, v140, v7
    v_mul_f32 v92, v92, v10
    v_sub_f32 v141, v141, v7
    v_mul_f32 v93, v93, v10
    v_sub_f32 v142, v142, v7
    v_mul_f32 v94, v94, v10
    v_sub_f32 v143, v143, v7
    v_mul_f32 v95, v95, v10
    v_sub_f32 v144, v144, v7
    v_mul_f32 v96, v96, v10
    v_sub_f32 v145, v145, v7
    v_mul_f32 v97, v97, v10
    v_sub_f32 v146, v146, v7
    v_mul_f32 v98, v98, v10
    v_sub_f32 v147, v147, v7
    v_mul_f32 v99, v99, v10
    v_sub_f32 v148, v148, v7
    v_mul_f32 v100, v100, v10
    v_sub_f32 v149, v149, v7
    v_mul_f32 v101, v101, v10
    v_sub_f32 v150, v150, v7
    v_mul_f32 v102, v102, v10
    v_sub_f32 v151, v151, v7
    v_mul_f32 v103, v103, v10
    v_exp_f32 v136, v136
    v_exp_f32 v137, v137
    v_exp_f32 v138, v138
    v_exp_f32 v139, v139
    v_cvt_pk_bf16_f32 v112, v136, v137
    v_cvt_pk_bf16_f32 v113, v138, v139
    v_exp_f32 v140, v140
    v_exp_f32 v141, v141
    v_exp_f32 v142, v142
    v_exp_f32 v143, v143
    v_cvt_pk_bf16_f32 v114, v140, v141
    v_cvt_pk_bf16_f32 v115, v142, v143
    v_exp_f32 v144, v144
    v_exp_f32 v145, v145
    v_exp_f32 v146, v146
    v_exp_f32 v147, v147
    v_cvt_pk_bf16_f32 v116, v144, v145
    v_cvt_pk_bf16_f32 v117, v146, v147
    v_exp_f32 v148, v148
    v_exp_f32 v149, v149
    v_exp_f32 v150, v150
    v_exp_f32 v151, v151
    v_cvt_pk_bf16_f32 v118, v148, v149
    v_cvt_pk_bf16_f32 v119, v150, v151
    s_nop 1
    v_mfma_f32_32x32x16_bf16 v[88:103], v[60:63], v[112:115], v[88:103]
    v_mfma_f32_32x32x16_bf16 v[88:103], v[64:67], v[116:119], v[88:103]
    s_add_u32 s28, s28, 1
    s_cmp_lt_u32 s28, 64
    s_nop 7
    s_nop 3
    s_cbranch_scc1 sl_98
    s_branch fin_66
code_end:
    s_endpgm
.section .rodata,"a"
.p2align 6
.amdhsa_kernel sequential_preLN__mha_block__dense_activation_relu__prompt_kernel
  .amdhsa_next_free_vgpr 256
  .amdhsa_next_free_sgpr 102
  .amdhsa_accum_offset 256
  .amdhsa_group_segment_fixed_size 0
  .amdhsa_kernarg_size 72
  .amdhsa_user_sgpr_count 2
  .amdhsa_user_sgpr_kernarg_segment_ptr 1
  .amdhsa_system_sgpr_workgroup_id_x 1
.end_amdhsa_kernel
```
